```python
import torch

def _softmax(x, axis=-1):
    return torch.softmax(x, dim=axis)

def _gelu(x):
    return torch.nn.functional.gelu(x, approximate='tanh')

def _silu(x):
    return torch.nn.functional.silu(x)

def _sigmoid(x):
    return torch.sigmoid(x)

def _layernorm(x, axis=-1, eps=1e-05):
    m = x.mean(dim=axis, keepdim=True)
    v = x.var(dim=axis, keepdim=True, unbiased=False)
    return (x - m) / torch.sqrt(v + eps)

def _scatter_add(tgt, idx, src, axis=0):
    return tgt.clone().index_add_(axis, idx, src)

def _segment_sum(src, seg, n):
    out = torch.zeros((n,) + src.shape[1:], dtype=src.dtype)
    return out.index_add_(0, seg, src)

def _pad(x, pw):
    flat = tuple((v for pair in reversed(pw) for v in pair))
    return torch.nn.functional.pad(x, flat)
kernel_name = 'adaLN_cond__memory_aug_recurrent_mem_tr__glu_gated_geglu__prompt'

def setup_inputs():

    _w = lambda a: (lambda t: t.to(torch.bfloat16) if t.is_floating_point() else t)(torch.as_tensor(a))

    def _A_setup():
        B, S, Dm = (1, 2048, 512)
        H, Dh = (32, 128)
        M, seg = (8, 32)
        seg = min(seg, S)
        S = S // seg * seg
        return {'x': _w((lambda *s: torch.randn(*s, dtype=torch.bfloat16) * 0.05)(B, S, Dm)), 'mem0': _w((lambda *s: torch.randn(*s, dtype=torch.bfloat16) * 0.8)(B, M, Dm)), 'Wq': _w((lambda *s: torch.randn(*s, dtype=torch.bfloat16) * 0.8)(Dm, H, Dh) * Dm ** (-0.5)), 'Wk': _w((lambda *s: torch.randn(*s, dtype=torch.bfloat16) * 0.8)(Dm, H, Dh) * Dm ** (-0.5)), 'Wv': _w((lambda *s: torch.randn(*s, dtype=torch.bfloat16) * 0.8)(Dm, H, Dh) * Dm ** (-0.5)), 'Wo': _w((lambda *s: torch.randn(*s, dtype=torch.bfloat16) * 0.8)(H, Dh, Dm) * (H * Dh) ** (-0.5)), 'seg_len': seg}
    _A_in = _A_setup()

    def _B_setup():
        B, S, Dm, Df = (1, 2048, 512, 1376)
        return {'x': _w((lambda *s: torch.randn(*s, dtype=torch.bfloat16) * 0.05)(B, S, Dm)), 'w_gate': _w((lambda *s: torch.randn(*s, dtype=torch.bfloat16) * 0.4)(Dm, Df) * Dm ** (-0.5)), 'w_up': _w((lambda *s: torch.randn(*s, dtype=torch.bfloat16) * 0.4)(Dm, Df) * Dm ** (-0.5)), 'w_down': _w((lambda *s: torch.randn(*s, dtype=torch.bfloat16) * 0.4)(Df, Dm) * Df ** (-0.5))}
    _B_in = _B_setup()
    return {'A_x': _A_in['x'], 'A_mem0': _A_in['mem0'], 'A_Wq': _A_in['Wq'], 'A_Wk': _A_in['Wk'], 'A_Wv': _A_in['Wv'], 'A_Wo': _A_in['Wo'], 'A_seg_len': _A_in['seg_len'], 'B_x': _B_in['x'], 'B_w_gate': _B_in['w_gate'], 'B_w_up': _B_in['w_up'], 'B_w_down': _B_in['w_down'], 'c': _w((lambda *s: torch.randn(*s, dtype=torch.bfloat16) * 0.2)(1, 512) * 8.0), 'w_mod': _w((lambda *s: torch.randn(*s, dtype=torch.bfloat16) * 0.2)(512, 6 * 512) * 512 ** (-0.5) * 8.0)}

def reference(A_x, A_mem0, A_Wq, A_Wk, A_Wv, A_Wo, A_seg_len, B_x, B_w_gate, B_w_up, B_w_down, c, w_mod):

    def _A_ref(x, mem0, Wq, Wk, Wv, Wo, seg_len):
        B, S, Dm = x.shape
        H, Dh = (Wq.shape[1], Wq.shape[2])
        M = mem0.shape[1]
        scale = Dh ** (-0.5)
        n_seg = S // seg_len
        L = M + seg_len
        idx = torch.arange(L)
        mask = (idx[:, None] < M) | (idx[:, None] >= idx[None, :])
        mem = mem0
        outs = []
        for s in range(n_seg):
            xs = x[:, s * seg_len:(s + 1) * seg_len, :].clone()
            h = torch.concatenate([mem, xs], axis=1)
            q = torch.einsum('btd,dhe->bhte', h, Wq)
            k = torch.einsum('btd,dhe->bhte', h, Wk)
            v = torch.einsum('btd,dhe->bhte', h, Wv)
            scores = torch.einsum('bhqe,bhke->bhqk', q, k) * scale
            scores = torch.where(mask[None, None], scores, -1000000000.0)
            p = _softmax(scores, axis=-1)
            o = torch.einsum('bhqk,bhke->bhqe', p, v)
            o = torch.einsum('bhte,hed->btd', o, Wo)
            mem = o[:, :M, :].clone()
            outs.append(o[:, M:, :])
        return torch.concatenate(outs, axis=1)

    def _B_ref(x, w_gate, w_up, w_down):
        g = torch.einsum('bsd,df->bsf', x, w_gate)
        u = torch.einsum('bsd,df->bsf', x, w_up)
        h = _gelu(g) * u
        return torch.einsum('bsf,fd->bsd', h, w_down)
    x = A_x
    mod = (_silu(c) @ w_mod).reshape(c.shape[0], 6, 1, -1)
    sa, ca, ga, sb, cb, gb = (mod[:, 0].clone(), mod[:, 1].clone(), mod[:, 2].clone(), mod[:, 3].clone(), mod[:, 4].clone(), mod[:, 5].clone())
    h = _layernorm(x, axis=-1) * (1 + ca) + sa
    x = x + ga * _A_ref(h, A_mem0, A_Wq, A_Wk, A_Wv, A_Wo, A_seg_len)
    h = _layernorm(x, axis=-1) * (1 + cb) + sb
    x = x + gb * _B_ref(h, B_w_gate, B_w_up, B_w_down)
    return x
```

```asm
; @launch kernel=prep_kernel grid=(256,1,1) block=(256,1,1) lds=2048
; @launch kernel=main_kernel grid=(256,1,1) block=(256,1,1) lds=162560
.amdgcn_target "amdgcn-amd-amdhsa--gfx950"
.text
.globl prep_kernel
.p2align 8
.type prep_kernel,@function
prep_kernel:
    s_cmp_ge_u32 s2, 256
    s_cbranch_scc1 prep_done
    s_load_dwordx2 s[4:5], s[0:1], 120
    s_load_dwordx2 s[6:7], s[0:1], 8
    s_load_dwordx2 s[8:9], s[0:1], 88
    s_load_dwordx2 s[10:11], s[0:1], 96
    s_lshl_b32 s3, s2, 8
    v_add_u32 v1, s3, v0
    s_waitcnt lgkmcnt(0)

    s_mov_b32 s12, s4
    s_mov_b32 s13, s5
    s_mov_b32 s14, 0x200000
    s_mov_b32 s15, 0x20000
    s_mov_b32 s16, s6
    s_mov_b32 s17, s7
    s_mov_b32 s18, 0x2000
    s_mov_b32 s19, 0x20000
    s_mov_b32 s20, s8
    s_mov_b32 s21, s9
    s_mov_b32 s22, 0x400
    s_mov_b32 s23, 0x20000
    s_mov_b32 s24, s10
    s_mov_b32 s25, s11
    s_mov_b32 s26, 0x300000
    s_mov_b32 s27, 0x20000
    v_mov_b32 v4, -1
    v_mov_b32 v5, -1
    v_mov_b32 v6, -1
    v_mov_b32 v7, -1
    v_lshlrev_b32 v2, 4, v1
    v_add_u32 v3, 0x100000, v2
    buffer_store_dwordx4 v[4:7], v3, s[12:15], 0 offen
    v_add_u32 v3, 0x10000, v2
    v_cmp_gt_u32 vcc, 0x8000, v1
    s_mov_b64 s[28:29], vcc
    v_cmp_le_u32 vcc, 0x200, v1
    s_and_b64 vcc, vcc, s[28:29]
    s_and_saveexec_b64 s[30:31], vcc
    s_cbranch_execz prep_f1
    buffer_store_dwordx4 v[4:7], v3, s[12:15], 0 offen
    prep_f1:
    s_mov_b64 exec, s[30:31]
    v_mov_b32 v8, 0
    v_mov_b32 v9, 0
    v_mov_b32 v10, 0
    v_mov_b32 v11, 0
    v_add_u32 v3, 0x4000, v2
    v_cmp_gt_u32 vcc, 0x800, v1
    s_and_saveexec_b64 s[30:31], vcc
    s_cbranch_execz prep_f2
    buffer_store_dwordx4 v[8:11], v3, s[12:15], 0 offen
    prep_f2:
    s_mov_b64 exec, s[30:31]

    s_load_dwordx2 s[36:37], s[0:1], 40
    s_load_dwordx2 s[38:39], s[0:1], 80
    v_lshrrev_b32 v20, 6, v0
    v_and_b32 v21, 63, v0
    v_readfirstlane_b32 s33, v20
    s_lshl_b32 s34, s2, 2
    s_add_u32 s33, s33, s34
    v_and_b32 v25, 3, v21
    v_bfe_u32 v26, v21, 2, 1
    v_lshl_add_u32 v25, v26, 3, v25
    v_bfe_u32 v26, v21, 3, 1
    v_lshl_add_u32 v25, v26, 2, v25
    v_bfe_u32 v26, v21, 4, 1
    v_lshl_add_u32 v25, v26, 4, v25
    v_lshrrev_b32 v23, 5, v21
    v_lshlrev_b32 v23, 13, v23
    v_lshl_add_u32 v22, v25, 1, v23
    v_add_u32 v23, 0x1000, v22
    v_lshlrev_b32 v24, 4, v21
    s_waitcnt lgkmcnt(0)

    s_mov_b32 s40, s36
    s_mov_b32 s41, s37
    s_mov_b32 s42, 0x400000
    s_mov_b32 s43, 0x20000
    s_mov_b32 s44, s38
    s_mov_b32 s45, s39
    s_mov_b32 s46, 0x158000
    s_mov_b32 s47, 0x20000
    s_add_u32 s48, s4, 0x5a00000
    s_addc_u32 s49, s5, 0
    s_mov_b32 s50, 0x560000
    s_mov_b32 s51, 0x20000
    s_and_b32 s34, s33, 255
    s_lshl_b32 s34, s34, 14
    s_lshr_b32 s35, s33, 8
    s_lshl_b32 s35, s35, 7
    s_add_u32 s34, s34, s35
    s_add_u32 s35, s34, 512
    s_mul_hi_u32 s36, s33, 49941481
    s_mul_i32 s37, s36, 86
    s_sub_u32 s37, s33, s37
    s_lshl_b32 s37, s37, 14
    s_lshl_b32 s36, s36, 7
    s_add_u32 s36, s36, s37

    buffer_load_ushort v32, v22, s[40:43], s34 offen offset:0
    buffer_load_ushort v33, v22, s[40:43], s34 offen offset:1024
    buffer_load_ushort v34, v22, s[40:43], s34 offen offset:2048
    buffer_load_ushort v35, v22, s[40:43], s34 offen offset:3072
    buffer_load_ushort v36, v23, s[40:43], s34 offen offset:0
    buffer_load_ushort v37, v23, s[40:43], s34 offen offset:1024
    buffer_load_ushort v38, v23, s[40:43], s34 offen offset:2048
    buffer_load_ushort v39, v23, s[40:43], s34 offen offset:3072
    buffer_load_ushort v40, v22, s[40:43], s34 offen offset:64
    buffer_load_ushort v41, v22, s[40:43], s34 offen offset:1088
    buffer_load_ushort v42, v22, s[40:43], s34 offen offset:2112
    buffer_load_ushort v43, v22, s[40:43], s34 offen offset:3136
    buffer_load_ushort v44, v23, s[40:43], s34 offen offset:64
    buffer_load_ushort v45, v23, s[40:43], s34 offen offset:1088
    buffer_load_ushort v46, v23, s[40:43], s34 offen offset:2112
    buffer_load_ushort v47, v23, s[40:43], s34 offen offset:3136
    buffer_load_ushort v48, v22, s[40:43], s35 offen offset:0
    buffer_load_ushort v49, v22, s[40:43], s35 offen offset:1024
    buffer_load_ushort v50, v22, s[40:43], s35 offen offset:2048
    buffer_load_ushort v51, v22, s[40:43], s35 offen offset:3072
    buffer_load_ushort v52, v23, s[40:43], s35 offen offset:0
    buffer_load_ushort v53, v23, s[40:43], s35 offen offset:1024
    buffer_load_ushort v54, v23, s[40:43], s35 offen offset:2048
    buffer_load_ushort v55, v23, s[40:43], s35 offen offset:3072
    buffer_load_ushort v56, v22, s[40:43], s35 offen offset:64
    buffer_load_ushort v57, v22, s[40:43], s35 offen offset:1088
    buffer_load_ushort v58, v22, s[40:43], s35 offen offset:2112
    buffer_load_ushort v59, v22, s[40:43], s35 offen offset:3136
    buffer_load_ushort v60, v23, s[40:43], s35 offen offset:64
    buffer_load_ushort v61, v23, s[40:43], s35 offen offset:1088
    buffer_load_ushort v62, v23, s[40:43], s35 offen offset:2112
    buffer_load_ushort v63, v23, s[40:43], s35 offen offset:3136
    buffer_load_ushort v64, v22, s[44:47], s36 offen offset:0
    buffer_load_ushort v65, v22, s[44:47], s36 offen offset:1024
    buffer_load_ushort v66, v22, s[44:47], s36 offen offset:2048
    buffer_load_ushort v67, v22, s[44:47], s36 offen offset:3072
    buffer_load_ushort v68, v23, s[44:47], s36 offen offset:0
    buffer_load_ushort v69, v23, s[44:47], s36 offen offset:1024
    buffer_load_ushort v70, v23, s[44:47], s36 offen offset:2048
    buffer_load_ushort v71, v23, s[44:47], s36 offen offset:3072
    buffer_load_ushort v72, v22, s[44:47], s36 offen offset:64
    buffer_load_ushort v73, v22, s[44:47], s36 offen offset:1088
    buffer_load_ushort v74, v22, s[44:47], s36 offen offset:2112
    buffer_load_ushort v75, v22, s[44:47], s36 offen offset:3136
    buffer_load_ushort v76, v23, s[44:47], s36 offen offset:64
    buffer_load_ushort v77, v23, s[44:47], s36 offen offset:1088
    buffer_load_ushort v78, v23, s[44:47], s36 offen offset:2112
    buffer_load_ushort v79, v23, s[44:47], s36 offen offset:3136
    s_lshl_b32 s34, s33, 11
    s_waitcnt vmcnt(0)
    v_lshl_or_b32 v80, v33, 16, v32
    v_lshl_or_b32 v81, v35, 16, v34
    v_lshl_or_b32 v82, v37, 16, v36
    v_lshl_or_b32 v83, v39, 16, v38
    buffer_store_dwordx4 v[80:83], v24, s[48:51], s34 offen offset:0
    v_lshl_or_b32 v84, v41, 16, v40
    v_lshl_or_b32 v85, v43, 16, v42
    v_lshl_or_b32 v86, v45, 16, v44
    v_lshl_or_b32 v87, v47, 16, v46
    buffer_store_dwordx4 v[84:87], v24, s[48:51], s34 offen offset:1024
    s_add_u32 s34, s34, 0x200000
    s_nop 1
    v_lshl_or_b32 v80, v49, 16, v48
    v_lshl_or_b32 v81, v51, 16, v50
    v_lshl_or_b32 v82, v53, 16, v52
    v_lshl_or_b32 v83, v55, 16, v54
    buffer_store_dwordx4 v[80:83], v24, s[48:51], s34 offen offset:0
    v_lshl_or_b32 v84, v57, 16, v56
    v_lshl_or_b32 v85, v59, 16, v58
    v_lshl_or_b32 v86, v61, 16, v60
    v_lshl_or_b32 v87, v63, 16, v62
    buffer_store_dwordx4 v[84:87], v24, s[48:51], s34 offen offset:1024
    s_add_u32 s34, s34, 0x200000
    s_nop 1
    s_cmp_ge_u32 s33, 688
    s_cbranch_scc1 prep_pk
    v_lshl_or_b32 v80, v65, 16, v64
    v_lshl_or_b32 v81, v67, 16, v66
    v_lshl_or_b32 v82, v69, 16, v68
    v_lshl_or_b32 v83, v71, 16, v70
    buffer_store_dwordx4 v[80:83], v24, s[48:51], s34 offen offset:0
    v_lshl_or_b32 v84, v73, 16, v72
    v_lshl_or_b32 v85, v75, 16, v74
    v_lshl_or_b32 v86, v77, 16, v76
    v_lshl_or_b32 v87, v79, 16, v78
    buffer_store_dwordx4 v[84:87], v24, s[48:51], s34 offen offset:1024
    s_add_u32 s34, s34, 0x200000
    s_nop 1
prep_pk:
    s_cmp_ge_u32 s2, 8
    s_cbranch_scc1 prep_f3
    v_lshrrev_b32 v12, 6, v1
    v_bfe_u32 v13, v1, 3, 3
    v_and_b32 v14, 7, v1
    v_lshrrev_b32 v15, 1, v12
    v_lshlrev_b32 v15, 5, v15
    v_and_b32 v16, 1, v12
    v_add_u32 v15, v15, v16
    v_lshl_add_u32 v15, v14, 2, v15
    v_lshl_add_u32 v15, v13, 9, v15
    v_lshlrev_b32 v15, 1, v15
    buffer_load_ushort v17, v15, s[16:19], 0 offen
    buffer_load_ushort v18, v15, s[16:19], 0 offen offset:4
    v_lshlrev_b32 v19, 2, v1
    v_add_u32 v19, 0x10000, v19
    s_waitcnt vmcnt(0)
    v_lshl_or_b32 v17, v18, 16, v17
    buffer_store_dword v17, v19, s[12:15], 0 offen
    prep_f3:

    s_cmp_ge_u32 s2, 96
    s_cbranch_scc1 prep_done
    v_lshrrev_b32 v2, 4, v0
    v_and_b32 v3, 15, v0
    s_lshl_b32 s3, s2, 6
    v_lshlrev_b32 v4, 2, v3
    v_add_u32 v4, s3, v4
    s_mov_b32 s33, 196608
    v_mul_lo_u32 v5, v2, s33
    v_add_u32 v4, v4, v5

    s_mov_b32 s34, 0
    buffer_load_dword v32, v4, s[24:27], s34 offen
    s_mov_b32 s34, 6144
    buffer_load_dword v33, v4, s[24:27], s34 offen
    s_mov_b32 s34, 12288
    buffer_load_dword v34, v4, s[24:27], s34 offen
    s_mov_b32 s34, 18432
    buffer_load_dword v35, v4, s[24:27], s34 offen
    s_mov_b32 s34, 24576
    buffer_load_dword v36, v4, s[24:27], s34 offen
    s_mov_b32 s34, 30720
    buffer_load_dword v37, v4, s[24:27], s34 offen
    s_mov_b32 s34, 36864
    buffer_load_dword v38, v4, s[24:27], s34 offen
    s_mov_b32 s34, 43008
    buffer_load_dword v39, v4, s[24:27], s34 offen
    s_mov_b32 s34, 49152
    buffer_load_dword v40, v4, s[24:27], s34 offen
    s_mov_b32 s34, 55296
    buffer_load_dword v41, v4, s[24:27], s34 offen
    s_mov_b32 s34, 61440
    buffer_load_dword v42, v4, s[24:27], s34 offen
    s_mov_b32 s34, 67584
    buffer_load_dword v43, v4, s[24:27], s34 offen
    s_mov_b32 s34, 73728
    buffer_load_dword v44, v4, s[24:27], s34 offen
    s_mov_b32 s34, 79872
    buffer_load_dword v45, v4, s[24:27], s34 offen
    s_mov_b32 s34, 86016
    buffer_load_dword v46, v4, s[24:27], s34 offen
    s_mov_b32 s34, 92160
    buffer_load_dword v47, v4, s[24:27], s34 offen
    s_mov_b32 s34, 98304
    buffer_load_dword v48, v4, s[24:27], s34 offen
    s_mov_b32 s34, 104448
    buffer_load_dword v49, v4, s[24:27], s34 offen
    s_mov_b32 s34, 110592
    buffer_load_dword v50, v4, s[24:27], s34 offen
    s_mov_b32 s34, 116736
    buffer_load_dword v51, v4, s[24:27], s34 offen
    s_mov_b32 s34, 122880
    buffer_load_dword v52, v4, s[24:27], s34 offen
    s_mov_b32 s34, 129024
    buffer_load_dword v53, v4, s[24:27], s34 offen
    s_mov_b32 s34, 135168
    buffer_load_dword v54, v4, s[24:27], s34 offen
    s_mov_b32 s34, 141312
    buffer_load_dword v55, v4, s[24:27], s34 offen
    s_mov_b32 s34, 147456
    buffer_load_dword v56, v4, s[24:27], s34 offen
    s_mov_b32 s34, 153600
    buffer_load_dword v57, v4, s[24:27], s34 offen
    s_mov_b32 s34, 159744
    buffer_load_dword v58, v4, s[24:27], s34 offen
    s_mov_b32 s34, 165888
    buffer_load_dword v59, v4, s[24:27], s34 offen
    s_mov_b32 s34, 172032
    buffer_load_dword v60, v4, s[24:27], s34 offen
    s_mov_b32 s34, 178176
    buffer_load_dword v61, v4, s[24:27], s34 offen
    s_mov_b32 s34, 184320
    buffer_load_dword v62, v4, s[24:27], s34 offen
    s_mov_b32 s34, 190464
    buffer_load_dword v63, v4, s[24:27], s34 offen
    v_lshlrev_b32 v6, 6, v2
    buffer_load_dwordx4 v[64:67], v6, s[20:23], 0 offen offset:0
    buffer_load_dwordx4 v[68:71], v6, s[20:23], 0 offen offset:16
    buffer_load_dwordx4 v[72:75], v6, s[20:23], 0 offen offset:32
    buffer_load_dwordx4 v[76:79], v6, s[20:23], 0 offen offset:48
    s_waitcnt vmcnt(0)
    s_mov_b32 s35, 0xbfb8aa3b
    v_lshlrev_b32 v80, 16, v64
    v_and_b32 v81, 0xffff0000, v64
    v_lshlrev_b32 v82, 16, v65
    v_and_b32 v83, 0xffff0000, v65
    v_lshlrev_b32 v84, 16, v66
    v_and_b32 v85, 0xffff0000, v66
    v_lshlrev_b32 v86, 16, v67
    v_and_b32 v87, 0xffff0000, v67
    v_lshlrev_b32 v88, 16, v68
    v_and_b32 v89, 0xffff0000, v68
    v_lshlrev_b32 v90, 16, v69
    v_and_b32 v91, 0xffff0000, v69
    v_lshlrev_b32 v92, 16, v70
    v_and_b32 v93, 0xffff0000, v70
    v_lshlrev_b32 v94, 16, v71
    v_and_b32 v95, 0xffff0000, v71
    v_lshlrev_b32 v96, 16, v72
    v_and_b32 v97, 0xffff0000, v72
    v_lshlrev_b32 v98, 16, v73
    v_and_b32 v99, 0xffff0000, v73
    v_lshlrev_b32 v100, 16, v74
    v_and_b32 v101, 0xffff0000, v74
    v_lshlrev_b32 v102, 16, v75
    v_and_b32 v103, 0xffff0000, v75
    v_lshlrev_b32 v104, 16, v76
    v_and_b32 v105, 0xffff0000, v76
    v_lshlrev_b32 v106, 16, v77
    v_and_b32 v107, 0xffff0000, v77
    v_lshlrev_b32 v108, 16, v78
    v_and_b32 v109, 0xffff0000, v78
    v_lshlrev_b32 v110, 16, v79
    v_and_b32 v111, 0xffff0000, v79
    v_mul_f32 v112, s35, v80
    v_exp_f32 v112, v112
    s_nop 0
    v_add_f32 v112, 1.0, v112
    v_rcp_f32 v112, v112
    s_nop 0
    v_mul_f32 v80, v80, v112
    v_mul_f32 v113, s35, v81
    v_exp_f32 v113, v113
    s_nop 0
    v_add_f32 v113, 1.0, v113
    v_rcp_f32 v113, v113
    s_nop 0
    v_mul_f32 v81, v81, v113
    v_mul_f32 v114, s35, v82
    v_exp_f32 v114, v114
    s_nop 0
    v_add_f32 v114, 1.0, v114
    v_rcp_f32 v114, v114
    s_nop 0
    v_mul_f32 v82, v82, v114
    v_mul_f32 v115, s35, v83
    v_exp_f32 v115, v115
    s_nop 0
    v_add_f32 v115, 1.0, v115
    v_rcp_f32 v115, v115
    s_nop 0
    v_mul_f32 v83, v83, v115
    v_mul_f32 v116, s35, v84
    v_exp_f32 v116, v116
    s_nop 0
    v_add_f32 v116, 1.0, v116
    v_rcp_f32 v116, v116
    s_nop 0
    v_mul_f32 v84, v84, v116
    v_mul_f32 v117, s35, v85
    v_exp_f32 v117, v117
    s_nop 0
    v_add_f32 v117, 1.0, v117
    v_rcp_f32 v117, v117
    s_nop 0
    v_mul_f32 v85, v85, v117
    v_mul_f32 v118, s35, v86
    v_exp_f32 v118, v118
    s_nop 0
    v_add_f32 v118, 1.0, v118
    v_rcp_f32 v118, v118
    s_nop 0
    v_mul_f32 v86, v86, v118
    v_mul_f32 v119, s35, v87
    v_exp_f32 v119, v119
    s_nop 0
    v_add_f32 v119, 1.0, v119
    v_rcp_f32 v119, v119
    s_nop 0
    v_mul_f32 v87, v87, v119
    v_mul_f32 v112, s35, v88
    v_exp_f32 v112, v112
    s_nop 0
    v_add_f32 v112, 1.0, v112
    v_rcp_f32 v112, v112
    s_nop 0
    v_mul_f32 v88, v88, v112
    v_mul_f32 v113, s35, v89
    v_exp_f32 v113, v113
    s_nop 0
    v_add_f32 v113, 1.0, v113
    v_rcp_f32 v113, v113
    s_nop 0
    v_mul_f32 v89, v89, v113
    v_mul_f32 v114, s35, v90
    v_exp_f32 v114, v114
    s_nop 0
    v_add_f32 v114, 1.0, v114
    v_rcp_f32 v114, v114
    s_nop 0
    v_mul_f32 v90, v90, v114
    v_mul_f32 v115, s35, v91
    v_exp_f32 v115, v115
    s_nop 0
    v_add_f32 v115, 1.0, v115
    v_rcp_f32 v115, v115
    s_nop 0
    v_mul_f32 v91, v91, v115
    v_mul_f32 v116, s35, v92
    v_exp_f32 v116, v116
    s_nop 0
    v_add_f32 v116, 1.0, v116
    v_rcp_f32 v116, v116
    s_nop 0
    v_mul_f32 v92, v92, v116
    v_mul_f32 v117, s35, v93
    v_exp_f32 v117, v117
    s_nop 0
    v_add_f32 v117, 1.0, v117
    v_rcp_f32 v117, v117
    s_nop 0
    v_mul_f32 v93, v93, v117
    v_mul_f32 v118, s35, v94
    v_exp_f32 v118, v118
    s_nop 0
    v_add_f32 v118, 1.0, v118
    v_rcp_f32 v118, v118
    s_nop 0
    v_mul_f32 v94, v94, v118
    v_mul_f32 v119, s35, v95
    v_exp_f32 v119, v119
    s_nop 0
    v_add_f32 v119, 1.0, v119
    v_rcp_f32 v119, v119
    s_nop 0
    v_mul_f32 v95, v95, v119
    v_mul_f32 v112, s35, v96
    v_exp_f32 v112, v112
    s_nop 0
    v_add_f32 v112, 1.0, v112
    v_rcp_f32 v112, v112
    s_nop 0
    v_mul_f32 v96, v96, v112
    v_mul_f32 v113, s35, v97
    v_exp_f32 v113, v113
    s_nop 0
    v_add_f32 v113, 1.0, v113
    v_rcp_f32 v113, v113
    s_nop 0
    v_mul_f32 v97, v97, v113
    v_mul_f32 v114, s35, v98
    v_exp_f32 v114, v114
    s_nop 0
    v_add_f32 v114, 1.0, v114
    v_rcp_f32 v114, v114
    s_nop 0
    v_mul_f32 v98, v98, v114
    v_mul_f32 v115, s35, v99
    v_exp_f32 v115, v115
    s_nop 0
    v_add_f32 v115, 1.0, v115
    v_rcp_f32 v115, v115
    s_nop 0
    v_mul_f32 v99, v99, v115
    v_mul_f32 v116, s35, v100
    v_exp_f32 v116, v116
    s_nop 0
    v_add_f32 v116, 1.0, v116
    v_rcp_f32 v116, v116
    s_nop 0
    v_mul_f32 v100, v100, v116
    v_mul_f32 v117, s35, v101
    v_exp_f32 v117, v117
    s_nop 0
    v_add_f32 v117, 1.0, v117
    v_rcp_f32 v117, v117
    s_nop 0
    v_mul_f32 v101, v101, v117
    v_mul_f32 v118, s35, v102
    v_exp_f32 v118, v118
    s_nop 0
    v_add_f32 v118, 1.0, v118
    v_rcp_f32 v118, v118
    s_nop 0
    v_mul_f32 v102, v102, v118
    v_mul_f32 v119, s35, v103
    v_exp_f32 v119, v119
    s_nop 0
    v_add_f32 v119, 1.0, v119
    v_rcp_f32 v119, v119
    s_nop 0
    v_mul_f32 v103, v103, v119
    v_mul_f32 v112, s35, v104
    v_exp_f32 v112, v112
    s_nop 0
    v_add_f32 v112, 1.0, v112
    v_rcp_f32 v112, v112
    s_nop 0
    v_mul_f32 v104, v104, v112
    v_mul_f32 v113, s35, v105
    v_exp_f32 v113, v113
    s_nop 0
    v_add_f32 v113, 1.0, v113
    v_rcp_f32 v113, v113
    s_nop 0
    v_mul_f32 v105, v105, v113
    v_mul_f32 v114, s35, v106
    v_exp_f32 v114, v114
    s_nop 0
    v_add_f32 v114, 1.0, v114
    v_rcp_f32 v114, v114
    s_nop 0
    v_mul_f32 v106, v106, v114
    v_mul_f32 v115, s35, v107
    v_exp_f32 v115, v115
    s_nop 0
    v_add_f32 v115, 1.0, v115
    v_rcp_f32 v115, v115
    s_nop 0
    v_mul_f32 v107, v107, v115
    v_mul_f32 v116, s35, v108
    v_exp_f32 v116, v116
    s_nop 0
    v_add_f32 v116, 1.0, v116
    v_rcp_f32 v116, v116
    s_nop 0
    v_mul_f32 v108, v108, v116
    v_mul_f32 v117, s35, v109
    v_exp_f32 v117, v117
    s_nop 0
    v_add_f32 v117, 1.0, v117
    v_rcp_f32 v117, v117
    s_nop 0
    v_mul_f32 v109, v109, v117
    v_mul_f32 v118, s35, v110
    v_exp_f32 v118, v118
    s_nop 0
    v_add_f32 v118, 1.0, v118
    v_rcp_f32 v118, v118
    s_nop 0
    v_mul_f32 v110, v110, v118
    v_mul_f32 v119, s35, v111
    v_exp_f32 v119, v119
    s_nop 0
    v_add_f32 v119, 1.0, v119
    v_rcp_f32 v119, v119
    s_nop 0
    v_mul_f32 v111, v111, v119
    v_cvt_pk_bf16_f32 v112, v80, v81
    v_lshlrev_b32 v80, 16, v112
    v_and_b32 v81, 0xffff0000, v112
    v_cvt_pk_bf16_f32 v112, v82, v83
    v_lshlrev_b32 v82, 16, v112
    v_and_b32 v83, 0xffff0000, v112
    v_cvt_pk_bf16_f32 v112, v84, v85
    v_lshlrev_b32 v84, 16, v112
    v_and_b32 v85, 0xffff0000, v112
    v_cvt_pk_bf16_f32 v112, v86, v87
    v_lshlrev_b32 v86, 16, v112
    v_and_b32 v87, 0xffff0000, v112
    v_cvt_pk_bf16_f32 v112, v88, v89
    v_lshlrev_b32 v88, 16, v112
    v_and_b32 v89, 0xffff0000, v112
    v_cvt_pk_bf16_f32 v112, v90, v91
    v_lshlrev_b32 v90, 16, v112
    v_and_b32 v91, 0xffff0000, v112
    v_cvt_pk_bf16_f32 v112, v92, v93
    v_lshlrev_b32 v92, 16, v112
    v_and_b32 v93, 0xffff0000, v112
    v_cvt_pk_bf16_f32 v112, v94, v95
    v_lshlrev_b32 v94, 16, v112
    v_and_b32 v95, 0xffff0000, v112
    v_cvt_pk_bf16_f32 v112, v96, v97
    v_lshlrev_b32 v96, 16, v112
    v_and_b32 v97, 0xffff0000, v112
    v_cvt_pk_bf16_f32 v112, v98, v99
    v_lshlrev_b32 v98, 16, v112
    v_and_b32 v99, 0xffff0000, v112
    v_cvt_pk_bf16_f32 v112, v100, v101
    v_lshlrev_b32 v100, 16, v112
    v_and_b32 v101, 0xffff0000, v112
    v_cvt_pk_bf16_f32 v112, v102, v103
    v_lshlrev_b32 v102, 16, v112
    v_and_b32 v103, 0xffff0000, v112
    v_cvt_pk_bf16_f32 v112, v104, v105
    v_lshlrev_b32 v104, 16, v112
    v_and_b32 v105, 0xffff0000, v112
    v_cvt_pk_bf16_f32 v112, v106, v107
    v_lshlrev_b32 v106, 16, v112
    v_and_b32 v107, 0xffff0000, v112
    v_cvt_pk_bf16_f32 v112, v108, v109
    v_lshlrev_b32 v108, 16, v112
    v_and_b32 v109, 0xffff0000, v112
    v_cvt_pk_bf16_f32 v112, v110, v111
    v_lshlrev_b32 v110, 16, v112
    v_and_b32 v111, 0xffff0000, v112
    v_mov_b32 v8, 0
    v_mov_b32 v9, 0
    v_lshlrev_b32 v112, 16, v32
    v_and_b32 v113, 0xffff0000, v32
    v_fma_f32 v8, v112, v80, v8
    v_fma_f32 v9, v113, v80, v9
    v_lshlrev_b32 v112, 16, v33
    v_and_b32 v113, 0xffff0000, v33
    v_fma_f32 v8, v112, v81, v8
    v_fma_f32 v9, v113, v81, v9
    v_lshlrev_b32 v112, 16, v34
    v_and_b32 v113, 0xffff0000, v34
    v_fma_f32 v8, v112, v82, v8
    v_fma_f32 v9, v113, v82, v9
    v_lshlrev_b32 v112, 16, v35
    v_and_b32 v113, 0xffff0000, v35
    v_fma_f32 v8, v112, v83, v8
    v_fma_f32 v9, v113, v83, v9
    v_lshlrev_b32 v112, 16, v36
    v_and_b32 v113, 0xffff0000, v36
    v_fma_f32 v8, v112, v84, v8
    v_fma_f32 v9, v113, v84, v9
    v_lshlrev_b32 v112, 16, v37
    v_and_b32 v113, 0xffff0000, v37
    v_fma_f32 v8, v112, v85, v8
    v_fma_f32 v9, v113, v85, v9
    v_lshlrev_b32 v112, 16, v38
    v_and_b32 v113, 0xffff0000, v38
    v_fma_f32 v8, v112, v86, v8
    v_fma_f32 v9, v113, v86, v9
    v_lshlrev_b32 v112, 16, v39
    v_and_b32 v113, 0xffff0000, v39
    v_fma_f32 v8, v112, v87, v8
    v_fma_f32 v9, v113, v87, v9
    v_lshlrev_b32 v112, 16, v40
    v_and_b32 v113, 0xffff0000, v40
    v_fma_f32 v8, v112, v88, v8
    v_fma_f32 v9, v113, v88, v9
    v_lshlrev_b32 v112, 16, v41
    v_and_b32 v113, 0xffff0000, v41
    v_fma_f32 v8, v112, v89, v8
    v_fma_f32 v9, v113, v89, v9
    v_lshlrev_b32 v112, 16, v42
    v_and_b32 v113, 0xffff0000, v42
    v_fma_f32 v8, v112, v90, v8
    v_fma_f32 v9, v113, v90, v9
    v_lshlrev_b32 v112, 16, v43
    v_and_b32 v113, 0xffff0000, v43
    v_fma_f32 v8, v112, v91, v8
    v_fma_f32 v9, v113, v91, v9
    v_lshlrev_b32 v112, 16, v44
    v_and_b32 v113, 0xffff0000, v44
    v_fma_f32 v8, v112, v92, v8
    v_fma_f32 v9, v113, v92, v9
    v_lshlrev_b32 v112, 16, v45
    v_and_b32 v113, 0xffff0000, v45
    v_fma_f32 v8, v112, v93, v8
    v_fma_f32 v9, v113, v93, v9
    v_lshlrev_b32 v112, 16, v46
    v_and_b32 v113, 0xffff0000, v46
    v_fma_f32 v8, v112, v94, v8
    v_fma_f32 v9, v113, v94, v9
    v_lshlrev_b32 v112, 16, v47
    v_and_b32 v113, 0xffff0000, v47
    v_fma_f32 v8, v112, v95, v8
    v_fma_f32 v9, v113, v95, v9
    v_lshlrev_b32 v112, 16, v48
    v_and_b32 v113, 0xffff0000, v48
    v_fma_f32 v8, v112, v96, v8
    v_fma_f32 v9, v113, v96, v9
    v_lshlrev_b32 v112, 16, v49
    v_and_b32 v113, 0xffff0000, v49
    v_fma_f32 v8, v112, v97, v8
    v_fma_f32 v9, v113, v97, v9
    v_lshlrev_b32 v112, 16, v50
    v_and_b32 v113, 0xffff0000, v50
    v_fma_f32 v8, v112, v98, v8
    v_fma_f32 v9, v113, v98, v9
    v_lshlrev_b32 v112, 16, v51
    v_and_b32 v113, 0xffff0000, v51
    v_fma_f32 v8, v112, v99, v8
    v_fma_f32 v9, v113, v99, v9
    v_lshlrev_b32 v112, 16, v52
    v_and_b32 v113, 0xffff0000, v52
    v_fma_f32 v8, v112, v100, v8
    v_fma_f32 v9, v113, v100, v9
    v_lshlrev_b32 v112, 16, v53
    v_and_b32 v113, 0xffff0000, v53
    v_fma_f32 v8, v112, v101, v8
    v_fma_f32 v9, v113, v101, v9
    v_lshlrev_b32 v112, 16, v54
    v_and_b32 v113, 0xffff0000, v54
    v_fma_f32 v8, v112, v102, v8
    v_fma_f32 v9, v113, v102, v9
    v_lshlrev_b32 v112, 16, v55
    v_and_b32 v113, 0xffff0000, v55
    v_fma_f32 v8, v112, v103, v8
    v_fma_f32 v9, v113, v103, v9
    v_lshlrev_b32 v112, 16, v56
    v_and_b32 v113, 0xffff0000, v56
    v_fma_f32 v8, v112, v104, v8
    v_fma_f32 v9, v113, v104, v9
    v_lshlrev_b32 v112, 16, v57
    v_and_b32 v113, 0xffff0000, v57
    v_fma_f32 v8, v112, v105, v8
    v_fma_f32 v9, v113, v105, v9
    v_lshlrev_b32 v112, 16, v58
    v_and_b32 v113, 0xffff0000, v58
    v_fma_f32 v8, v112, v106, v8
    v_fma_f32 v9, v113, v106, v9
    v_lshlrev_b32 v112, 16, v59
    v_and_b32 v113, 0xffff0000, v59
    v_fma_f32 v8, v112, v107, v8
    v_fma_f32 v9, v113, v107, v9
    v_lshlrev_b32 v112, 16, v60
    v_and_b32 v113, 0xffff0000, v60
    v_fma_f32 v8, v112, v108, v8
    v_fma_f32 v9, v113, v108, v9
    v_lshlrev_b32 v112, 16, v61
    v_and_b32 v113, 0xffff0000, v61
    v_fma_f32 v8, v112, v109, v8
    v_fma_f32 v9, v113, v109, v9
    v_lshlrev_b32 v112, 16, v62
    v_and_b32 v113, 0xffff0000, v62
    v_fma_f32 v8, v112, v110, v8
    v_fma_f32 v9, v113, v110, v9
    v_lshlrev_b32 v112, 16, v63
    v_and_b32 v113, 0xffff0000, v63
    v_fma_f32 v8, v112, v111, v8
    v_fma_f32 v9, v113, v111, v9
    v_lshlrev_b32 v10, 3, v0
    ds_write_b64 v10, v[8:9]
    s_waitcnt lgkmcnt(0)
    s_barrier
    v_cmp_gt_u32 vcc, 32, v0
    s_and_saveexec_b64 s[30:31], vcc
    s_cbranch_execz prep_done
    v_lshlrev_b32 v10, 2, v0

    ds_read_b32 v32, v10 offset:0
    ds_read_b32 v33, v10 offset:128
    ds_read_b32 v34, v10 offset:256
    ds_read_b32 v35, v10 offset:384
    ds_read_b32 v36, v10 offset:512
    ds_read_b32 v37, v10 offset:640
    ds_read_b32 v38, v10 offset:768
    ds_read_b32 v39, v10 offset:896
    ds_read_b32 v40, v10 offset:1024
    ds_read_b32 v41, v10 offset:1152
    ds_read_b32 v42, v10 offset:1280
    ds_read_b32 v43, v10 offset:1408
    ds_read_b32 v44, v10 offset:1536
    ds_read_b32 v45, v10 offset:1664
    ds_read_b32 v46, v10 offset:1792
    ds_read_b32 v47, v10 offset:1920
    s_waitcnt lgkmcnt(0)
    v_add_f32 v32, v32, v33
    v_add_f32 v32, v32, v34
    v_add_f32 v32, v32, v35
    v_add_f32 v32, v32, v36
    v_add_f32 v32, v32, v37
    v_add_f32 v32, v32, v38
    v_add_f32 v32, v32, v39
    v_add_f32 v32, v32, v40
    v_add_f32 v32, v32, v41
    v_add_f32 v32, v32, v42
    v_add_f32 v32, v32, v43
    v_add_f32 v32, v32, v44
    v_add_f32 v32, v32, v45
    v_add_f32 v32, v32, v46
    v_add_f32 v32, v32, v47
    v_cvt_pk_bf16_f32 v32, v32, v32
    v_lshlrev_b32 v32, 16, v32
    s_lshr_b32 s36, s2, 4
    s_cmp_eq_u32 s36, 1
    s_cselect_b32 s37, 1, 0
    s_cmp_eq_u32 s36, 4
    s_cselect_b32 s37, 1, s37
    s_cmp_eq_u32 s37, 0
    s_cbranch_scc1 prep_m1
    v_add_f32 v32, 1.0, v32
    v_cvt_pk_bf16_f32 v32, v32, v32
    v_lshlrev_b32 v32, 16, v32
    prep_m1:
    s_lshl_b32 s3, s2, 7
    v_lshl_add_u32 v10, v0, 2, s3
    buffer_store_dword v32, v10, s[12:15], 0 offen
    prep_done:
    s_endpgm

.globl main_kernel
.p2align 8
.type main_kernel,@function
main_kernel:
    s_cmp_ge_u32 s2, 256
    s_cbranch_scc1 main_done
    s_load_dwordx2 s[4:5], s[0:1], 120
    s_and_b32 s3, s2, 7
    s_mov_b32 s98, 0
    s_mov_b32 s97, s3
    s_lshr_b32 s96, s2, 3
    s_lshr_b32 s29, s2, 3
    s_sub_u32 s38, s2, s29
    s_sub_u32 s38, s38, 1
    s_waitcnt lgkmcnt(0)
    s_cmp_eq_u32 s3, 0
    s_cbranch_scc1 main_chain
    s_mov_b32 s68, s38

    s_sub_u32 s69, s2, 1
    s_cmp_ge_u32 s38, 192
    s_cbranch_scc1 main_f1
    s_mov_b32 s31, 0

    s_lshr_b32 s35, s38, 2
    s_and_b32 s28, s38, 3
    s_lshr_b32 s36, s35, 4
    s_and_b32 s37, s35, 15
    s_load_dwordx2 s[12:13], s[0:1], 24
    s_load_dwordx2 s[62:63], s[0:1], 32
    s_load_dwordx2 s[64:65], s[0:1], 16
    s_load_dwordx2 s[14:15], s[0:1], 0
    s_mov_b32 s41, 0x2000000
    s_cmp_eq_u32 s36, 1
    s_cselect_b32 s41, 0x3000000, s41
    s_cselect_b32 s32, 1, 0
    s_cmp_eq_u32 s36, 2
    s_cselect_b32 s41, 0x1000000, s41
    s_add_u32 s20, s4, s41
    s_addc_u32 s21, s5, 0
    s_mov_b32 s22, 0x1000000
    s_mov_b32 s23, 0x20000
    s_waitcnt lgkmcnt(0)
    s_cmp_eq_u32 s36, 1
    s_cselect_b32 s12, s62, s12
    s_cselect_b32 s13, s63, s13
    s_cmp_eq_u32 s36, 2
    s_cselect_b32 s12, s64, s12
    s_cselect_b32 s13, s65, s13

    s_mov_b32 s8, s12
    s_mov_b32 s9, s13
    s_mov_b32 s10, 0x400000
    s_mov_b32 s11, 0x20000
    s_mov_b32 s16, s14
    s_mov_b32 s17, s15
    s_mov_b32 s18, 0x200000
    s_mov_b32 s19, 0x20000
    s_mov_b32 s24, s4
    s_mov_b32 s25, s5
    s_mov_b32 s26, 0x10000
    s_mov_b32 s27, 0x20000
    v_lshrrev_b32 v1, 6, v0
    s_nop 0
    v_readfirstlane_b32 s40, v1
    s_mov_b32 s29, 4
    s_mov_b32 s30, 64
    s_mov_b32 s31, 0
    s_lshl_b32 s34, s38, 7
    s_add_u32 s34, s34, 0x4000

    v_and_b32 v1, 63, v0
    v_lshlrev_b32 v3, 4, v1
    s_lshl_b32 s41, s40, 13
    v_add_u32 v3, s41, v3
    v_add_u32 v4, 0x1000, v3
    s_mul_i32 s41, s40, 8320
    v_lshlrev_b32 v5, 4, v1
    v_add_u32 v5, s41, v5
    v_and_b32 v9, 31, v1
    v_lshrrev_b32 v10, 5, v1
    v_mul_u32_u24 v6, 1040, v9
    v_lshl_add_u32 v6, v10, 4, v6
    v_lshlrev_b32 v11, 5, v1
    v_add_u32 v11, 0, v11
    buffer_load_dwordx4 v[136:139], v11, s[24:27], 0 offen
    buffer_load_dwordx4 v[140:143], v11, s[24:27], 0 offen offset:16
    buffer_load_dwordx4 v[128:131], v11, s[24:27], 0 offen offset:2048
    buffer_load_dwordx4 v[132:135], v11, s[24:27], 0 offen offset:2064
    s_mov_b32 s42, 0x05040100
    s_mov_b32 s43, 0x07060302
    s_mov_b32 s44, 0xffff0000

    s_lshl_b32 s41, s37, 9
    s_lshl_b32 s35, s40, 7
    s_add_u32 s41, s41, s35
    v_lshlrev_b32 v2, 16, v10
    v_lshl_add_u32 v2, v9, 2, v2
    v_add_u32 v2, s41, v2

    s_lshr_b32 s35, s40, 1
    s_lshl_b32 s33, s37, 1
    s_add_u32 s33, s33, s35
    s_lshl_b32 s33, s33, 13
    s_and_b32 s35, s40, 1
    s_lshl_b32 s41, s35, 11
    s_lshl_b32 s35, s35, 12
    s_cmp_eq_u32 s32, 1
    s_cselect_b32 s41, s35, s41
    s_add_u32 s33, s33, s41
    v_and_b32 v12, 15, v1
    v_bfe_u32 v13, v1, 4, 1
    v_lshlrev_b32 v7, 4, v12
    v_lshl_add_u32 v7, v10, 8, v7
    v_lshl_add_u32 v8, v13, 11, v7
    v_lshl_add_u32 v7, v13, 12, v7

    s_mov_b32 s41, 0
    buffer_load_dword v48, v2, s[8:11], s41 offen
    s_mov_b32 s41, 8192
    buffer_load_dword v49, v2, s[8:11], s41 offen
    s_mov_b32 s41, 16384
    buffer_load_dword v50, v2, s[8:11], s41 offen
    s_mov_b32 s41, 24576
    buffer_load_dword v51, v2, s[8:11], s41 offen
    s_mov_b32 s41, 32768
    buffer_load_dword v52, v2, s[8:11], s41 offen
    s_mov_b32 s41, 40960
    buffer_load_dword v53, v2, s[8:11], s41 offen
    s_mov_b32 s41, 49152
    buffer_load_dword v54, v2, s[8:11], s41 offen
    s_mov_b32 s41, 57344
    buffer_load_dword v55, v2, s[8:11], s41 offen
    s_mov_b32 s41, 131072
    buffer_load_dword v56, v2, s[8:11], s41 offen
    s_mov_b32 s41, 139264
    buffer_load_dword v57, v2, s[8:11], s41 offen
    s_mov_b32 s41, 147456
    buffer_load_dword v58, v2, s[8:11], s41 offen
    s_mov_b32 s41, 155648
    buffer_load_dword v59, v2, s[8:11], s41 offen
    s_mov_b32 s41, 163840
    buffer_load_dword v60, v2, s[8:11], s41 offen
    s_mov_b32 s41, 172032
    buffer_load_dword v61, v2, s[8:11], s41 offen
    s_mov_b32 s41, 180224
    buffer_load_dword v62, v2, s[8:11], s41 offen
    s_mov_b32 s41, 188416
    buffer_load_dword v63, v2, s[8:11], s41 offen
    s_mov_b32 s41, 262144
    buffer_load_dword v64, v2, s[8:11], s41 offen
    s_mov_b32 s41, 270336
    buffer_load_dword v65, v2, s[8:11], s41 offen
    s_mov_b32 s41, 278528
    buffer_load_dword v66, v2, s[8:11], s41 offen
    s_mov_b32 s41, 286720
    buffer_load_dword v67, v2, s[8:11], s41 offen
    s_mov_b32 s41, 294912
    buffer_load_dword v68, v2, s[8:11], s41 offen
    s_mov_b32 s41, 303104
    buffer_load_dword v69, v2, s[8:11], s41 offen
    s_mov_b32 s41, 311296
    buffer_load_dword v70, v2, s[8:11], s41 offen
    s_mov_b32 s41, 319488
    buffer_load_dword v71, v2, s[8:11], s41 offen
    s_mov_b32 s41, 393216
    buffer_load_dword v72, v2, s[8:11], s41 offen
    s_mov_b32 s41, 401408
    buffer_load_dword v73, v2, s[8:11], s41 offen
    s_mov_b32 s41, 409600
    buffer_load_dword v74, v2, s[8:11], s41 offen
    s_mov_b32 s41, 417792
    buffer_load_dword v75, v2, s[8:11], s41 offen
    s_mov_b32 s41, 425984
    buffer_load_dword v76, v2, s[8:11], s41 offen
    s_mov_b32 s41, 434176
    buffer_load_dword v77, v2, s[8:11], s41 offen
    s_mov_b32 s41, 442368
    buffer_load_dword v78, v2, s[8:11], s41 offen
    s_mov_b32 s41, 450560
    buffer_load_dword v79, v2, s[8:11], s41 offen
    s_mov_b32 s41, 524288
    buffer_load_dword v80, v2, s[8:11], s41 offen
    s_mov_b32 s41, 532480
    buffer_load_dword v81, v2, s[8:11], s41 offen
    s_mov_b32 s41, 540672
    buffer_load_dword v82, v2, s[8:11], s41 offen
    s_mov_b32 s41, 548864
    buffer_load_dword v83, v2, s[8:11], s41 offen
    s_mov_b32 s41, 557056
    buffer_load_dword v84, v2, s[8:11], s41 offen
    s_mov_b32 s41, 565248
    buffer_load_dword v85, v2, s[8:11], s41 offen
    s_mov_b32 s41, 573440
    buffer_load_dword v86, v2, s[8:11], s41 offen
    s_mov_b32 s41, 581632
    buffer_load_dword v87, v2, s[8:11], s41 offen
    s_mov_b32 s41, 655360
    buffer_load_dword v88, v2, s[8:11], s41 offen
    s_mov_b32 s41, 663552
    buffer_load_dword v89, v2, s[8:11], s41 offen
    s_mov_b32 s41, 671744
    buffer_load_dword v90, v2, s[8:11], s41 offen
    s_mov_b32 s41, 679936
    buffer_load_dword v91, v2, s[8:11], s41 offen
    s_mov_b32 s41, 688128
    buffer_load_dword v92, v2, s[8:11], s41 offen
    s_mov_b32 s41, 696320
    buffer_load_dword v93, v2, s[8:11], s41 offen
    s_mov_b32 s41, 704512
    buffer_load_dword v94, v2, s[8:11], s41 offen
    s_mov_b32 s41, 712704
    buffer_load_dword v95, v2, s[8:11], s41 offen
    s_mov_b32 s41, 786432
    buffer_load_dword v96, v2, s[8:11], s41 offen
    s_mov_b32 s41, 794624
    buffer_load_dword v97, v2, s[8:11], s41 offen
    s_mov_b32 s41, 802816
    buffer_load_dword v98, v2, s[8:11], s41 offen
    s_mov_b32 s41, 811008
    buffer_load_dword v99, v2, s[8:11], s41 offen
    s_mov_b32 s41, 819200
    buffer_load_dword v100, v2, s[8:11], s41 offen
    s_mov_b32 s41, 827392
    buffer_load_dword v101, v2, s[8:11], s41 offen
    s_mov_b32 s41, 835584
    buffer_load_dword v102, v2, s[8:11], s41 offen
    s_mov_b32 s41, 843776
    buffer_load_dword v103, v2, s[8:11], s41 offen
    s_mov_b32 s41, 917504
    buffer_load_dword v104, v2, s[8:11], s41 offen
    s_mov_b32 s41, 925696
    buffer_load_dword v105, v2, s[8:11], s41 offen
    s_mov_b32 s41, 933888
    buffer_load_dword v106, v2, s[8:11], s41 offen
    s_mov_b32 s41, 942080
    buffer_load_dword v107, v2, s[8:11], s41 offen
    s_mov_b32 s41, 950272
    buffer_load_dword v108, v2, s[8:11], s41 offen
    s_mov_b32 s41, 958464
    buffer_load_dword v109, v2, s[8:11], s41 offen
    s_mov_b32 s41, 966656
    buffer_load_dword v110, v2, s[8:11], s41 offen
    s_mov_b32 s41, 974848
    buffer_load_dword v111, v2, s[8:11], s41 offen
    s_waitcnt vmcnt(32)
    v_perm_b32 v112, v49, v48, s42
    v_perm_b32 v116, v49, v48, s43
    v_perm_b32 v113, v51, v50, s42
    v_perm_b32 v117, v51, v50, s43
    v_perm_b32 v114, v53, v52, s42
    v_perm_b32 v118, v53, v52, s43
    v_perm_b32 v115, v55, v54, s42
    v_perm_b32 v119, v55, v54, s43
    v_accvgpr_write_b32 a0, v112
    v_accvgpr_write_b32 a128, v116
    v_accvgpr_write_b32 a1, v113
    v_accvgpr_write_b32 a129, v117
    v_accvgpr_write_b32 a2, v114
    v_accvgpr_write_b32 a130, v118
    v_accvgpr_write_b32 a3, v115
    v_accvgpr_write_b32 a131, v119
    v_perm_b32 v112, v57, v56, s42
    v_perm_b32 v116, v57, v56, s43
    v_perm_b32 v113, v59, v58, s42
    v_perm_b32 v117, v59, v58, s43
    v_perm_b32 v114, v61, v60, s42
    v_perm_b32 v118, v61, v60, s43
    v_perm_b32 v115, v63, v62, s42
    v_perm_b32 v119, v63, v62, s43
    v_accvgpr_write_b32 a4, v112
    v_accvgpr_write_b32 a132, v116
    v_accvgpr_write_b32 a5, v113
    v_accvgpr_write_b32 a133, v117
    v_accvgpr_write_b32 a6, v114
    v_accvgpr_write_b32 a134, v118
    v_accvgpr_write_b32 a7, v115
    v_accvgpr_write_b32 a135, v119
    v_perm_b32 v112, v65, v64, s42
    v_perm_b32 v116, v65, v64, s43
    v_perm_b32 v113, v67, v66, s42
    v_perm_b32 v117, v67, v66, s43
    v_perm_b32 v114, v69, v68, s42
    v_perm_b32 v118, v69, v68, s43
    v_perm_b32 v115, v71, v70, s42
    v_perm_b32 v119, v71, v70, s43
    v_accvgpr_write_b32 a8, v112
    v_accvgpr_write_b32 a136, v116
    v_accvgpr_write_b32 a9, v113
    v_accvgpr_write_b32 a137, v117
    v_accvgpr_write_b32 a10, v114
    v_accvgpr_write_b32 a138, v118
    v_accvgpr_write_b32 a11, v115
    v_accvgpr_write_b32 a139, v119
    v_perm_b32 v112, v73, v72, s42
    v_perm_b32 v116, v73, v72, s43
    v_perm_b32 v113, v75, v74, s42
    v_perm_b32 v117, v75, v74, s43
    v_perm_b32 v114, v77, v76, s42
    v_perm_b32 v118, v77, v76, s43
    v_perm_b32 v115, v79, v78, s42
    v_perm_b32 v119, v79, v78, s43
    v_accvgpr_write_b32 a12, v112
    v_accvgpr_write_b32 a140, v116
    v_accvgpr_write_b32 a13, v113
    v_accvgpr_write_b32 a141, v117
    v_accvgpr_write_b32 a14, v114
    v_accvgpr_write_b32 a142, v118
    v_accvgpr_write_b32 a15, v115
    v_accvgpr_write_b32 a143, v119
    s_mov_b32 s41, 1048576
    buffer_load_dword v48, v2, s[8:11], s41 offen
    s_mov_b32 s41, 1056768
    buffer_load_dword v49, v2, s[8:11], s41 offen
    s_mov_b32 s41, 1064960
    buffer_load_dword v50, v2, s[8:11], s41 offen
    s_mov_b32 s41, 1073152
    buffer_load_dword v51, v2, s[8:11], s41 offen
    s_mov_b32 s41, 1081344
    buffer_load_dword v52, v2, s[8:11], s41 offen
    s_mov_b32 s41, 1089536
    buffer_load_dword v53, v2, s[8:11], s41 offen
    s_mov_b32 s41, 1097728
    buffer_load_dword v54, v2, s[8:11], s41 offen
    s_mov_b32 s41, 1105920
    buffer_load_dword v55, v2, s[8:11], s41 offen
    s_mov_b32 s41, 1179648
    buffer_load_dword v56, v2, s[8:11], s41 offen
    s_mov_b32 s41, 1187840
    buffer_load_dword v57, v2, s[8:11], s41 offen
    s_mov_b32 s41, 1196032
    buffer_load_dword v58, v2, s[8:11], s41 offen
    s_mov_b32 s41, 1204224
    buffer_load_dword v59, v2, s[8:11], s41 offen
    s_mov_b32 s41, 1212416
    buffer_load_dword v60, v2, s[8:11], s41 offen
    s_mov_b32 s41, 1220608
    buffer_load_dword v61, v2, s[8:11], s41 offen
    s_mov_b32 s41, 1228800
    buffer_load_dword v62, v2, s[8:11], s41 offen
    s_mov_b32 s41, 1236992
    buffer_load_dword v63, v2, s[8:11], s41 offen
    s_mov_b32 s41, 1310720
    buffer_load_dword v64, v2, s[8:11], s41 offen
    s_mov_b32 s41, 1318912
    buffer_load_dword v65, v2, s[8:11], s41 offen
    s_mov_b32 s41, 1327104
    buffer_load_dword v66, v2, s[8:11], s41 offen
    s_mov_b32 s41, 1335296
    buffer_load_dword v67, v2, s[8:11], s41 offen
    s_mov_b32 s41, 1343488
    buffer_load_dword v68, v2, s[8:11], s41 offen
    s_mov_b32 s41, 1351680
    buffer_load_dword v69, v2, s[8:11], s41 offen
    s_mov_b32 s41, 1359872
    buffer_load_dword v70, v2, s[8:11], s41 offen
    s_mov_b32 s41, 1368064
    buffer_load_dword v71, v2, s[8:11], s41 offen
    s_mov_b32 s41, 1441792
    buffer_load_dword v72, v2, s[8:11], s41 offen
    s_mov_b32 s41, 1449984
    buffer_load_dword v73, v2, s[8:11], s41 offen
    s_mov_b32 s41, 1458176
    buffer_load_dword v74, v2, s[8:11], s41 offen
    s_mov_b32 s41, 1466368
    buffer_load_dword v75, v2, s[8:11], s41 offen
    s_mov_b32 s41, 1474560
    buffer_load_dword v76, v2, s[8:11], s41 offen
    s_mov_b32 s41, 1482752
    buffer_load_dword v77, v2, s[8:11], s41 offen
    s_mov_b32 s41, 1490944
    buffer_load_dword v78, v2, s[8:11], s41 offen
    s_mov_b32 s41, 1499136
    buffer_load_dword v79, v2, s[8:11], s41 offen
    s_waitcnt vmcnt(32)
    v_perm_b32 v112, v81, v80, s42
    v_perm_b32 v116, v81, v80, s43
    v_perm_b32 v113, v83, v82, s42
    v_perm_b32 v117, v83, v82, s43
    v_perm_b32 v114, v85, v84, s42
    v_perm_b32 v118, v85, v84, s43
    v_perm_b32 v115, v87, v86, s42
    v_perm_b32 v119, v87, v86, s43
    v_accvgpr_write_b32 a16, v112
    v_accvgpr_write_b32 a144, v116
    v_accvgpr_write_b32 a17, v113
    v_accvgpr_write_b32 a145, v117
    v_accvgpr_write_b32 a18, v114
    v_accvgpr_write_b32 a146, v118
    v_accvgpr_write_b32 a19, v115
    v_accvgpr_write_b32 a147, v119
    v_perm_b32 v112, v89, v88, s42
    v_perm_b32 v116, v89, v88, s43
    v_perm_b32 v113, v91, v90, s42
    v_perm_b32 v117, v91, v90, s43
    v_perm_b32 v114, v93, v92, s42
    v_perm_b32 v118, v93, v92, s43
    v_perm_b32 v115, v95, v94, s42
    v_perm_b32 v119, v95, v94, s43
    v_accvgpr_write_b32 a20, v112
    v_accvgpr_write_b32 a148, v116
    v_accvgpr_write_b32 a21, v113
    v_accvgpr_write_b32 a149, v117
    v_accvgpr_write_b32 a22, v114
    v_accvgpr_write_b32 a150, v118
    v_accvgpr_write_b32 a23, v115
    v_accvgpr_write_b32 a151, v119
    v_perm_b32 v112, v97, v96, s42
    v_perm_b32 v116, v97, v96, s43
    v_perm_b32 v113, v99, v98, s42
    v_perm_b32 v117, v99, v98, s43
    v_perm_b32 v114, v101, v100, s42
    v_perm_b32 v118, v101, v100, s43
    v_perm_b32 v115, v103, v102, s42
    v_perm_b32 v119, v103, v102, s43
    v_accvgpr_write_b32 a24, v112
    v_accvgpr_write_b32 a152, v116
    v_accvgpr_write_b32 a25, v113
    v_accvgpr_write_b32 a153, v117
    v_accvgpr_write_b32 a26, v114
    v_accvgpr_write_b32 a154, v118
    v_accvgpr_write_b32 a27, v115
    v_accvgpr_write_b32 a155, v119
    v_perm_b32 v112, v105, v104, s42
    v_perm_b32 v116, v105, v104, s43
    v_perm_b32 v113, v107, v106, s42
    v_perm_b32 v117, v107, v106, s43
    v_perm_b32 v114, v109, v108, s42
    v_perm_b32 v118, v109, v108, s43
    v_perm_b32 v115, v111, v110, s42
    v_perm_b32 v119, v111, v110, s43
    v_accvgpr_write_b32 a28, v112
    v_accvgpr_write_b32 a156, v116
    v_accvgpr_write_b32 a29, v113
    v_accvgpr_write_b32 a157, v117
    v_accvgpr_write_b32 a30, v114
    v_accvgpr_write_b32 a158, v118
    v_accvgpr_write_b32 a31, v115
    v_accvgpr_write_b32 a159, v119
    s_mov_b32 s41, 1572864
    buffer_load_dword v80, v2, s[8:11], s41 offen
    s_mov_b32 s41, 1581056
    buffer_load_dword v81, v2, s[8:11], s41 offen
    s_mov_b32 s41, 1589248
    buffer_load_dword v82, v2, s[8:11], s41 offen
    s_mov_b32 s41, 1597440
    buffer_load_dword v83, v2, s[8:11], s41 offen
    s_mov_b32 s41, 1605632
    buffer_load_dword v84, v2, s[8:11], s41 offen
    s_mov_b32 s41, 1613824
    buffer_load_dword v85, v2, s[8:11], s41 offen
    s_mov_b32 s41, 1622016
    buffer_load_dword v86, v2, s[8:11], s41 offen
    s_mov_b32 s41, 1630208
    buffer_load_dword v87, v2, s[8:11], s41 offen
    s_mov_b32 s41, 1703936
    buffer_load_dword v88, v2, s[8:11], s41 offen
    s_mov_b32 s41, 1712128
    buffer_load_dword v89, v2, s[8:11], s41 offen
    s_mov_b32 s41, 1720320
    buffer_load_dword v90, v2, s[8:11], s41 offen
    s_mov_b32 s41, 1728512
    buffer_load_dword v91, v2, s[8:11], s41 offen
    s_mov_b32 s41, 1736704
    buffer_load_dword v92, v2, s[8:11], s41 offen
    s_mov_b32 s41, 1744896
    buffer_load_dword v93, v2, s[8:11], s41 offen
    s_mov_b32 s41, 1753088
    buffer_load_dword v94, v2, s[8:11], s41 offen
    s_mov_b32 s41, 1761280
    buffer_load_dword v95, v2, s[8:11], s41 offen
    s_mov_b32 s41, 1835008
    buffer_load_dword v96, v2, s[8:11], s41 offen
    s_mov_b32 s41, 1843200
    buffer_load_dword v97, v2, s[8:11], s41 offen
    s_mov_b32 s41, 1851392
    buffer_load_dword v98, v2, s[8:11], s41 offen
    s_mov_b32 s41, 1859584
    buffer_load_dword v99, v2, s[8:11], s41 offen
    s_mov_b32 s41, 1867776
    buffer_load_dword v100, v2, s[8:11], s41 offen
    s_mov_b32 s41, 1875968
    buffer_load_dword v101, v2, s[8:11], s41 offen
    s_mov_b32 s41, 1884160
    buffer_load_dword v102, v2, s[8:11], s41 offen
    s_mov_b32 s41, 1892352
    buffer_load_dword v103, v2, s[8:11], s41 offen
    s_mov_b32 s41, 1966080
    buffer_load_dword v104, v2, s[8:11], s41 offen
    s_mov_b32 s41, 1974272
    buffer_load_dword v105, v2, s[8:11], s41 offen
    s_mov_b32 s41, 1982464
    buffer_load_dword v106, v2, s[8:11], s41 offen
    s_mov_b32 s41, 1990656
    buffer_load_dword v107, v2, s[8:11], s41 offen
    s_mov_b32 s41, 1998848
    buffer_load_dword v108, v2, s[8:11], s41 offen
    s_mov_b32 s41, 2007040
    buffer_load_dword v109, v2, s[8:11], s41 offen
    s_mov_b32 s41, 2015232
    buffer_load_dword v110, v2, s[8:11], s41 offen
    s_mov_b32 s41, 2023424
    buffer_load_dword v111, v2, s[8:11], s41 offen
    s_waitcnt vmcnt(32)
    v_perm_b32 v112, v49, v48, s42
    v_perm_b32 v116, v49, v48, s43
    v_perm_b32 v113, v51, v50, s42
    v_perm_b32 v117, v51, v50, s43
    v_perm_b32 v114, v53, v52, s42
    v_perm_b32 v118, v53, v52, s43
    v_perm_b32 v115, v55, v54, s42
    v_perm_b32 v119, v55, v54, s43
    v_accvgpr_write_b32 a32, v112
    v_accvgpr_write_b32 a160, v116
    v_accvgpr_write_b32 a33, v113
    v_accvgpr_write_b32 a161, v117
    v_accvgpr_write_b32 a34, v114
    v_accvgpr_write_b32 a162, v118
    v_accvgpr_write_b32 a35, v115
    v_accvgpr_write_b32 a163, v119
    v_perm_b32 v112, v57, v56, s42
    v_perm_b32 v116, v57, v56, s43
    v_perm_b32 v113, v59, v58, s42
    v_perm_b32 v117, v59, v58, s43
    v_perm_b32 v114, v61, v60, s42
    v_perm_b32 v118, v61, v60, s43
    v_perm_b32 v115, v63, v62, s42
    v_perm_b32 v119, v63, v62, s43
    v_accvgpr_write_b32 a36, v112
    v_accvgpr_write_b32 a164, v116
    v_accvgpr_write_b32 a37, v113
    v_accvgpr_write_b32 a165, v117
    v_accvgpr_write_b32 a38, v114
    v_accvgpr_write_b32 a166, v118
    v_accvgpr_write_b32 a39, v115
    v_accvgpr_write_b32 a167, v119
    v_perm_b32 v112, v65, v64, s42
    v_perm_b32 v116, v65, v64, s43
    v_perm_b32 v113, v67, v66, s42
    v_perm_b32 v117, v67, v66, s43
    v_perm_b32 v114, v69, v68, s42
    v_perm_b32 v118, v69, v68, s43
    v_perm_b32 v115, v71, v70, s42
    v_perm_b32 v119, v71, v70, s43
    v_accvgpr_write_b32 a40, v112
    v_accvgpr_write_b32 a168, v116
    v_accvgpr_write_b32 a41, v113
    v_accvgpr_write_b32 a169, v117
    v_accvgpr_write_b32 a42, v114
    v_accvgpr_write_b32 a170, v118
    v_accvgpr_write_b32 a43, v115
    v_accvgpr_write_b32 a171, v119
    v_perm_b32 v112, v73, v72, s42
    v_perm_b32 v116, v73, v72, s43
    v_perm_b32 v113, v75, v74, s42
    v_perm_b32 v117, v75, v74, s43
    v_perm_b32 v114, v77, v76, s42
    v_perm_b32 v118, v77, v76, s43
    v_perm_b32 v115, v79, v78, s42
    v_perm_b32 v119, v79, v78, s43
    v_accvgpr_write_b32 a44, v112
    v_accvgpr_write_b32 a172, v116
    v_accvgpr_write_b32 a45, v113
    v_accvgpr_write_b32 a173, v117
    v_accvgpr_write_b32 a46, v114
    v_accvgpr_write_b32 a174, v118
    v_accvgpr_write_b32 a47, v115
    v_accvgpr_write_b32 a175, v119
    s_mov_b32 s41, 2097152
    buffer_load_dword v48, v2, s[8:11], s41 offen
    s_mov_b32 s41, 2105344
    buffer_load_dword v49, v2, s[8:11], s41 offen
    s_mov_b32 s41, 2113536
    buffer_load_dword v50, v2, s[8:11], s41 offen
    s_mov_b32 s41, 2121728
    buffer_load_dword v51, v2, s[8:11], s41 offen
    s_mov_b32 s41, 2129920
    buffer_load_dword v52, v2, s[8:11], s41 offen
    s_mov_b32 s41, 2138112
    buffer_load_dword v53, v2, s[8:11], s41 offen
    s_mov_b32 s41, 2146304
    buffer_load_dword v54, v2, s[8:11], s41 offen
    s_mov_b32 s41, 2154496
    buffer_load_dword v55, v2, s[8:11], s41 offen
    s_mov_b32 s41, 2228224
    buffer_load_dword v56, v2, s[8:11], s41 offen
    s_mov_b32 s41, 2236416
    buffer_load_dword v57, v2, s[8:11], s41 offen
    s_mov_b32 s41, 2244608
    buffer_load_dword v58, v2, s[8:11], s41 offen
    s_mov_b32 s41, 2252800
    buffer_load_dword v59, v2, s[8:11], s41 offen
    s_mov_b32 s41, 2260992
    buffer_load_dword v60, v2, s[8:11], s41 offen
    s_mov_b32 s41, 2269184
    buffer_load_dword v61, v2, s[8:11], s41 offen
    s_mov_b32 s41, 2277376
    buffer_load_dword v62, v2, s[8:11], s41 offen
    s_mov_b32 s41, 2285568
    buffer_load_dword v63, v2, s[8:11], s41 offen
    s_mov_b32 s41, 2359296
    buffer_load_dword v64, v2, s[8:11], s41 offen
    s_mov_b32 s41, 2367488
    buffer_load_dword v65, v2, s[8:11], s41 offen
    s_mov_b32 s41, 2375680
    buffer_load_dword v66, v2, s[8:11], s41 offen
    s_mov_b32 s41, 2383872
    buffer_load_dword v67, v2, s[8:11], s41 offen
    s_mov_b32 s41, 2392064
    buffer_load_dword v68, v2, s[8:11], s41 offen
    s_mov_b32 s41, 2400256
    buffer_load_dword v69, v2, s[8:11], s41 offen
    s_mov_b32 s41, 2408448
    buffer_load_dword v70, v2, s[8:11], s41 offen
    s_mov_b32 s41, 2416640
    buffer_load_dword v71, v2, s[8:11], s41 offen
    s_mov_b32 s41, 2490368
    buffer_load_dword v72, v2, s[8:11], s41 offen
    s_mov_b32 s41, 2498560
    buffer_load_dword v73, v2, s[8:11], s41 offen
    s_mov_b32 s41, 2506752
    buffer_load_dword v74, v2, s[8:11], s41 offen
    s_mov_b32 s41, 2514944
    buffer_load_dword v75, v2, s[8:11], s41 offen
    s_mov_b32 s41, 2523136
    buffer_load_dword v76, v2, s[8:11], s41 offen
    s_mov_b32 s41, 2531328
    buffer_load_dword v77, v2, s[8:11], s41 offen
    s_mov_b32 s41, 2539520
    buffer_load_dword v78, v2, s[8:11], s41 offen
    s_mov_b32 s41, 2547712
    buffer_load_dword v79, v2, s[8:11], s41 offen
    s_waitcnt vmcnt(32)
    v_perm_b32 v112, v81, v80, s42
    v_perm_b32 v116, v81, v80, s43
    v_perm_b32 v113, v83, v82, s42
    v_perm_b32 v117, v83, v82, s43
    v_perm_b32 v114, v85, v84, s42
    v_perm_b32 v118, v85, v84, s43
    v_perm_b32 v115, v87, v86, s42
    v_perm_b32 v119, v87, v86, s43
    v_accvgpr_write_b32 a48, v112
    v_accvgpr_write_b32 a176, v116
    v_accvgpr_write_b32 a49, v113
    v_accvgpr_write_b32 a177, v117
    v_accvgpr_write_b32 a50, v114
    v_accvgpr_write_b32 a178, v118
    v_accvgpr_write_b32 a51, v115
    v_accvgpr_write_b32 a179, v119
    v_perm_b32 v112, v89, v88, s42
    v_perm_b32 v116, v89, v88, s43
    v_perm_b32 v113, v91, v90, s42
    v_perm_b32 v117, v91, v90, s43
    v_perm_b32 v114, v93, v92, s42
    v_perm_b32 v118, v93, v92, s43
    v_perm_b32 v115, v95, v94, s42
    v_perm_b32 v119, v95, v94, s43
    v_accvgpr_write_b32 a52, v112
    v_accvgpr_write_b32 a180, v116
    v_accvgpr_write_b32 a53, v113
    v_accvgpr_write_b32 a181, v117
    v_accvgpr_write_b32 a54, v114
    v_accvgpr_write_b32 a182, v118
    v_accvgpr_write_b32 a55, v115
    v_accvgpr_write_b32 a183, v119
    v_perm_b32 v112, v97, v96, s42
    v_perm_b32 v116, v97, v96, s43
    v_perm_b32 v113, v99, v98, s42
    v_perm_b32 v117, v99, v98, s43
    v_perm_b32 v114, v101, v100, s42
    v_perm_b32 v118, v101, v100, s43
    v_perm_b32 v115, v103, v102, s42
    v_perm_b32 v119, v103, v102, s43
    v_accvgpr_write_b32 a56, v112
    v_accvgpr_write_b32 a184, v116
    v_accvgpr_write_b32 a57, v113
    v_accvgpr_write_b32 a185, v117
    v_accvgpr_write_b32 a58, v114
    v_accvgpr_write_b32 a186, v118
    v_accvgpr_write_b32 a59, v115
    v_accvgpr_write_b32 a187, v119
    v_perm_b32 v112, v105, v104, s42
    v_perm_b32 v116, v105, v104, s43
    v_perm_b32 v113, v107, v106, s42
    v_perm_b32 v117, v107, v106, s43
    v_perm_b32 v114, v109, v108, s42
    v_perm_b32 v118, v109, v108, s43
    v_perm_b32 v115, v111, v110, s42
    v_perm_b32 v119, v111, v110, s43
    v_accvgpr_write_b32 a60, v112
    v_accvgpr_write_b32 a188, v116
    v_accvgpr_write_b32 a61, v113
    v_accvgpr_write_b32 a189, v117
    v_accvgpr_write_b32 a62, v114
    v_accvgpr_write_b32 a190, v118
    v_accvgpr_write_b32 a63, v115
    v_accvgpr_write_b32 a191, v119
    s_mov_b32 s41, 2621440
    buffer_load_dword v80, v2, s[8:11], s41 offen
    s_mov_b32 s41, 2629632
    buffer_load_dword v81, v2, s[8:11], s41 offen
    s_mov_b32 s41, 2637824
    buffer_load_dword v82, v2, s[8:11], s41 offen
    s_mov_b32 s41, 2646016
    buffer_load_dword v83, v2, s[8:11], s41 offen
    s_mov_b32 s41, 2654208
    buffer_load_dword v84, v2, s[8:11], s41 offen
    s_mov_b32 s41, 2662400
    buffer_load_dword v85, v2, s[8:11], s41 offen
    s_mov_b32 s41, 2670592
    buffer_load_dword v86, v2, s[8:11], s41 offen
    s_mov_b32 s41, 2678784
    buffer_load_dword v87, v2, s[8:11], s41 offen
    s_mov_b32 s41, 2752512
    buffer_load_dword v88, v2, s[8:11], s41 offen
    s_mov_b32 s41, 2760704
    buffer_load_dword v89, v2, s[8:11], s41 offen
    s_mov_b32 s41, 2768896
    buffer_load_dword v90, v2, s[8:11], s41 offen
    s_mov_b32 s41, 2777088
    buffer_load_dword v91, v2, s[8:11], s41 offen
    s_mov_b32 s41, 2785280
    buffer_load_dword v92, v2, s[8:11], s41 offen
    s_mov_b32 s41, 2793472
    buffer_load_dword v93, v2, s[8:11], s41 offen
    s_mov_b32 s41, 2801664
    buffer_load_dword v94, v2, s[8:11], s41 offen
    s_mov_b32 s41, 2809856
    buffer_load_dword v95, v2, s[8:11], s41 offen
    s_mov_b32 s41, 2883584
    buffer_load_dword v96, v2, s[8:11], s41 offen
    s_mov_b32 s41, 2891776
    buffer_load_dword v97, v2, s[8:11], s41 offen
    s_mov_b32 s41, 2899968
    buffer_load_dword v98, v2, s[8:11], s41 offen
    s_mov_b32 s41, 2908160
    buffer_load_dword v99, v2, s[8:11], s41 offen
    s_mov_b32 s41, 2916352
    buffer_load_dword v100, v2, s[8:11], s41 offen
    s_mov_b32 s41, 2924544
    buffer_load_dword v101, v2, s[8:11], s41 offen
    s_mov_b32 s41, 2932736
    buffer_load_dword v102, v2, s[8:11], s41 offen
    s_mov_b32 s41, 2940928
    buffer_load_dword v103, v2, s[8:11], s41 offen
    s_mov_b32 s41, 3014656
    buffer_load_dword v104, v2, s[8:11], s41 offen
    s_mov_b32 s41, 3022848
    buffer_load_dword v105, v2, s[8:11], s41 offen
    s_mov_b32 s41, 3031040
    buffer_load_dword v106, v2, s[8:11], s41 offen
    s_mov_b32 s41, 3039232
    buffer_load_dword v107, v2, s[8:11], s41 offen
    s_mov_b32 s41, 3047424
    buffer_load_dword v108, v2, s[8:11], s41 offen
    s_mov_b32 s41, 3055616
    buffer_load_dword v109, v2, s[8:11], s41 offen
    s_mov_b32 s41, 3063808
    buffer_load_dword v110, v2, s[8:11], s41 offen
    s_mov_b32 s41, 3072000
    buffer_load_dword v111, v2, s[8:11], s41 offen
    s_waitcnt vmcnt(32)
    v_perm_b32 v112, v49, v48, s42
    v_perm_b32 v116, v49, v48, s43
    v_perm_b32 v113, v51, v50, s42
    v_perm_b32 v117, v51, v50, s43
    v_perm_b32 v114, v53, v52, s42
    v_perm_b32 v118, v53, v52, s43
    v_perm_b32 v115, v55, v54, s42
    v_perm_b32 v119, v55, v54, s43
    v_accvgpr_write_b32 a64, v112
    v_accvgpr_write_b32 a192, v116
    v_accvgpr_write_b32 a65, v113
    v_accvgpr_write_b32 a193, v117
    v_accvgpr_write_b32 a66, v114
    v_accvgpr_write_b32 a194, v118
    v_accvgpr_write_b32 a67, v115
    v_accvgpr_write_b32 a195, v119
    v_perm_b32 v112, v57, v56, s42
    v_perm_b32 v116, v57, v56, s43
    v_perm_b32 v113, v59, v58, s42
    v_perm_b32 v117, v59, v58, s43
    v_perm_b32 v114, v61, v60, s42
    v_perm_b32 v118, v61, v60, s43
    v_perm_b32 v115, v63, v62, s42
    v_perm_b32 v119, v63, v62, s43
    v_accvgpr_write_b32 a68, v112
    v_accvgpr_write_b32 a196, v116
    v_accvgpr_write_b32 a69, v113
    v_accvgpr_write_b32 a197, v117
    v_accvgpr_write_b32 a70, v114
    v_accvgpr_write_b32 a198, v118
    v_accvgpr_write_b32 a71, v115
    v_accvgpr_write_b32 a199, v119
    v_perm_b32 v112, v65, v64, s42
    v_perm_b32 v116, v65, v64, s43
    v_perm_b32 v113, v67, v66, s42
    v_perm_b32 v117, v67, v66, s43
    v_perm_b32 v114, v69, v68, s42
    v_perm_b32 v118, v69, v68, s43
    v_perm_b32 v115, v71, v70, s42
    v_perm_b32 v119, v71, v70, s43
    v_accvgpr_write_b32 a72, v112
    v_accvgpr_write_b32 a200, v116
    v_accvgpr_write_b32 a73, v113
    v_accvgpr_write_b32 a201, v117
    v_accvgpr_write_b32 a74, v114
    v_accvgpr_write_b32 a202, v118
    v_accvgpr_write_b32 a75, v115
    v_accvgpr_write_b32 a203, v119
    v_perm_b32 v112, v73, v72, s42
    v_perm_b32 v116, v73, v72, s43
    v_perm_b32 v113, v75, v74, s42
    v_perm_b32 v117, v75, v74, s43
    v_perm_b32 v114, v77, v76, s42
    v_perm_b32 v118, v77, v76, s43
    v_perm_b32 v115, v79, v78, s42
    v_perm_b32 v119, v79, v78, s43
    v_accvgpr_write_b32 a76, v112
    v_accvgpr_write_b32 a204, v116
    v_accvgpr_write_b32 a77, v113
    v_accvgpr_write_b32 a205, v117
    v_accvgpr_write_b32 a78, v114
    v_accvgpr_write_b32 a206, v118
    v_accvgpr_write_b32 a79, v115
    v_accvgpr_write_b32 a207, v119
    s_mov_b32 s41, 3145728
    buffer_load_dword v48, v2, s[8:11], s41 offen
    s_mov_b32 s41, 3153920
    buffer_load_dword v49, v2, s[8:11], s41 offen
    s_mov_b32 s41, 3162112
    buffer_load_dword v50, v2, s[8:11], s41 offen
    s_mov_b32 s41, 3170304
    buffer_load_dword v51, v2, s[8:11], s41 offen
    s_mov_b32 s41, 3178496
    buffer_load_dword v52, v2, s[8:11], s41 offen
    s_mov_b32 s41, 3186688
    buffer_load_dword v53, v2, s[8:11], s41 offen
    s_mov_b32 s41, 3194880
    buffer_load_dword v54, v2, s[8:11], s41 offen
    s_mov_b32 s41, 3203072
    buffer_load_dword v55, v2, s[8:11], s41 offen
    s_mov_b32 s41, 3276800
    buffer_load_dword v56, v2, s[8:11], s41 offen
    s_mov_b32 s41, 3284992
    buffer_load_dword v57, v2, s[8:11], s41 offen
    s_mov_b32 s41, 3293184
    buffer_load_dword v58, v2, s[8:11], s41 offen
    s_mov_b32 s41, 3301376
    buffer_load_dword v59, v2, s[8:11], s41 offen
    s_mov_b32 s41, 3309568
    buffer_load_dword v60, v2, s[8:11], s41 offen
    s_mov_b32 s41, 3317760
    buffer_load_dword v61, v2, s[8:11], s41 offen
    s_mov_b32 s41, 3325952
    buffer_load_dword v62, v2, s[8:11], s41 offen
    s_mov_b32 s41, 3334144
    buffer_load_dword v63, v2, s[8:11], s41 offen
    s_mov_b32 s41, 3407872
    buffer_load_dword v64, v2, s[8:11], s41 offen
    s_mov_b32 s41, 3416064
    buffer_load_dword v65, v2, s[8:11], s41 offen
    s_mov_b32 s41, 3424256
    buffer_load_dword v66, v2, s[8:11], s41 offen
    s_mov_b32 s41, 3432448
    buffer_load_dword v67, v2, s[8:11], s41 offen
    s_mov_b32 s41, 3440640
    buffer_load_dword v68, v2, s[8:11], s41 offen
    s_mov_b32 s41, 3448832
    buffer_load_dword v69, v2, s[8:11], s41 offen
    s_mov_b32 s41, 3457024
    buffer_load_dword v70, v2, s[8:11], s41 offen
    s_mov_b32 s41, 3465216
    buffer_load_dword v71, v2, s[8:11], s41 offen
    s_mov_b32 s41, 3538944
    buffer_load_dword v72, v2, s[8:11], s41 offen
    s_mov_b32 s41, 3547136
    buffer_load_dword v73, v2, s[8:11], s41 offen
    s_mov_b32 s41, 3555328
    buffer_load_dword v74, v2, s[8:11], s41 offen
    s_mov_b32 s41, 3563520
    buffer_load_dword v75, v2, s[8:11], s41 offen
    s_mov_b32 s41, 3571712
    buffer_load_dword v76, v2, s[8:11], s41 offen
    s_mov_b32 s41, 3579904
    buffer_load_dword v77, v2, s[8:11], s41 offen
    s_mov_b32 s41, 3588096
    buffer_load_dword v78, v2, s[8:11], s41 offen
    s_mov_b32 s41, 3596288
    buffer_load_dword v79, v2, s[8:11], s41 offen
    s_waitcnt vmcnt(32)
    v_perm_b32 v112, v81, v80, s42
    v_perm_b32 v116, v81, v80, s43
    v_perm_b32 v113, v83, v82, s42
    v_perm_b32 v117, v83, v82, s43
    v_perm_b32 v114, v85, v84, s42
    v_perm_b32 v118, v85, v84, s43
    v_perm_b32 v115, v87, v86, s42
    v_perm_b32 v119, v87, v86, s43
    v_accvgpr_write_b32 a80, v112
    v_accvgpr_write_b32 a208, v116
    v_accvgpr_write_b32 a81, v113
    v_accvgpr_write_b32 a209, v117
    v_accvgpr_write_b32 a82, v114
    v_accvgpr_write_b32 a210, v118
    v_accvgpr_write_b32 a83, v115
    v_accvgpr_write_b32 a211, v119
    v_perm_b32 v112, v89, v88, s42
    v_perm_b32 v116, v89, v88, s43
    v_perm_b32 v113, v91, v90, s42
    v_perm_b32 v117, v91, v90, s43
    v_perm_b32 v114, v93, v92, s42
    v_perm_b32 v118, v93, v92, s43
    v_perm_b32 v115, v95, v94, s42
    v_perm_b32 v119, v95, v94, s43
    v_accvgpr_write_b32 a84, v112
    v_accvgpr_write_b32 a212, v116
    v_accvgpr_write_b32 a85, v113
    v_accvgpr_write_b32 a213, v117
    v_accvgpr_write_b32 a86, v114
    v_accvgpr_write_b32 a214, v118
    v_accvgpr_write_b32 a87, v115
    v_accvgpr_write_b32 a215, v119
    v_perm_b32 v112, v97, v96, s42
    v_perm_b32 v116, v97, v96, s43
    v_perm_b32 v113, v99, v98, s42
    v_perm_b32 v117, v99, v98, s43
    v_perm_b32 v114, v101, v100, s42
    v_perm_b32 v118, v101, v100, s43
    v_perm_b32 v115, v103, v102, s42
    v_perm_b32 v119, v103, v102, s43
    v_accvgpr_write_b32 a88, v112
    v_accvgpr_write_b32 a216, v116
    v_accvgpr_write_b32 a89, v113
    v_accvgpr_write_b32 a217, v117
    v_accvgpr_write_b32 a90, v114
    v_accvgpr_write_b32 a218, v118
    v_accvgpr_write_b32 a91, v115
    v_accvgpr_write_b32 a219, v119
    v_perm_b32 v112, v105, v104, s42
    v_perm_b32 v116, v105, v104, s43
    v_perm_b32 v113, v107, v106, s42
    v_perm_b32 v117, v107, v106, s43
    v_perm_b32 v114, v109, v108, s42
    v_perm_b32 v118, v109, v108, s43
    v_perm_b32 v115, v111, v110, s42
    v_perm_b32 v119, v111, v110, s43
    v_accvgpr_write_b32 a92, v112
    v_accvgpr_write_b32 a220, v116
    v_accvgpr_write_b32 a93, v113
    v_accvgpr_write_b32 a221, v117
    v_accvgpr_write_b32 a94, v114
    v_accvgpr_write_b32 a222, v118
    v_accvgpr_write_b32 a95, v115
    v_accvgpr_write_b32 a223, v119
    s_mov_b32 s41, 3670016
    buffer_load_dword v80, v2, s[8:11], s41 offen
    s_mov_b32 s41, 3678208
    buffer_load_dword v81, v2, s[8:11], s41 offen
    s_mov_b32 s41, 3686400
    buffer_load_dword v82, v2, s[8:11], s41 offen
    s_mov_b32 s41, 3694592
    buffer_load_dword v83, v2, s[8:11], s41 offen
    s_mov_b32 s41, 3702784
    buffer_load_dword v84, v2, s[8:11], s41 offen
    s_mov_b32 s41, 3710976
    buffer_load_dword v85, v2, s[8:11], s41 offen
    s_mov_b32 s41, 3719168
    buffer_load_dword v86, v2, s[8:11], s41 offen
    s_mov_b32 s41, 3727360
    buffer_load_dword v87, v2, s[8:11], s41 offen
    s_mov_b32 s41, 3801088
    buffer_load_dword v88, v2, s[8:11], s41 offen
    s_mov_b32 s41, 3809280
    buffer_load_dword v89, v2, s[8:11], s41 offen
    s_mov_b32 s41, 3817472
    buffer_load_dword v90, v2, s[8:11], s41 offen
    s_mov_b32 s41, 3825664
    buffer_load_dword v91, v2, s[8:11], s41 offen
    s_mov_b32 s41, 3833856
    buffer_load_dword v92, v2, s[8:11], s41 offen
    s_mov_b32 s41, 3842048
    buffer_load_dword v93, v2, s[8:11], s41 offen
    s_mov_b32 s41, 3850240
    buffer_load_dword v94, v2, s[8:11], s41 offen
    s_mov_b32 s41, 3858432
    buffer_load_dword v95, v2, s[8:11], s41 offen
    s_mov_b32 s41, 3932160
    buffer_load_dword v96, v2, s[8:11], s41 offen
    s_mov_b32 s41, 3940352
    buffer_load_dword v97, v2, s[8:11], s41 offen
    s_mov_b32 s41, 3948544
    buffer_load_dword v98, v2, s[8:11], s41 offen
    s_mov_b32 s41, 3956736
    buffer_load_dword v99, v2, s[8:11], s41 offen
    s_mov_b32 s41, 3964928
    buffer_load_dword v100, v2, s[8:11], s41 offen
    s_mov_b32 s41, 3973120
    buffer_load_dword v101, v2, s[8:11], s41 offen
    s_mov_b32 s41, 3981312
    buffer_load_dword v102, v2, s[8:11], s41 offen
    s_mov_b32 s41, 3989504
    buffer_load_dword v103, v2, s[8:11], s41 offen
    s_mov_b32 s41, 4063232
    buffer_load_dword v104, v2, s[8:11], s41 offen
    s_mov_b32 s41, 4071424
    buffer_load_dword v105, v2, s[8:11], s41 offen
    s_mov_b32 s41, 4079616
    buffer_load_dword v106, v2, s[8:11], s41 offen
    s_mov_b32 s41, 4087808
    buffer_load_dword v107, v2, s[8:11], s41 offen
    s_mov_b32 s41, 4096000
    buffer_load_dword v108, v2, s[8:11], s41 offen
    s_mov_b32 s41, 4104192
    buffer_load_dword v109, v2, s[8:11], s41 offen
    s_mov_b32 s41, 4112384
    buffer_load_dword v110, v2, s[8:11], s41 offen
    s_mov_b32 s41, 4120576
    buffer_load_dword v111, v2, s[8:11], s41 offen
    s_waitcnt vmcnt(32)
    v_perm_b32 v112, v49, v48, s42
    v_perm_b32 v116, v49, v48, s43
    v_perm_b32 v113, v51, v50, s42
    v_perm_b32 v117, v51, v50, s43
    v_perm_b32 v114, v53, v52, s42
    v_perm_b32 v118, v53, v52, s43
    v_perm_b32 v115, v55, v54, s42
    v_perm_b32 v119, v55, v54, s43
    v_accvgpr_write_b32 a96, v112
    v_accvgpr_write_b32 a224, v116
    v_accvgpr_write_b32 a97, v113
    v_accvgpr_write_b32 a225, v117
    v_accvgpr_write_b32 a98, v114
    v_accvgpr_write_b32 a226, v118
    v_accvgpr_write_b32 a99, v115
    v_accvgpr_write_b32 a227, v119
    v_perm_b32 v112, v57, v56, s42
    v_perm_b32 v116, v57, v56, s43
    v_perm_b32 v113, v59, v58, s42
    v_perm_b32 v117, v59, v58, s43
    v_perm_b32 v114, v61, v60, s42
    v_perm_b32 v118, v61, v60, s43
    v_perm_b32 v115, v63, v62, s42
    v_perm_b32 v119, v63, v62, s43
    v_accvgpr_write_b32 a100, v112
    v_accvgpr_write_b32 a228, v116
    v_accvgpr_write_b32 a101, v113
    v_accvgpr_write_b32 a229, v117
    v_accvgpr_write_b32 a102, v114
    v_accvgpr_write_b32 a230, v118
    v_accvgpr_write_b32 a103, v115
    v_accvgpr_write_b32 a231, v119
    v_perm_b32 v112, v65, v64, s42
    v_perm_b32 v116, v65, v64, s43
    v_perm_b32 v113, v67, v66, s42
    v_perm_b32 v117, v67, v66, s43
    v_perm_b32 v114, v69, v68, s42
    v_perm_b32 v118, v69, v68, s43
    v_perm_b32 v115, v71, v70, s42
    v_perm_b32 v119, v71, v70, s43
    v_accvgpr_write_b32 a104, v112
    v_accvgpr_write_b32 a232, v116
    v_accvgpr_write_b32 a105, v113
    v_accvgpr_write_b32 a233, v117
    v_accvgpr_write_b32 a106, v114
    v_accvgpr_write_b32 a234, v118
    v_accvgpr_write_b32 a107, v115
    v_accvgpr_write_b32 a235, v119
    v_perm_b32 v112, v73, v72, s42
    v_perm_b32 v116, v73, v72, s43
    v_perm_b32 v113, v75, v74, s42
    v_perm_b32 v117, v75, v74, s43
    v_perm_b32 v114, v77, v76, s42
    v_perm_b32 v118, v77, v76, s43
    v_perm_b32 v115, v79, v78, s42
    v_perm_b32 v119, v79, v78, s43
    v_accvgpr_write_b32 a108, v112
    v_accvgpr_write_b32 a236, v116
    v_accvgpr_write_b32 a109, v113
    v_accvgpr_write_b32 a237, v117
    v_accvgpr_write_b32 a110, v114
    v_accvgpr_write_b32 a238, v118
    v_accvgpr_write_b32 a111, v115
    v_accvgpr_write_b32 a239, v119
    s_waitcnt vmcnt(0)
    v_perm_b32 v112, v81, v80, s42
    v_perm_b32 v116, v81, v80, s43
    v_perm_b32 v113, v83, v82, s42
    v_perm_b32 v117, v83, v82, s43
    v_perm_b32 v114, v85, v84, s42
    v_perm_b32 v118, v85, v84, s43
    v_perm_b32 v115, v87, v86, s42
    v_perm_b32 v119, v87, v86, s43
    v_accvgpr_write_b32 a112, v112
    v_accvgpr_write_b32 a240, v116
    v_accvgpr_write_b32 a113, v113
    v_accvgpr_write_b32 a241, v117
    v_accvgpr_write_b32 a114, v114
    v_accvgpr_write_b32 a242, v118
    v_accvgpr_write_b32 a115, v115
    v_accvgpr_write_b32 a243, v119
    v_perm_b32 v112, v89, v88, s42
    v_perm_b32 v116, v89, v88, s43
    v_perm_b32 v113, v91, v90, s42
    v_perm_b32 v117, v91, v90, s43
    v_perm_b32 v114, v93, v92, s42
    v_perm_b32 v118, v93, v92, s43
    v_perm_b32 v115, v95, v94, s42
    v_perm_b32 v119, v95, v94, s43
    v_accvgpr_write_b32 a116, v112
    v_accvgpr_write_b32 a244, v116
    v_accvgpr_write_b32 a117, v113
    v_accvgpr_write_b32 a245, v117
    v_accvgpr_write_b32 a118, v114
    v_accvgpr_write_b32 a246, v118
    v_accvgpr_write_b32 a119, v115
    v_accvgpr_write_b32 a247, v119
    v_perm_b32 v112, v97, v96, s42
    v_perm_b32 v116, v97, v96, s43
    v_perm_b32 v113, v99, v98, s42
    v_perm_b32 v117, v99, v98, s43
    v_perm_b32 v114, v101, v100, s42
    v_perm_b32 v118, v101, v100, s43
    v_perm_b32 v115, v103, v102, s42
    v_perm_b32 v119, v103, v102, s43
    v_accvgpr_write_b32 a120, v112
    v_accvgpr_write_b32 a248, v116
    v_accvgpr_write_b32 a121, v113
    v_accvgpr_write_b32 a249, v117
    v_accvgpr_write_b32 a122, v114
    v_accvgpr_write_b32 a250, v118
    v_accvgpr_write_b32 a123, v115
    v_accvgpr_write_b32 a251, v119
    v_perm_b32 v112, v105, v104, s42
    v_perm_b32 v116, v105, v104, s43
    v_perm_b32 v113, v107, v106, s42
    v_perm_b32 v117, v107, v106, s43
    v_perm_b32 v114, v109, v108, s42
    v_perm_b32 v118, v109, v108, s43
    v_perm_b32 v115, v111, v110, s42
    v_perm_b32 v119, v111, v110, s43
    v_accvgpr_write_b32 a124, v112
    v_accvgpr_write_b32 a252, v116
    v_accvgpr_write_b32 a125, v113
    v_accvgpr_write_b32 a253, v117
    v_accvgpr_write_b32 a126, v114
    v_accvgpr_write_b32 a254, v118
    v_accvgpr_write_b32 a127, v115
    v_accvgpr_write_b32 a255, v119
    s_waitcnt vmcnt(0)
    s_lshl_b32 s41, s28, 15
    buffer_load_dwordx4 v[16:19], v3, s[16:19], s41 offen offset:0
    buffer_load_dwordx4 v[20:23], v3, s[16:19], s41 offen offset:1024
    buffer_load_dwordx4 v[24:27], v3, s[16:19], s41 offen offset:2048
    buffer_load_dwordx4 v[28:31], v3, s[16:19], s41 offen offset:3072
    buffer_load_dwordx4 v[32:35], v4, s[16:19], s41 offen offset:0
    buffer_load_dwordx4 v[36:39], v4, s[16:19], s41 offen offset:1024
    buffer_load_dwordx4 v[40:43], v4, s[16:19], s41 offen offset:2048
    buffer_load_dwordx4 v[44:47], v4, s[16:19], s41 offen offset:3072
bulk_loop:
    s_waitcnt vmcnt(0)
    v_lshlrev_b32 v48, 16, v16
    v_and_b32 v49, s44, v16
    v_lshlrev_b32 v50, 16, v17
    v_and_b32 v51, s44, v17
    v_lshlrev_b32 v52, 16, v18
    v_and_b32 v53, s44, v18
    v_lshlrev_b32 v54, 16, v19
    v_and_b32 v55, s44, v19
    v_lshlrev_b32 v56, 16, v20
    v_and_b32 v57, s44, v20
    v_lshlrev_b32 v58, 16, v21
    v_and_b32 v59, s44, v21
    v_lshlrev_b32 v60, 16, v22
    v_and_b32 v61, s44, v22
    v_lshlrev_b32 v62, 16, v23
    v_and_b32 v63, s44, v23
    v_lshlrev_b32 v64, 16, v24
    v_and_b32 v65, s44, v24
    v_lshlrev_b32 v66, 16, v25
    v_and_b32 v67, s44, v25
    v_lshlrev_b32 v68, 16, v26
    v_and_b32 v69, s44, v26
    v_lshlrev_b32 v70, 16, v27
    v_and_b32 v71, s44, v27
    v_lshlrev_b32 v72, 16, v28
    v_and_b32 v73, s44, v28
    v_lshlrev_b32 v74, 16, v29
    v_and_b32 v75, s44, v29
    v_lshlrev_b32 v76, 16, v30
    v_and_b32 v77, s44, v30
    v_lshlrev_b32 v78, 16, v31
    v_and_b32 v79, s44, v31
    v_lshlrev_b32 v80, 16, v32
    v_and_b32 v81, s44, v32
    v_lshlrev_b32 v82, 16, v33
    v_and_b32 v83, s44, v33
    v_lshlrev_b32 v84, 16, v34
    v_and_b32 v85, s44, v34
    v_lshlrev_b32 v86, 16, v35
    v_and_b32 v87, s44, v35
    v_lshlrev_b32 v88, 16, v36
    v_and_b32 v89, s44, v36
    v_lshlrev_b32 v90, 16, v37
    v_and_b32 v91, s44, v37
    v_lshlrev_b32 v92, 16, v38
    v_and_b32 v93, s44, v38
    v_lshlrev_b32 v94, 16, v39
    v_and_b32 v95, s44, v39
    v_lshlrev_b32 v96, 16, v40
    v_and_b32 v97, s44, v40
    v_lshlrev_b32 v98, 16, v41
    v_and_b32 v99, s44, v41
    v_lshlrev_b32 v100, 16, v42
    v_and_b32 v101, s44, v42
    v_lshlrev_b32 v102, 16, v43
    v_and_b32 v103, s44, v43
    v_lshlrev_b32 v104, 16, v44
    v_and_b32 v105, s44, v44
    v_lshlrev_b32 v106, 16, v45
    v_and_b32 v107, s44, v45
    v_lshlrev_b32 v108, 16, v46
    v_and_b32 v109, s44, v46
    v_lshlrev_b32 v110, 16, v47
    v_and_b32 v111, s44, v47
    s_mov_b32 s39, s28
    s_add_u32 s28, s28, s29
    s_lshl_b32 s41, s28, 15
    buffer_load_dwordx4 v[16:19], v3, s[16:19], s41 offen offset:0
    buffer_load_dwordx4 v[20:23], v3, s[16:19], s41 offen offset:1024
    buffer_load_dwordx4 v[24:27], v3, s[16:19], s41 offen offset:2048
    buffer_load_dwordx4 v[28:31], v3, s[16:19], s41 offen offset:3072
    buffer_load_dwordx4 v[32:35], v4, s[16:19], s41 offen offset:0
    buffer_load_dwordx4 v[36:39], v4, s[16:19], s41 offen offset:1024
    buffer_load_dwordx4 v[40:43], v4, s[16:19], s41 offen offset:2048
    buffer_load_dwordx4 v[44:47], v4, s[16:19], s41 offen offset:3072
    v_add_f32 v112, v48, v49
    v_mul_f32 v120, v48, v48
    v_add_f32 v113, v56, v57
    v_mul_f32 v121, v56, v56
    v_add_f32 v114, v64, v65
    v_mul_f32 v122, v64, v64
    v_add_f32 v115, v72, v73
    v_mul_f32 v123, v72, v72
    v_add_f32 v116, v80, v81
    v_mul_f32 v124, v80, v80
    v_add_f32 v117, v88, v89
    v_mul_f32 v125, v88, v88
    v_add_f32 v118, v96, v97
    v_mul_f32 v126, v96, v96
    v_add_f32 v119, v104, v105
    v_mul_f32 v127, v104, v104
    v_fma_f32 v120, v49, v49, v120
    v_fma_f32 v121, v57, v57, v121
    v_fma_f32 v122, v65, v65, v122
    v_fma_f32 v123, v73, v73, v123
    v_fma_f32 v124, v81, v81, v124
    v_fma_f32 v125, v89, v89, v125
    v_fma_f32 v126, v97, v97, v126
    v_fma_f32 v127, v105, v105, v127
    v_add_f32 v112, v112, v50
    v_fma_f32 v120, v50, v50, v120
    v_add_f32 v113, v113, v58
    v_fma_f32 v121, v58, v58, v121
    v_add_f32 v114, v114, v66
    v_fma_f32 v122, v66, v66, v122
    v_add_f32 v115, v115, v74
    v_fma_f32 v123, v74, v74, v123
    v_add_f32 v116, v116, v82
    v_fma_f32 v124, v82, v82, v124
    v_add_f32 v117, v117, v90
    v_fma_f32 v125, v90, v90, v125
    v_add_f32 v118, v118, v98
    v_fma_f32 v126, v98, v98, v126
    v_add_f32 v119, v119, v106
    v_fma_f32 v127, v106, v106, v127
    v_add_f32 v112, v112, v51
    v_fma_f32 v120, v51, v51, v120
    v_add_f32 v113, v113, v59
    v_fma_f32 v121, v59, v59, v121
    v_add_f32 v114, v114, v67
    v_fma_f32 v122, v67, v67, v122
    v_add_f32 v115, v115, v75
    v_fma_f32 v123, v75, v75, v123
    v_add_f32 v116, v116, v83
    v_fma_f32 v124, v83, v83, v124
    v_add_f32 v117, v117, v91
    v_fma_f32 v125, v91, v91, v125
    v_add_f32 v118, v118, v99
    v_fma_f32 v126, v99, v99, v126
    v_add_f32 v119, v119, v107
    v_fma_f32 v127, v107, v107, v127
    v_add_f32 v112, v112, v52
    v_fma_f32 v120, v52, v52, v120
    v_add_f32 v113, v113, v60
    v_fma_f32 v121, v60, v60, v121
    v_add_f32 v114, v114, v68
    v_fma_f32 v122, v68, v68, v122
    v_add_f32 v115, v115, v76
    v_fma_f32 v123, v76, v76, v123
    v_add_f32 v116, v116, v84
    v_fma_f32 v124, v84, v84, v124
    v_add_f32 v117, v117, v92
    v_fma_f32 v125, v92, v92, v125
    v_add_f32 v118, v118, v100
    v_fma_f32 v126, v100, v100, v126
    v_add_f32 v119, v119, v108
    v_fma_f32 v127, v108, v108, v127
    v_add_f32 v112, v112, v53
    v_fma_f32 v120, v53, v53, v120
    v_add_f32 v113, v113, v61
    v_fma_f32 v121, v61, v61, v121
    v_add_f32 v114, v114, v69
    v_fma_f32 v122, v69, v69, v122
    v_add_f32 v115, v115, v77
    v_fma_f32 v123, v77, v77, v123
    v_add_f32 v116, v116, v85
    v_fma_f32 v124, v85, v85, v124
    v_add_f32 v117, v117, v93
    v_fma_f32 v125, v93, v93, v125
    v_add_f32 v118, v118, v101
    v_fma_f32 v126, v101, v101, v126
    v_add_f32 v119, v119, v109
    v_fma_f32 v127, v109, v109, v127
    v_add_f32 v112, v112, v54
    v_fma_f32 v120, v54, v54, v120
    v_add_f32 v113, v113, v62
    v_fma_f32 v121, v62, v62, v121
    v_add_f32 v114, v114, v70
    v_fma_f32 v122, v70, v70, v122
    v_add_f32 v115, v115, v78
    v_fma_f32 v123, v78, v78, v123
    v_add_f32 v116, v116, v86
    v_fma_f32 v124, v86, v86, v124
    v_add_f32 v117, v117, v94
    v_fma_f32 v125, v94, v94, v125
    v_add_f32 v118, v118, v102
    v_fma_f32 v126, v102, v102, v126
    v_add_f32 v119, v119, v110
    v_fma_f32 v127, v110, v110, v127
    v_add_f32 v112, v112, v55
    v_fma_f32 v120, v55, v55, v120
    v_add_f32 v113, v113, v63
    v_fma_f32 v121, v63, v63, v121
    v_add_f32 v114, v114, v71
    v_fma_f32 v122, v71, v71, v122
    v_add_f32 v115, v115, v79
    v_fma_f32 v123, v79, v79, v123
    v_add_f32 v116, v116, v87
    v_fma_f32 v124, v87, v87, v124
    v_add_f32 v117, v117, v95
    v_fma_f32 v125, v95, v95, v125
    v_add_f32 v118, v118, v103
    v_fma_f32 v126, v103, v103, v126
    v_add_f32 v119, v119, v111
    v_fma_f32 v127, v111, v111, v127
    v_add_f32_dpp v112, v112, v112 row_shr:1 bound_ctrl:0
    v_add_f32_dpp v113, v113, v113 row_shr:1 bound_ctrl:0
    v_add_f32_dpp v114, v114, v114 row_shr:1 bound_ctrl:0
    v_add_f32_dpp v115, v115, v115 row_shr:1 bound_ctrl:0
    v_add_f32_dpp v116, v116, v116 row_shr:1 bound_ctrl:0
    v_add_f32_dpp v117, v117, v117 row_shr:1 bound_ctrl:0
    v_add_f32_dpp v118, v118, v118 row_shr:1 bound_ctrl:0
    v_add_f32_dpp v119, v119, v119 row_shr:1 bound_ctrl:0
    v_add_f32_dpp v120, v120, v120 row_shr:1 bound_ctrl:0
    v_add_f32_dpp v121, v121, v121 row_shr:1 bound_ctrl:0
    v_add_f32_dpp v122, v122, v122 row_shr:1 bound_ctrl:0
    v_add_f32_dpp v123, v123, v123 row_shr:1 bound_ctrl:0
    v_add_f32_dpp v124, v124, v124 row_shr:1 bound_ctrl:0
    v_add_f32_dpp v125, v125, v125 row_shr:1 bound_ctrl:0
    v_add_f32_dpp v126, v126, v126 row_shr:1 bound_ctrl:0
    v_add_f32_dpp v127, v127, v127 row_shr:1 bound_ctrl:0
    v_add_f32_dpp v112, v112, v112 row_shr:2 bound_ctrl:0
    v_add_f32_dpp v113, v113, v113 row_shr:2 bound_ctrl:0
    v_add_f32_dpp v114, v114, v114 row_shr:2 bound_ctrl:0
    v_add_f32_dpp v115, v115, v115 row_shr:2 bound_ctrl:0
    v_add_f32_dpp v116, v116, v116 row_shr:2 bound_ctrl:0
    v_add_f32_dpp v117, v117, v117 row_shr:2 bound_ctrl:0
    v_add_f32_dpp v118, v118, v118 row_shr:2 bound_ctrl:0
    v_add_f32_dpp v119, v119, v119 row_shr:2 bound_ctrl:0
    v_add_f32_dpp v120, v120, v120 row_shr:2 bound_ctrl:0
    v_add_f32_dpp v121, v121, v121 row_shr:2 bound_ctrl:0
    v_add_f32_dpp v122, v122, v122 row_shr:2 bound_ctrl:0
    v_add_f32_dpp v123, v123, v123 row_shr:2 bound_ctrl:0
    v_add_f32_dpp v124, v124, v124 row_shr:2 bound_ctrl:0
    v_add_f32_dpp v125, v125, v125 row_shr:2 bound_ctrl:0
    v_add_f32_dpp v126, v126, v126 row_shr:2 bound_ctrl:0
    v_add_f32_dpp v127, v127, v127 row_shr:2 bound_ctrl:0
    v_add_f32_dpp v112, v112, v112 row_shr:4 bound_ctrl:0
    v_add_f32_dpp v113, v113, v113 row_shr:4 bound_ctrl:0
    v_add_f32_dpp v114, v114, v114 row_shr:4 bound_ctrl:0
    v_add_f32_dpp v115, v115, v115 row_shr:4 bound_ctrl:0
    v_add_f32_dpp v116, v116, v116 row_shr:4 bound_ctrl:0
    v_add_f32_dpp v117, v117, v117 row_shr:4 bound_ctrl:0
    v_add_f32_dpp v118, v118, v118 row_shr:4 bound_ctrl:0
    v_add_f32_dpp v119, v119, v119 row_shr:4 bound_ctrl:0
    v_add_f32_dpp v120, v120, v120 row_shr:4 bound_ctrl:0
    v_add_f32_dpp v121, v121, v121 row_shr:4 bound_ctrl:0
    v_add_f32_dpp v122, v122, v122 row_shr:4 bound_ctrl:0
    v_add_f32_dpp v123, v123, v123 row_shr:4 bound_ctrl:0
    v_add_f32_dpp v124, v124, v124 row_shr:4 bound_ctrl:0
    v_add_f32_dpp v125, v125, v125 row_shr:4 bound_ctrl:0
    v_add_f32_dpp v126, v126, v126 row_shr:4 bound_ctrl:0
    v_add_f32_dpp v127, v127, v127 row_shr:4 bound_ctrl:0
    v_add_f32_dpp v112, v112, v112 row_shr:8 bound_ctrl:0
    v_add_f32_dpp v113, v113, v113 row_shr:8 bound_ctrl:0
    v_add_f32_dpp v114, v114, v114 row_shr:8 bound_ctrl:0
    v_add_f32_dpp v115, v115, v115 row_shr:8 bound_ctrl:0
    v_add_f32_dpp v116, v116, v116 row_shr:8 bound_ctrl:0
    v_add_f32_dpp v117, v117, v117 row_shr:8 bound_ctrl:0
    v_add_f32_dpp v118, v118, v118 row_shr:8 bound_ctrl:0
    v_add_f32_dpp v119, v119, v119 row_shr:8 bound_ctrl:0
    v_add_f32_dpp v120, v120, v120 row_shr:8 bound_ctrl:0
    v_add_f32_dpp v121, v121, v121 row_shr:8 bound_ctrl:0
    v_add_f32_dpp v122, v122, v122 row_shr:8 bound_ctrl:0
    v_add_f32_dpp v123, v123, v123 row_shr:8 bound_ctrl:0
    v_add_f32_dpp v124, v124, v124 row_shr:8 bound_ctrl:0
    v_add_f32_dpp v125, v125, v125 row_shr:8 bound_ctrl:0
    v_add_f32_dpp v126, v126, v126 row_shr:8 bound_ctrl:0
    v_add_f32_dpp v127, v127, v127 row_shr:8 bound_ctrl:0
    v_add_f32_dpp v112, v112, v112 row_bcast:15 row_mask:0xa
    v_add_f32_dpp v113, v113, v113 row_bcast:15 row_mask:0xa
    v_add_f32_dpp v114, v114, v114 row_bcast:15 row_mask:0xa
    v_add_f32_dpp v115, v115, v115 row_bcast:15 row_mask:0xa
    v_add_f32_dpp v116, v116, v116 row_bcast:15 row_mask:0xa
    v_add_f32_dpp v117, v117, v117 row_bcast:15 row_mask:0xa
    v_add_f32_dpp v118, v118, v118 row_bcast:15 row_mask:0xa
    v_add_f32_dpp v119, v119, v119 row_bcast:15 row_mask:0xa
    v_add_f32_dpp v120, v120, v120 row_bcast:15 row_mask:0xa
    v_add_f32_dpp v121, v121, v121 row_bcast:15 row_mask:0xa
    v_add_f32_dpp v122, v122, v122 row_bcast:15 row_mask:0xa
    v_add_f32_dpp v123, v123, v123 row_bcast:15 row_mask:0xa
    v_add_f32_dpp v124, v124, v124 row_bcast:15 row_mask:0xa
    v_add_f32_dpp v125, v125, v125 row_bcast:15 row_mask:0xa
    v_add_f32_dpp v126, v126, v126 row_bcast:15 row_mask:0xa
    v_add_f32_dpp v127, v127, v127 row_bcast:15 row_mask:0xa
    v_add_f32_dpp v112, v112, v112 row_bcast:31 row_mask:0xc
    v_add_f32_dpp v113, v113, v113 row_bcast:31 row_mask:0xc
    v_add_f32_dpp v114, v114, v114 row_bcast:31 row_mask:0xc
    v_add_f32_dpp v115, v115, v115 row_bcast:31 row_mask:0xc
    v_add_f32_dpp v116, v116, v116 row_bcast:31 row_mask:0xc
    v_add_f32_dpp v117, v117, v117 row_bcast:31 row_mask:0xc
    v_add_f32_dpp v118, v118, v118 row_bcast:31 row_mask:0xc
    v_add_f32_dpp v119, v119, v119 row_bcast:31 row_mask:0xc
    v_add_f32_dpp v120, v120, v120 row_bcast:31 row_mask:0xc
    v_add_f32_dpp v121, v121, v121 row_bcast:31 row_mask:0xc
    v_add_f32_dpp v122, v122, v122 row_bcast:31 row_mask:0xc
    v_add_f32_dpp v123, v123, v123 row_bcast:31 row_mask:0xc
    v_add_f32_dpp v124, v124, v124 row_bcast:31 row_mask:0xc
    v_add_f32_dpp v125, v125, v125 row_bcast:31 row_mask:0xc
    v_add_f32_dpp v126, v126, v126 row_bcast:31 row_mask:0xc
    v_add_f32_dpp v127, v127, v127 row_bcast:31 row_mask:0xc
    s_mov_b32 s45, 0x3b000000
    s_mov_b32 s46, 0x3727c5ac
    v_mul_f32 v112, s45, v112
    v_mul_f32 v113, s45, v113
    v_mul_f32 v114, s45, v114
    v_mul_f32 v115, s45, v115
    v_mul_f32 v116, s45, v116
    v_mul_f32 v117, s45, v117
    v_mul_f32 v118, s45, v118
    v_mul_f32 v119, s45, v119
    v_mul_f32 v120, s45, v120
    v_mul_f32 v121, s45, v121
    v_mul_f32 v122, s45, v122
    v_mul_f32 v123, s45, v123
    v_mul_f32 v124, s45, v124
    v_mul_f32 v125, s45, v125
    v_mul_f32 v126, s45, v126
    v_mul_f32 v127, s45, v127
    v_fma_f32 v120, -v112, v112, v120
    v_fma_f32 v121, -v113, v113, v121
    v_fma_f32 v122, -v114, v114, v122
    v_fma_f32 v123, -v115, v115, v123
    v_fma_f32 v124, -v116, v116, v124
    v_fma_f32 v125, -v117, v117, v125
    v_fma_f32 v126, -v118, v118, v126
    v_fma_f32 v127, -v119, v119, v127
    v_max_f32 v120, 0, v120
    v_max_f32 v121, 0, v121
    v_max_f32 v122, 0, v122
    v_max_f32 v123, 0, v123
    v_max_f32 v124, 0, v124
    v_max_f32 v125, 0, v125
    v_max_f32 v126, 0, v126
    v_max_f32 v127, 0, v127
    v_add_f32 v120, s46, v120
    v_add_f32 v121, s46, v121
    v_add_f32 v122, s46, v122
    v_add_f32 v123, s46, v123
    v_add_f32 v124, s46, v124
    v_add_f32 v125, s46, v125
    v_add_f32 v126, s46, v126
    v_add_f32 v127, s46, v127
    v_rsq_f32 v120, v120
    v_rsq_f32 v121, v121
    v_rsq_f32 v122, v122
    v_rsq_f32 v123, v123
    v_rsq_f32 v124, v124
    v_rsq_f32 v125, v125
    v_rsq_f32 v126, v126
    v_rsq_f32 v127, v127
    s_nop 1
    v_readlane_b32 s48, v112, 63
    v_readlane_b32 s56, v120, 63
    v_readlane_b32 s49, v113, 63
    v_readlane_b32 s57, v121, 63
    v_readlane_b32 s50, v114, 63
    v_readlane_b32 s58, v122, 63
    v_readlane_b32 s51, v115, 63
    v_readlane_b32 s59, v123, 63
    v_readlane_b32 s52, v116, 63
    v_readlane_b32 s60, v124, 63
    v_readlane_b32 s53, v117, 63
    v_readlane_b32 s61, v125, 63
    v_readlane_b32 s54, v118, 63
    v_readlane_b32 s62, v126, 63
    v_readlane_b32 s55, v119, 63
    v_readlane_b32 s63, v127, 63
    s_nop 1
    v_subrev_f32 v48, s48, v48
    v_subrev_f32 v49, s48, v49
    v_subrev_f32 v50, s48, v50
    v_subrev_f32 v51, s48, v51
    v_subrev_f32 v52, s48, v52
    v_subrev_f32 v53, s48, v53
    v_subrev_f32 v54, s48, v54
    v_subrev_f32 v55, s48, v55
    v_mul_f32 v48, s56, v48
    v_mul_f32 v49, s56, v49
    v_mul_f32 v50, s56, v50
    v_mul_f32 v51, s56, v51
    v_mul_f32 v52, s56, v52
    v_mul_f32 v53, s56, v53
    v_mul_f32 v54, s56, v54
    v_mul_f32 v55, s56, v55
    v_fma_f32 v48, v48, v128, v136
    v_fma_f32 v49, v49, v129, v137
    v_fma_f32 v50, v50, v130, v138
    v_fma_f32 v51, v51, v131, v139
    v_fma_f32 v52, v52, v132, v140
    v_fma_f32 v53, v53, v133, v141
    v_fma_f32 v54, v54, v134, v142
    v_fma_f32 v55, v55, v135, v143
    v_cvt_pk_bf16_f32 v48, v48, v49
    v_cvt_pk_bf16_f32 v49, v50, v51
    v_cvt_pk_bf16_f32 v50, v52, v53
    v_cvt_pk_bf16_f32 v51, v54, v55
    ds_write_b128 v5, v[48:51] offset:0
    v_subrev_f32 v56, s49, v56
    v_subrev_f32 v57, s49, v57
    v_subrev_f32 v58, s49, v58
    v_subrev_f32 v59, s49, v59
    v_subrev_f32 v60, s49, v60
    v_subrev_f32 v61, s49, v61
    v_subrev_f32 v62, s49, v62
    v_subrev_f32 v63, s49, v63
    v_mul_f32 v56, s57, v56
    v_mul_f32 v57, s57, v57
    v_mul_f32 v58, s57, v58
    v_mul_f32 v59, s57, v59
    v_mul_f32 v60, s57, v60
    v_mul_f32 v61, s57, v61
    v_mul_f32 v62, s57, v62
    v_mul_f32 v63, s57, v63
    v_fma_f32 v56, v56, v128, v136
    v_fma_f32 v57, v57, v129, v137
    v_fma_f32 v58, v58, v130, v138
    v_fma_f32 v59, v59, v131, v139
    v_fma_f32 v60, v60, v132, v140
    v_fma_f32 v61, v61, v133, v141
    v_fma_f32 v62, v62, v134, v142
    v_fma_f32 v63, v63, v135, v143
    v_cvt_pk_bf16_f32 v56, v56, v57
    v_cvt_pk_bf16_f32 v57, v58, v59
    v_cvt_pk_bf16_f32 v58, v60, v61
    v_cvt_pk_bf16_f32 v59, v62, v63
    ds_write_b128 v5, v[56:59] offset:1040
    v_subrev_f32 v64, s50, v64
    v_subrev_f32 v65, s50, v65
    v_subrev_f32 v66, s50, v66
    v_subrev_f32 v67, s50, v67
    v_subrev_f32 v68, s50, v68
    v_subrev_f32 v69, s50, v69
    v_subrev_f32 v70, s50, v70
    v_subrev_f32 v71, s50, v71
    v_mul_f32 v64, s58, v64
    v_mul_f32 v65, s58, v65
    v_mul_f32 v66, s58, v66
    v_mul_f32 v67, s58, v67
    v_mul_f32 v68, s58, v68
    v_mul_f32 v69, s58, v69
    v_mul_f32 v70, s58, v70
    v_mul_f32 v71, s58, v71
    v_fma_f32 v64, v64, v128, v136
    v_fma_f32 v65, v65, v129, v137
    v_fma_f32 v66, v66, v130, v138
    v_fma_f32 v67, v67, v131, v139
    v_fma_f32 v68, v68, v132, v140
    v_fma_f32 v69, v69, v133, v141
    v_fma_f32 v70, v70, v134, v142
    v_fma_f32 v71, v71, v135, v143
    v_cvt_pk_bf16_f32 v64, v64, v65
    v_cvt_pk_bf16_f32 v65, v66, v67
    v_cvt_pk_bf16_f32 v66, v68, v69
    v_cvt_pk_bf16_f32 v67, v70, v71
    ds_write_b128 v5, v[64:67] offset:2080
    v_subrev_f32 v72, s51, v72
    v_subrev_f32 v73, s51, v73
    v_subrev_f32 v74, s51, v74
    v_subrev_f32 v75, s51, v75
    v_subrev_f32 v76, s51, v76
    v_subrev_f32 v77, s51, v77
    v_subrev_f32 v78, s51, v78
    v_subrev_f32 v79, s51, v79
    v_mul_f32 v72, s59, v72
    v_mul_f32 v73, s59, v73
    v_mul_f32 v74, s59, v74
    v_mul_f32 v75, s59, v75
    v_mul_f32 v76, s59, v76
    v_mul_f32 v77, s59, v77
    v_mul_f32 v78, s59, v78
    v_mul_f32 v79, s59, v79
    v_fma_f32 v72, v72, v128, v136
    v_fma_f32 v73, v73, v129, v137
    v_fma_f32 v74, v74, v130, v138
    v_fma_f32 v75, v75, v131, v139
    v_fma_f32 v76, v76, v132, v140
    v_fma_f32 v77, v77, v133, v141
    v_fma_f32 v78, v78, v134, v142
    v_fma_f32 v79, v79, v135, v143
    v_cvt_pk_bf16_f32 v72, v72, v73
    v_cvt_pk_bf16_f32 v73, v74, v75
    v_cvt_pk_bf16_f32 v74, v76, v77
    v_cvt_pk_bf16_f32 v75, v78, v79
    ds_write_b128 v5, v[72:75] offset:3120
    v_subrev_f32 v80, s52, v80
    v_subrev_f32 v81, s52, v81
    v_subrev_f32 v82, s52, v82
    v_subrev_f32 v83, s52, v83
    v_subrev_f32 v84, s52, v84
    v_subrev_f32 v85, s52, v85
    v_subrev_f32 v86, s52, v86
    v_subrev_f32 v87, s52, v87
    v_mul_f32 v80, s60, v80
    v_mul_f32 v81, s60, v81
    v_mul_f32 v82, s60, v82
    v_mul_f32 v83, s60, v83
    v_mul_f32 v84, s60, v84
    v_mul_f32 v85, s60, v85
    v_mul_f32 v86, s60, v86
    v_mul_f32 v87, s60, v87
    v_fma_f32 v80, v80, v128, v136
    v_fma_f32 v81, v81, v129, v137
    v_fma_f32 v82, v82, v130, v138
    v_fma_f32 v83, v83, v131, v139
    v_fma_f32 v84, v84, v132, v140
    v_fma_f32 v85, v85, v133, v141
    v_fma_f32 v86, v86, v134, v142
    v_fma_f32 v87, v87, v135, v143
    v_cvt_pk_bf16_f32 v80, v80, v81
    v_cvt_pk_bf16_f32 v81, v82, v83
    v_cvt_pk_bf16_f32 v82, v84, v85
    v_cvt_pk_bf16_f32 v83, v86, v87
    ds_write_b128 v5, v[80:83] offset:4160
    v_subrev_f32 v88, s53, v88
    v_subrev_f32 v89, s53, v89
    v_subrev_f32 v90, s53, v90
    v_subrev_f32 v91, s53, v91
    v_subrev_f32 v92, s53, v92
    v_subrev_f32 v93, s53, v93
    v_subrev_f32 v94, s53, v94
    v_subrev_f32 v95, s53, v95
    v_mul_f32 v88, s61, v88
    v_mul_f32 v89, s61, v89
    v_mul_f32 v90, s61, v90
    v_mul_f32 v91, s61, v91
    v_mul_f32 v92, s61, v92
    v_mul_f32 v93, s61, v93
    v_mul_f32 v94, s61, v94
    v_mul_f32 v95, s61, v95
    v_fma_f32 v88, v88, v128, v136
    v_fma_f32 v89, v89, v129, v137
    v_fma_f32 v90, v90, v130, v138
    v_fma_f32 v91, v91, v131, v139
    v_fma_f32 v92, v92, v132, v140
    v_fma_f32 v93, v93, v133, v141
    v_fma_f32 v94, v94, v134, v142
    v_fma_f32 v95, v95, v135, v143
    v_cvt_pk_bf16_f32 v88, v88, v89
    v_cvt_pk_bf16_f32 v89, v90, v91
    v_cvt_pk_bf16_f32 v90, v92, v93
    v_cvt_pk_bf16_f32 v91, v94, v95
    ds_write_b128 v5, v[88:91] offset:5200
    v_subrev_f32 v96, s54, v96
    v_subrev_f32 v97, s54, v97
    v_subrev_f32 v98, s54, v98
    v_subrev_f32 v99, s54, v99
    v_subrev_f32 v100, s54, v100
    v_subrev_f32 v101, s54, v101
    v_subrev_f32 v102, s54, v102
    v_subrev_f32 v103, s54, v103
    v_mul_f32 v96, s62, v96
    v_mul_f32 v97, s62, v97
    v_mul_f32 v98, s62, v98
    v_mul_f32 v99, s62, v99
    v_mul_f32 v100, s62, v100
    v_mul_f32 v101, s62, v101
    v_mul_f32 v102, s62, v102
    v_mul_f32 v103, s62, v103
    v_fma_f32 v96, v96, v128, v136
    v_fma_f32 v97, v97, v129, v137
    v_fma_f32 v98, v98, v130, v138
    v_fma_f32 v99, v99, v131, v139
    v_fma_f32 v100, v100, v132, v140
    v_fma_f32 v101, v101, v133, v141
    v_fma_f32 v102, v102, v134, v142
    v_fma_f32 v103, v103, v135, v143
    v_cvt_pk_bf16_f32 v96, v96, v97
    v_cvt_pk_bf16_f32 v97, v98, v99
    v_cvt_pk_bf16_f32 v98, v100, v101
    v_cvt_pk_bf16_f32 v99, v102, v103
    ds_write_b128 v5, v[96:99] offset:6240
    v_subrev_f32 v104, s55, v104
    v_subrev_f32 v105, s55, v105
    v_subrev_f32 v106, s55, v106
    v_subrev_f32 v107, s55, v107
    v_subrev_f32 v108, s55, v108
    v_subrev_f32 v109, s55, v109
    v_subrev_f32 v110, s55, v110
    v_subrev_f32 v111, s55, v111
    v_mul_f32 v104, s63, v104
    v_mul_f32 v105, s63, v105
    v_mul_f32 v106, s63, v106
    v_mul_f32 v107, s63, v107
    v_mul_f32 v108, s63, v108
    v_mul_f32 v109, s63, v109
    v_mul_f32 v110, s63, v110
    v_mul_f32 v111, s63, v111
    v_fma_f32 v104, v104, v128, v136
    v_fma_f32 v105, v105, v129, v137
    v_fma_f32 v106, v106, v130, v138
    v_fma_f32 v107, v107, v131, v139
    v_fma_f32 v108, v108, v132, v140
    v_fma_f32 v109, v109, v133, v141
    v_fma_f32 v110, v110, v134, v142
    v_fma_f32 v111, v111, v135, v143
    v_cvt_pk_bf16_f32 v104, v104, v105
    v_cvt_pk_bf16_f32 v105, v106, v107
    v_cvt_pk_bf16_f32 v106, v108, v109
    v_cvt_pk_bf16_f32 v107, v110, v111
    ds_write_b128 v5, v[104:107] offset:7280
    s_waitcnt lgkmcnt(0)
    s_barrier
    s_lshl_b32 s47, s39, 18
    s_add_u32 s47, s47, s33
    s_cmp_eq_u32 s32, 1
    s_cbranch_scc1 bulk_v
    ds_read_b128 v[176:179], v6 offset:0
    ds_read_b128 v[180:183], v6 offset:32
    ds_read_b128 v[184:187], v6 offset:64
    ds_read_b128 v[188:191], v6 offset:96
    ds_read_b128 v[192:195], v6 offset:128
    ds_read_b128 v[196:199], v6 offset:160
    ds_read_b128 v[200:203], v6 offset:192
    ds_read_b128 v[204:207], v6 offset:224
    s_waitcnt lgkmcnt(7)
    v_mfma_f32_32x32x16_bf16 v[144:159], a[0:3], v[176:179], 0
    v_mfma_f32_32x32x16_bf16 v[160:175], a[128:131], v[176:179], 0
    ds_read_b128 v[176:179], v6 offset:256
    s_waitcnt lgkmcnt(7)
    v_mfma_f32_32x32x16_bf16 v[144:159], a[4:7], v[180:183], v[144:159]
    v_mfma_f32_32x32x16_bf16 v[160:175], a[132:135], v[180:183], v[160:175]
    ds_read_b128 v[180:183], v6 offset:288
    s_waitcnt lgkmcnt(7)
    v_mfma_f32_32x32x16_bf16 v[144:159], a[8:11], v[184:187], v[144:159]
    v_mfma_f32_32x32x16_bf16 v[160:175], a[136:139], v[184:187], v[160:175]
    ds_read_b128 v[184:187], v6 offset:320
    s_waitcnt lgkmcnt(7)
    v_mfma_f32_32x32x16_bf16 v[144:159], a[12:15], v[188:191], v[144:159]
    v_mfma_f32_32x32x16_bf16 v[160:175], a[140:143], v[188:191], v[160:175]
    ds_read_b128 v[188:191], v6 offset:352
    s_waitcnt lgkmcnt(7)
    v_mfma_f32_32x32x16_bf16 v[144:159], a[16:19], v[192:195], v[144:159]
    v_mfma_f32_32x32x16_bf16 v[160:175], a[144:147], v[192:195], v[160:175]
    ds_read_b128 v[192:195], v6 offset:384
    s_waitcnt lgkmcnt(7)
    v_mfma_f32_32x32x16_bf16 v[144:159], a[20:23], v[196:199], v[144:159]
    v_mfma_f32_32x32x16_bf16 v[160:175], a[148:151], v[196:199], v[160:175]
    ds_read_b128 v[196:199], v6 offset:416
    s_waitcnt lgkmcnt(7)
    v_mfma_f32_32x32x16_bf16 v[144:159], a[24:27], v[200:203], v[144:159]
    v_mfma_f32_32x32x16_bf16 v[160:175], a[152:155], v[200:203], v[160:175]
    ds_read_b128 v[200:203], v6 offset:448
    s_waitcnt lgkmcnt(7)
    v_mfma_f32_32x32x16_bf16 v[144:159], a[28:31], v[204:207], v[144:159]
    v_mfma_f32_32x32x16_bf16 v[160:175], a[156:159], v[204:207], v[160:175]
    ds_read_b128 v[204:207], v6 offset:480
    s_waitcnt lgkmcnt(7)
    v_mfma_f32_32x32x16_bf16 v[144:159], a[32:35], v[176:179], v[144:159]
    v_mfma_f32_32x32x16_bf16 v[160:175], a[160:163], v[176:179], v[160:175]
    ds_read_b128 v[176:179], v6 offset:512
    s_waitcnt lgkmcnt(7)
    v_mfma_f32_32x32x16_bf16 v[144:159], a[36:39], v[180:183], v[144:159]
    v_mfma_f32_32x32x16_bf16 v[160:175], a[164:167], v[180:183], v[160:175]
    ds_read_b128 v[180:183], v6 offset:544
    s_waitcnt lgkmcnt(7)
    v_mfma_f32_32x32x16_bf16 v[144:159], a[40:43], v[184:187], v[144:159]
    v_mfma_f32_32x32x16_bf16 v[160:175], a[168:171], v[184:187], v[160:175]
    ds_read_b128 v[184:187], v6 offset:576
    s_waitcnt lgkmcnt(7)
    v_mfma_f32_32x32x16_bf16 v[144:159], a[44:47], v[188:191], v[144:159]
    v_mfma_f32_32x32x16_bf16 v[160:175], a[172:175], v[188:191], v[160:175]
    ds_read_b128 v[188:191], v6 offset:608
    s_waitcnt lgkmcnt(7)
    v_mfma_f32_32x32x16_bf16 v[144:159], a[48:51], v[192:195], v[144:159]
    v_mfma_f32_32x32x16_bf16 v[160:175], a[176:179], v[192:195], v[160:175]
    ds_read_b128 v[192:195], v6 offset:640
    s_waitcnt lgkmcnt(7)
    v_mfma_f32_32x32x16_bf16 v[144:159], a[52:55], v[196:199], v[144:159]
    v_mfma_f32_32x32x16_bf16 v[160:175], a[180:183], v[196:199], v[160:175]
    ds_read_b128 v[196:199], v6 offset:672
    s_waitcnt lgkmcnt(7)
    v_mfma_f32_32x32x16_bf16 v[144:159], a[56:59], v[200:203], v[144:159]
    v_mfma_f32_32x32x16_bf16 v[160:175], a[184:187], v[200:203], v[160:175]
    ds_read_b128 v[200:203], v6 offset:704
    s_waitcnt lgkmcnt(7)
    v_mfma_f32_32x32x16_bf16 v[144:159], a[60:63], v[204:207], v[144:159]
    v_mfma_f32_32x32x16_bf16 v[160:175], a[188:191], v[204:207], v[160:175]
    ds_read_b128 v[204:207], v6 offset:736
    s_waitcnt lgkmcnt(7)
    v_mfma_f32_32x32x16_bf16 v[144:159], a[64:67], v[176:179], v[144:159]
    v_mfma_f32_32x32x16_bf16 v[160:175], a[192:195], v[176:179], v[160:175]
    ds_read_b128 v[176:179], v6 offset:768
    s_waitcnt lgkmcnt(7)
    v_mfma_f32_32x32x16_bf16 v[144:159], a[68:71], v[180:183], v[144:159]
    v_mfma_f32_32x32x16_bf16 v[160:175], a[196:199], v[180:183], v[160:175]
    ds_read_b128 v[180:183], v6 offset:800
    s_waitcnt lgkmcnt(7)
    v_mfma_f32_32x32x16_bf16 v[144:159], a[72:75], v[184:187], v[144:159]
    v_mfma_f32_32x32x16_bf16 v[160:175], a[200:203], v[184:187], v[160:175]
    ds_read_b128 v[184:187], v6 offset:832
    s_waitcnt lgkmcnt(7)
    v_mfma_f32_32x32x16_bf16 v[144:159], a[76:79], v[188:191], v[144:159]
    v_mfma_f32_32x32x16_bf16 v[160:175], a[204:207], v[188:191], v[160:175]
    ds_read_b128 v[188:191], v6 offset:864
    s_waitcnt lgkmcnt(7)
    v_mfma_f32_32x32x16_bf16 v[144:159], a[80:83], v[192:195], v[144:159]
    v_mfma_f32_32x32x16_bf16 v[160:175], a[208:211], v[192:195], v[160:175]
    ds_read_b128 v[192:195], v6 offset:896
    s_waitcnt lgkmcnt(7)
    v_mfma_f32_32x32x16_bf16 v[144:159], a[84:87], v[196:199], v[144:159]
    v_mfma_f32_32x32x16_bf16 v[160:175], a[212:215], v[196:199], v[160:175]
    ds_read_b128 v[196:199], v6 offset:928
    s_waitcnt lgkmcnt(7)
    v_mfma_f32_32x32x16_bf16 v[144:159], a[88:91], v[200:203], v[144:159]
    v_mfma_f32_32x32x16_bf16 v[160:175], a[216:219], v[200:203], v[160:175]
    ds_read_b128 v[200:203], v6 offset:960
    s_waitcnt lgkmcnt(7)
    v_mfma_f32_32x32x16_bf16 v[144:159], a[92:95], v[204:207], v[144:159]
    v_mfma_f32_32x32x16_bf16 v[160:175], a[220:223], v[204:207], v[160:175]
    ds_read_b128 v[204:207], v6 offset:992
    s_waitcnt lgkmcnt(7)
    v_mfma_f32_32x32x16_bf16 v[144:159], a[96:99], v[176:179], v[144:159]
    v_mfma_f32_32x32x16_bf16 v[160:175], a[224:227], v[176:179], v[160:175]
    s_waitcnt lgkmcnt(6)
    v_mfma_f32_32x32x16_bf16 v[144:159], a[100:103], v[180:183], v[144:159]
    v_mfma_f32_32x32x16_bf16 v[160:175], a[228:231], v[180:183], v[160:175]
    s_waitcnt lgkmcnt(5)
    v_mfma_f32_32x32x16_bf16 v[144:159], a[104:107], v[184:187], v[144:159]
    v_mfma_f32_32x32x16_bf16 v[160:175], a[232:235], v[184:187], v[160:175]
    s_waitcnt lgkmcnt(4)
    v_mfma_f32_32x32x16_bf16 v[144:159], a[108:111], v[188:191], v[144:159]
    v_mfma_f32_32x32x16_bf16 v[160:175], a[236:239], v[188:191], v[160:175]
    s_waitcnt lgkmcnt(3)
    v_mfma_f32_32x32x16_bf16 v[144:159], a[112:115], v[192:195], v[144:159]
    v_mfma_f32_32x32x16_bf16 v[160:175], a[240:243], v[192:195], v[160:175]
    s_waitcnt lgkmcnt(2)
    v_mfma_f32_32x32x16_bf16 v[144:159], a[116:119], v[196:199], v[144:159]
    v_mfma_f32_32x32x16_bf16 v[160:175], a[244:247], v[196:199], v[160:175]
    s_waitcnt lgkmcnt(1)
    v_mfma_f32_32x32x16_bf16 v[144:159], a[120:123], v[200:203], v[144:159]
    v_mfma_f32_32x32x16_bf16 v[160:175], a[248:251], v[200:203], v[160:175]
    s_waitcnt lgkmcnt(0)
    v_mfma_f32_32x32x16_bf16 v[144:159], a[124:127], v[204:207], v[144:159]
    v_mfma_f32_32x32x16_bf16 v[160:175], a[252:255], v[204:207], v[160:175]
    s_nop 13
    v_cvt_pk_bf16_f32 v208, v144, v160
    v_cvt_pk_bf16_f32 v209, v145, v161
    v_cvt_pk_bf16_f32 v210, v146, v162
    v_cvt_pk_bf16_f32 v211, v147, v163
    buffer_store_dwordx4 v[208:211], v7, s[20:23], s47 offen offset:0 sc1
    v_cvt_pk_bf16_f32 v212, v148, v164
    v_cvt_pk_bf16_f32 v213, v149, v165
    v_cvt_pk_bf16_f32 v214, v150, v166
    v_cvt_pk_bf16_f32 v215, v151, v167
    buffer_store_dwordx4 v[212:215], v7, s[20:23], s47 offen offset:512 sc1
    v_cvt_pk_bf16_f32 v216, v152, v168
    v_cvt_pk_bf16_f32 v217, v153, v169
    v_cvt_pk_bf16_f32 v218, v154, v170
    v_cvt_pk_bf16_f32 v219, v155, v171
    buffer_store_dwordx4 v[216:219], v7, s[20:23], s47 offen offset:1024 sc1
    v_cvt_pk_bf16_f32 v220, v156, v172
    v_cvt_pk_bf16_f32 v221, v157, v173
    v_cvt_pk_bf16_f32 v222, v158, v174
    v_cvt_pk_bf16_f32 v223, v159, v175
    buffer_store_dwordx4 v[220:223], v7, s[20:23], s47 offen offset:1536 sc1
    s_branch bulk_fin
bulk_v:
    ds_read_b128 v[176:179], v6 offset:0
    ds_read_b128 v[180:183], v6 offset:32
    ds_read_b128 v[184:187], v6 offset:64
    ds_read_b128 v[188:191], v6 offset:96
    ds_read_b128 v[192:195], v6 offset:128
    ds_read_b128 v[196:199], v6 offset:160
    ds_read_b128 v[200:203], v6 offset:192
    ds_read_b128 v[204:207], v6 offset:224
    s_waitcnt lgkmcnt(7)
    v_mfma_f32_32x32x16_bf16 v[144:159], v[176:179], a[0:3], 0
    v_mfma_f32_32x32x16_bf16 v[160:175], v[176:179], a[128:131], 0
    ds_read_b128 v[176:179], v6 offset:256
    s_waitcnt lgkmcnt(7)
    v_mfma_f32_32x32x16_bf16 v[144:159], v[180:183], a[4:7], v[144:159]
    v_mfma_f32_32x32x16_bf16 v[160:175], v[180:183], a[132:135], v[160:175]
    ds_read_b128 v[180:183], v6 offset:288
    s_waitcnt lgkmcnt(7)
    v_mfma_f32_32x32x16_bf16 v[144:159], v[184:187], a[8:11], v[144:159]
    v_mfma_f32_32x32x16_bf16 v[160:175], v[184:187], a[136:139], v[160:175]
    ds_read_b128 v[184:187], v6 offset:320
    s_waitcnt lgkmcnt(7)
    v_mfma_f32_32x32x16_bf16 v[144:159], v[188:191], a[12:15], v[144:159]
    v_mfma_f32_32x32x16_bf16 v[160:175], v[188:191], a[140:143], v[160:175]
    ds_read_b128 v[188:191], v6 offset:352
    s_waitcnt lgkmcnt(7)
    v_mfma_f32_32x32x16_bf16 v[144:159], v[192:195], a[16:19], v[144:159]
    v_mfma_f32_32x32x16_bf16 v[160:175], v[192:195], a[144:147], v[160:175]
    ds_read_b128 v[192:195], v6 offset:384
    s_waitcnt lgkmcnt(7)
    v_mfma_f32_32x32x16_bf16 v[144:159], v[196:199], a[20:23], v[144:159]
    v_mfma_f32_32x32x16_bf16 v[160:175], v[196:199], a[148:151], v[160:175]
    ds_read_b128 v[196:199], v6 offset:416
    s_waitcnt lgkmcnt(7)
    v_mfma_f32_32x32x16_bf16 v[144:159], v[200:203], a[24:27], v[144:159]
    v_mfma_f32_32x32x16_bf16 v[160:175], v[200:203], a[152:155], v[160:175]
    ds_read_b128 v[200:203], v6 offset:448
    s_waitcnt lgkmcnt(7)
    v_mfma_f32_32x32x16_bf16 v[144:159], v[204:207], a[28:31], v[144:159]
    v_mfma_f32_32x32x16_bf16 v[160:175], v[204:207], a[156:159], v[160:175]
    ds_read_b128 v[204:207], v6 offset:480
    s_waitcnt lgkmcnt(7)
    v_mfma_f32_32x32x16_bf16 v[144:159], v[176:179], a[32:35], v[144:159]
    v_mfma_f32_32x32x16_bf16 v[160:175], v[176:179], a[160:163], v[160:175]
    ds_read_b128 v[176:179], v6 offset:512
    s_waitcnt lgkmcnt(7)
    v_mfma_f32_32x32x16_bf16 v[144:159], v[180:183], a[36:39], v[144:159]
    v_mfma_f32_32x32x16_bf16 v[160:175], v[180:183], a[164:167], v[160:175]
    ds_read_b128 v[180:183], v6 offset:544
    s_waitcnt lgkmcnt(7)
    v_mfma_f32_32x32x16_bf16 v[144:159], v[184:187], a[40:43], v[144:159]
    v_mfma_f32_32x32x16_bf16 v[160:175], v[184:187], a[168:171], v[160:175]
    ds_read_b128 v[184:187], v6 offset:576
    s_waitcnt lgkmcnt(7)
    v_mfma_f32_32x32x16_bf16 v[144:159], v[188:191], a[44:47], v[144:159]
    v_mfma_f32_32x32x16_bf16 v[160:175], v[188:191], a[172:175], v[160:175]
    ds_read_b128 v[188:191], v6 offset:608
    s_waitcnt lgkmcnt(7)
    v_mfma_f32_32x32x16_bf16 v[144:159], v[192:195], a[48:51], v[144:159]
    v_mfma_f32_32x32x16_bf16 v[160:175], v[192:195], a[176:179], v[160:175]
    ds_read_b128 v[192:195], v6 offset:640
    s_waitcnt lgkmcnt(7)
    v_mfma_f32_32x32x16_bf16 v[144:159], v[196:199], a[52:55], v[144:159]
    v_mfma_f32_32x32x16_bf16 v[160:175], v[196:199], a[180:183], v[160:175]
    ds_read_b128 v[196:199], v6 offset:672
    s_waitcnt lgkmcnt(7)
    v_mfma_f32_32x32x16_bf16 v[144:159], v[200:203], a[56:59], v[144:159]
    v_mfma_f32_32x32x16_bf16 v[160:175], v[200:203], a[184:187], v[160:175]
    ds_read_b128 v[200:203], v6 offset:704
    s_waitcnt lgkmcnt(7)
    v_mfma_f32_32x32x16_bf16 v[144:159], v[204:207], a[60:63], v[144:159]
    v_mfma_f32_32x32x16_bf16 v[160:175], v[204:207], a[188:191], v[160:175]
    ds_read_b128 v[204:207], v6 offset:736
    s_waitcnt lgkmcnt(7)
    v_mfma_f32_32x32x16_bf16 v[144:159], v[176:179], a[64:67], v[144:159]
    v_mfma_f32_32x32x16_bf16 v[160:175], v[176:179], a[192:195], v[160:175]
    ds_read_b128 v[176:179], v6 offset:768
    s_waitcnt lgkmcnt(7)
    v_mfma_f32_32x32x16_bf16 v[144:159], v[180:183], a[68:71], v[144:159]
    v_mfma_f32_32x32x16_bf16 v[160:175], v[180:183], a[196:199], v[160:175]
    ds_read_b128 v[180:183], v6 offset:800
    s_waitcnt lgkmcnt(7)
    v_mfma_f32_32x32x16_bf16 v[144:159], v[184:187], a[72:75], v[144:159]
    v_mfma_f32_32x32x16_bf16 v[160:175], v[184:187], a[200:203], v[160:175]
    ds_read_b128 v[184:187], v6 offset:832
    s_waitcnt lgkmcnt(7)
    v_mfma_f32_32x32x16_bf16 v[144:159], v[188:191], a[76:79], v[144:159]
    v_mfma_f32_32x32x16_bf16 v[160:175], v[188:191], a[204:207], v[160:175]
    ds_read_b128 v[188:191], v6 offset:864
    s_waitcnt lgkmcnt(7)
    v_mfma_f32_32x32x16_bf16 v[144:159], v[192:195], a[80:83], v[144:159]
    v_mfma_f32_32x32x16_bf16 v[160:175], v[192:195], a[208:211], v[160:175]
    ds_read_b128 v[192:195], v6 offset:896
    s_waitcnt lgkmcnt(7)
    v_mfma_f32_32x32x16_bf16 v[144:159], v[196:199], a[84:87], v[144:159]
    v_mfma_f32_32x32x16_bf16 v[160:175], v[196:199], a[212:215], v[160:175]
    ds_read_b128 v[196:199], v6 offset:928
    s_waitcnt lgkmcnt(7)
    v_mfma_f32_32x32x16_bf16 v[144:159], v[200:203], a[88:91], v[144:159]
    v_mfma_f32_32x32x16_bf16 v[160:175], v[200:203], a[216:219], v[160:175]
    ds_read_b128 v[200:203], v6 offset:960
    s_waitcnt lgkmcnt(7)
    v_mfma_f32_32x32x16_bf16 v[144:159], v[204:207], a[92:95], v[144:159]
    v_mfma_f32_32x32x16_bf16 v[160:175], v[204:207], a[220:223], v[160:175]
    ds_read_b128 v[204:207], v6 offset:992
    s_waitcnt lgkmcnt(7)
    v_mfma_f32_32x32x16_bf16 v[144:159], v[176:179], a[96:99], v[144:159]
    v_mfma_f32_32x32x16_bf16 v[160:175], v[176:179], a[224:227], v[160:175]
    s_waitcnt lgkmcnt(6)
    v_mfma_f32_32x32x16_bf16 v[144:159], v[180:183], a[100:103], v[144:159]
    v_mfma_f32_32x32x16_bf16 v[160:175], v[180:183], a[228:231], v[160:175]
    s_waitcnt lgkmcnt(5)
    v_mfma_f32_32x32x16_bf16 v[144:159], v[184:187], a[104:107], v[144:159]
    v_mfma_f32_32x32x16_bf16 v[160:175], v[184:187], a[232:235], v[160:175]
    s_waitcnt lgkmcnt(4)
    v_mfma_f32_32x32x16_bf16 v[144:159], v[188:191], a[108:111], v[144:159]
    v_mfma_f32_32x32x16_bf16 v[160:175], v[188:191], a[236:239], v[160:175]
    s_waitcnt lgkmcnt(3)
    v_mfma_f32_32x32x16_bf16 v[144:159], v[192:195], a[112:115], v[144:159]
    v_mfma_f32_32x32x16_bf16 v[160:175], v[192:195], a[240:243], v[160:175]
    s_waitcnt lgkmcnt(2)
    v_mfma_f32_32x32x16_bf16 v[144:159], v[196:199], a[116:119], v[144:159]
    v_mfma_f32_32x32x16_bf16 v[160:175], v[196:199], a[244:247], v[160:175]
    s_waitcnt lgkmcnt(1)
    v_mfma_f32_32x32x16_bf16 v[144:159], v[200:203], a[120:123], v[144:159]
    v_mfma_f32_32x32x16_bf16 v[160:175], v[200:203], a[248:251], v[160:175]
    s_waitcnt lgkmcnt(0)
    v_mfma_f32_32x32x16_bf16 v[144:159], v[204:207], a[124:127], v[144:159]
    v_mfma_f32_32x32x16_bf16 v[160:175], v[204:207], a[252:255], v[160:175]
    s_nop 13
    v_cvt_pk_bf16_f32 v208, v144, v145
    v_cvt_pk_bf16_f32 v209, v146, v147
    v_cvt_pk_bf16_f32 v210, v152, v153
    v_cvt_pk_bf16_f32 v211, v154, v155
    buffer_store_dwordx4 v[208:211], v8, s[20:23], s47 offen offset:0 sc1
    v_cvt_pk_bf16_f32 v212, v148, v149
    v_cvt_pk_bf16_f32 v213, v150, v151
    v_cvt_pk_bf16_f32 v214, v156, v157
    v_cvt_pk_bf16_f32 v215, v158, v159
    buffer_store_dwordx4 v[212:215], v8, s[20:23], s47 offen offset:512 sc1
    v_cvt_pk_bf16_f32 v216, v160, v161
    v_cvt_pk_bf16_f32 v217, v162, v163
    v_cvt_pk_bf16_f32 v218, v168, v169
    v_cvt_pk_bf16_f32 v219, v170, v171
    buffer_store_dwordx4 v[216:219], v8, s[20:23], s47 offen offset:1024 sc1
    v_cvt_pk_bf16_f32 v220, v164, v165
    v_cvt_pk_bf16_f32 v221, v166, v167
    v_cvt_pk_bf16_f32 v222, v172, v173
    v_cvt_pk_bf16_f32 v223, v174, v175
    buffer_store_dwordx4 v[220:223], v8, s[20:23], s47 offen offset:1536 sc1
bulk_fin:
    s_waitcnt vmcnt(0)
    s_barrier
    s_add_u32 s31, s31, 1
    s_cmp_lg_u32 s40, 0
    s_cbranch_scc1 bulk_nf
    v_mov_b32 v12, s31
    v_mov_b32 v13, s34
    s_mov_b64 exec, 1
    buffer_store_dword v12, v13, s[24:27], 0 offen sc1
    s_mov_b64 exec, -1

bulk_nf:
    s_cmp_lt_u32 s28, s30
    s_cbranch_scc1 bulk_loop
main_f1:
    s_cmp_eq_u32 s97, 7
    s_cbranch_scc1 main_at
    s_cmp_ge_u32 s96, 16
    s_cbranch_scc1 main_f1a
    s_cmp_ge_u32 s97, 5
    s_cbranch_scc1 main_f2
    s_branch main_op
main_at:
    s_mov_b32 s38, s96
    v_lshrrev_b32 v1, 6, v0
    v_and_b32 v0, 63, v0
    v_readfirstlane_b32 s30, v1
    s_mov_b32 s39, s38

    s_add_u32 s8, s4, 0x1000000
    s_addc_u32 s9, s5, 0
    s_mov_b32 s10, 0x1000000
    s_mov_b32 s11, 0x20000
    s_add_u32 s12, s4, 0x2000000
    s_addc_u32 s13, s5, 0
    s_mov_b32 s14, 0x1000000
    s_mov_b32 s15, 0x20000
    s_add_u32 s16, s4, 0x3000000
    s_addc_u32 s17, s5, 0
    s_mov_b32 s18, 0x1000000
    s_mov_b32 s19, 0x20000
    s_add_u32 s20, s4, 0x200000
    s_addc_u32 s21, s5, 0
    s_mov_b32 s22, 0x800000
    s_mov_b32 s23, 0x20000
    s_add_u32 s24, s4, 0xa00000
    s_addc_u32 s25, s5, 0
    s_mov_b32 s26, 0x400000
    s_mov_b32 s27, 0x20000
    s_add_u32 s32, s4, 0x4000000
    s_addc_u32 s33, s5, 0
    s_mov_b32 s34, 0x1000000
    s_mov_b32 s35, 0x20000
    s_mov_b32 s44, s4
    s_mov_b32 s45, s5
    s_mov_b32 s46, 0x10000
    s_mov_b32 s47, 0x20000
    s_lshr_b32 s36, s39, 1
    s_lshl_b32 s36, s36, 2
    s_add_u32 s36, s36, s30
    v_lshl_add_u32 v200, v0, 6, s36
    v_lshlrev_b32 v200, 7, v200
    v_add_u32 v200, 0x4000, v200
    s_lshl_b32 s36, s39, 4
    s_add_u32 s36, s36, 0x9ff0
    v_lshl_add_u32 v201, v0, 2, s36
    v_cmp_le_u32 vcc, 3, v0
    v_cndmask_b32 v200, v200, v201, vcc
    v_cmp_le_u32 vcc, 8, v0
    v_cndmask_b32 v200, v200, 0, vcc
    s_mov_b32 s41, s30

attr_loop:
    s_lshr_b32 s36, s41, 2
    s_add_u32 s36, s36, 1
    s_add_u32 s37, s41, 1
    v_mov_b32 v202, s36
    v_mov_b32 v203, s37
    v_cmp_le_u32 vcc, 3, v0
    v_cndmask_b32 v202, v202, v203, vcc
    v_cmp_eq_u32 vcc, 3, v0
    v_cndmask_b32 v202, v202, 0, vcc
    v_cmp_le_u32 vcc, 8, v0
    v_cndmask_b32 v202, v202, 0, vcc

attr_w:
    buffer_load_dword v203, v200, s[44:47], 0 offen sc1
    s_add_u32 s98, s98, 1
    s_waitcnt vmcnt(0)
    v_cmp_lt_u32 vcc, v203, v202
    s_cmp_gt_u32 s98, 262144
    s_cbranch_scc1 attr_x
    s_cbranch_vccnz attr_w

attr_x:
    s_lshl_b32 s28, s41, 5
    s_add_u32 s28, s28, s39
    v_lshlrev_b32 v1, 4, v0
    v_and_b32 v2, 31, v0
    v_and_b32 v3, 15, v0
    v_lshrrev_b32 v4, 4, v0
    v_lshlrev_b32 v2, 3, v2
    s_lshl_b32 s36, s28, 13
    s_lshl_b32 s37, s28, 12
    s_lshl_b32 s38, s28, 11
    v_add_u32 v5, 0x1000, v1

    buffer_load_dwordx4 v[16:19], v1, s[8:11], s36 offen offset:0 sc1
    buffer_load_dwordx4 v[20:23], v1, s[8:11], s36 offen offset:1024 sc1
    buffer_load_dwordx4 v[24:27], v1, s[8:11], s36 offen offset:2048 sc1
    buffer_load_dwordx4 v[28:31], v1, s[8:11], s36 offen offset:3072 sc1
    buffer_load_dwordx4 v[32:35], v5, s[8:11], s36 offen offset:0 sc1
    buffer_load_dwordx4 v[36:39], v5, s[8:11], s36 offen offset:1024 sc1
    buffer_load_dwordx4 v[40:43], v5, s[8:11], s36 offen offset:2048 sc1
    buffer_load_dwordx4 v[44:47], v5, s[8:11], s36 offen offset:3072 sc1
    buffer_load_dwordx4 v[48:51], v1, s[12:15], s36 offen offset:0 sc1
    buffer_load_dwordx4 v[52:55], v1, s[12:15], s36 offen offset:1024 sc1
    buffer_load_dwordx4 v[56:59], v1, s[12:15], s36 offen offset:2048 sc1
    buffer_load_dwordx4 v[60:63], v1, s[12:15], s36 offen offset:3072 sc1
    buffer_load_dwordx4 v[64:67], v5, s[12:15], s36 offen offset:0 sc1
    buffer_load_dwordx4 v[68:71], v5, s[12:15], s36 offen offset:1024 sc1
    buffer_load_dwordx4 v[72:75], v5, s[12:15], s36 offen offset:2048 sc1
    buffer_load_dwordx4 v[76:79], v5, s[12:15], s36 offen offset:3072 sc1
    buffer_load_dwordx4 v[80:83], v1, s[20:23], s37 offen offset:0 sc1
    buffer_load_dwordx4 v[84:87], v1, s[20:23], s37 offen offset:1024 sc1
    buffer_load_dwordx4 v[88:91], v1, s[20:23], s37 offen offset:2048 sc1
    buffer_load_dwordx4 v[92:95], v1, s[20:23], s37 offen offset:3072 sc1
    buffer_load_dwordx4 v[96:99], v1, s[16:19], s36 offen offset:0 sc1
    buffer_load_dwordx4 v[100:103], v1, s[16:19], s36 offen offset:1024 sc1
    buffer_load_dwordx4 v[104:107], v1, s[16:19], s36 offen offset:2048 sc1
    buffer_load_dwordx4 v[108:111], v1, s[16:19], s36 offen offset:3072 sc1
    buffer_load_dwordx4 v[112:115], v5, s[16:19], s36 offen offset:0 sc1
    buffer_load_dwordx4 v[116:119], v5, s[16:19], s36 offen offset:1024 sc1
    buffer_load_dwordx4 v[120:123], v5, s[16:19], s36 offen offset:2048 sc1
    buffer_load_dwordx4 v[124:127], v5, s[16:19], s36 offen offset:3072 sc1
    buffer_load_dwordx2 v[128:129], v2, s[24:27], s38 offen offset:0 sc1
    buffer_load_dwordx2 v[130:131], v2, s[24:27], s38 offen offset:256 sc1
    buffer_load_dwordx2 v[132:133], v2, s[24:27], s38 offen offset:512 sc1
    buffer_load_dwordx2 v[134:135], v2, s[24:27], s38 offen offset:768 sc1
    buffer_load_dwordx2 v[136:137], v2, s[24:27], s38 offen offset:1024 sc1
    buffer_load_dwordx2 v[138:139], v2, s[24:27], s38 offen offset:1280 sc1
    buffer_load_dwordx2 v[140:141], v2, s[24:27], s38 offen offset:1536 sc1
    buffer_load_dwordx2 v[142:143], v2, s[24:27], s38 offen offset:1792 sc1
    v_mov_b32 v15, 0xff61b1e6
    v_mov_b32 v6, 0
    v_cmp_le_u32 vcc, 32, v0
    v_cndmask_b32 v6, v6, v15, vcc
    v_mov_b32 v7, v6
    v_mov_b32 v8, v6
    v_mov_b32 v9, v6
    v_lshlrev_b32 v14, 2, v4
    s_mov_b32 s40, 0x3e0293ee

    v_add_u32 v10, 0, v14
    v_cmp_gt_u32 vcc, v10, v3
    v_mov_b32 v10, 0
    v_cndmask_b32 v10, v10, v15, vcc
    v_add_u32 v11, 1, v14
    v_cmp_gt_u32 vcc, v11, v3
    v_mov_b32 v11, 0
    v_cndmask_b32 v11, v11, v15, vcc
    v_add_u32 v12, 2, v14
    v_cmp_gt_u32 vcc, v12, v3
    v_mov_b32 v12, 0
    v_cndmask_b32 v12, v12, v15, vcc
    v_add_u32 v13, 3, v14
    v_cmp_gt_u32 vcc, v13, v3
    v_mov_b32 v13, 0
    v_cndmask_b32 v13, v13, v15, vcc
    v_lshrrev_b32 v14, 1, v4
    v_lshlrev_b32 v14, 10, v14
    v_and_b32 v15, 1, v4
    v_lshl_add_u32 v14, v15, 9, v14
    v_lshl_add_u32 v14, v3, 4, v14
    v_add_u32 v15, 0x1000, v14

    s_waitcnt vmcnt(16)
    v_mfma_f32_16x16x32_bf16 v[144:147], v[48:51], v[16:19], v[10:13]
    v_mfma_f32_16x16x32_bf16 v[148:151], v[80:83], v[16:19], v[6:9]
    v_mfma_f32_16x16x32_bf16 v[152:155], v[48:51], v[32:35], 0
    v_mfma_f32_16x16x32_bf16 v[156:159], v[64:67], v[32:35], v[10:13]
    v_mfma_f32_16x16x32_bf16 v[160:163], v[80:83], v[32:35], v[6:9]
    v_mfma_f32_16x16x32_bf16 v[144:147], v[52:55], v[20:23], v[144:147]
    v_mfma_f32_16x16x32_bf16 v[148:151], v[84:87], v[20:23], v[148:151]
    v_mfma_f32_16x16x32_bf16 v[152:155], v[52:55], v[36:39], v[152:155]
    v_mfma_f32_16x16x32_bf16 v[156:159], v[68:71], v[36:39], v[156:159]
    v_mfma_f32_16x16x32_bf16 v[160:163], v[84:87], v[36:39], v[160:163]
    v_mfma_f32_16x16x32_bf16 v[144:147], v[56:59], v[24:27], v[144:147]
    v_mfma_f32_16x16x32_bf16 v[148:151], v[88:91], v[24:27], v[148:151]
    v_mfma_f32_16x16x32_bf16 v[152:155], v[56:59], v[40:43], v[152:155]
    v_mfma_f32_16x16x32_bf16 v[156:159], v[72:75], v[40:43], v[156:159]
    v_mfma_f32_16x16x32_bf16 v[160:163], v[88:91], v[40:43], v[160:163]
    v_mfma_f32_16x16x32_bf16 v[144:147], v[60:63], v[28:31], v[144:147]
    v_mfma_f32_16x16x32_bf16 v[148:151], v[92:95], v[28:31], v[148:151]
    v_mfma_f32_16x16x32_bf16 v[152:155], v[60:63], v[44:47], v[152:155]
    v_mfma_f32_16x16x32_bf16 v[156:159], v[76:79], v[44:47], v[156:159]
    v_mfma_f32_16x16x32_bf16 v[160:163], v[92:95], v[44:47], v[160:163]
    s_nop 7
    v_max3_f32 v178, v144, v145, v146
    v_max3_f32 v178, v147, v148, v178
    v_max3_f32 v178, v149, v150, v178
    v_max_f32 v178, v151, v178
    v_mov_b32 v179, v178
    s_nop 1
    v_permlane16_swap_b32 v178, v179
    s_nop 1
    v_max_f32 v178, v178, v179
    v_mov_b32 v179, v178
    s_nop 1
    v_permlane32_swap_b32 v178, v179
    s_nop 1
    v_max_f32 v178, v178, v179
    v_mul_f32 v178, s40, v178
    v_fma_f32 v144, v144, s40, -v178
    v_fma_f32 v145, v145, s40, -v178
    v_fma_f32 v146, v146, s40, -v178
    v_fma_f32 v147, v147, s40, -v178
    v_fma_f32 v148, v148, s40, -v178
    v_fma_f32 v149, v149, s40, -v178
    v_fma_f32 v150, v150, s40, -v178
    v_fma_f32 v151, v151, s40, -v178
    v_exp_f32 v144, v144
    v_exp_f32 v145, v145
    v_exp_f32 v146, v146
    v_exp_f32 v147, v147
    v_exp_f32 v148, v148
    v_exp_f32 v149, v149
    v_exp_f32 v150, v150
    v_exp_f32 v151, v151
    s_nop 0
    v_cvt_pk_bf16_f32 v164, v144, v145
    v_cvt_pk_bf16_f32 v165, v146, v147
    v_mov_b32 v166, 0
    v_mov_b32 v167, 0
    v_cvt_pk_bf16_f32 v168, v148, v149
    v_cvt_pk_bf16_f32 v169, v150, v151
    v_add_f32 v176, v144, v145
    v_add_f32 v176, v176, v146
    v_add_f32 v176, v176, v147
    v_add_f32 v176, v176, v148
    v_add_f32 v176, v176, v149
    v_add_f32 v176, v176, v150
    v_add_f32 v176, v176, v151
    v_mov_b32 v179, v176
    s_nop 1
    v_permlane16_swap_b32 v176, v179
    s_nop 1
    v_add_f32 v176, v176, v179
    v_mov_b32 v179, v176
    s_nop 1
    v_permlane32_swap_b32 v176, v179
    s_nop 1
    v_add_f32 v176, v176, v179
    v_rcp_f32 v176, v176
    v_max3_f32 v180, v152, v153, v154
    v_max3_f32 v180, v155, v156, v180
    v_max3_f32 v180, v157, v158, v180
    v_max3_f32 v180, v159, v160, v180
    v_max3_f32 v180, v161, v162, v180
    v_max_f32 v180, v163, v180
    v_mov_b32 v181, v180
    s_nop 1
    v_permlane16_swap_b32 v180, v181
    s_nop 1
    v_max_f32 v180, v180, v181
    v_mov_b32 v181, v180
    s_nop 1
    v_permlane32_swap_b32 v180, v181
    s_nop 1
    v_max_f32 v180, v180, v181
    v_mul_f32 v180, s40, v180
    v_fma_f32 v152, v152, s40, -v180
    v_fma_f32 v153, v153, s40, -v180
    v_fma_f32 v154, v154, s40, -v180
    v_fma_f32 v155, v155, s40, -v180
    v_fma_f32 v156, v156, s40, -v180
    v_fma_f32 v157, v157, s40, -v180
    v_fma_f32 v158, v158, s40, -v180
    v_fma_f32 v159, v159, s40, -v180
    v_fma_f32 v160, v160, s40, -v180
    v_fma_f32 v161, v161, s40, -v180
    v_fma_f32 v162, v162, s40, -v180
    v_fma_f32 v163, v163, s40, -v180
    v_exp_f32 v152, v152
    v_exp_f32 v153, v153
    v_exp_f32 v154, v154
    v_exp_f32 v155, v155
    v_exp_f32 v156, v156
    v_exp_f32 v157, v157
    v_exp_f32 v158, v158
    v_exp_f32 v159, v159
    v_exp_f32 v160, v160
    v_exp_f32 v161, v161
    v_exp_f32 v162, v162
    v_exp_f32 v163, v163
    s_nop 0
    v_cvt_pk_bf16_f32 v170, v152, v153
    v_cvt_pk_bf16_f32 v171, v154, v155
    v_cvt_pk_bf16_f32 v172, v156, v157
    v_cvt_pk_bf16_f32 v173, v158, v159
    v_cvt_pk_bf16_f32 v174, v160, v161
    v_cvt_pk_bf16_f32 v175, v162, v163
    v_add_f32 v177, v152, v153
    v_add_f32 v177, v177, v154
    v_add_f32 v177, v177, v155
    v_add_f32 v177, v177, v156
    v_add_f32 v177, v177, v157
    v_add_f32 v177, v177, v158
    v_add_f32 v177, v177, v159
    v_add_f32 v177, v177, v160
    v_add_f32 v177, v177, v161
    v_add_f32 v177, v177, v162
    v_add_f32 v177, v177, v163
    v_mov_b32 v181, v177
    s_nop 1
    v_permlane16_swap_b32 v177, v181
    s_nop 1
    v_add_f32 v177, v177, v181
    v_mov_b32 v181, v177
    s_nop 1
    v_permlane32_swap_b32 v177, v181
    s_nop 1
    v_add_f32 v177, v177, v181
    v_rcp_f32 v177, v177
    s_waitcnt vmcnt(0)
    v_mfma_f32_16x16x32_bf16 v[16:19], v[96:99], v[164:167], 0
    v_mfma_f32_16x16x32_bf16 v[20:23], v[100:103], v[164:167], 0
    v_mfma_f32_16x16x32_bf16 v[24:27], v[104:107], v[164:167], 0
    v_mfma_f32_16x16x32_bf16 v[28:31], v[108:111], v[164:167], 0
    v_mfma_f32_16x16x32_bf16 v[32:35], v[112:115], v[164:167], 0
    v_mfma_f32_16x16x32_bf16 v[36:39], v[116:119], v[164:167], 0
    v_mfma_f32_16x16x32_bf16 v[40:43], v[120:123], v[164:167], 0
    v_mfma_f32_16x16x32_bf16 v[44:47], v[124:127], v[164:167], 0
    v_mfma_f32_16x16x32_bf16 v[48:51], v[96:99], v[170:173], 0
    v_mfma_f32_16x16x32_bf16 v[52:55], v[100:103], v[170:173], 0
    v_mfma_f32_16x16x32_bf16 v[56:59], v[104:107], v[170:173], 0
    v_mfma_f32_16x16x32_bf16 v[60:63], v[108:111], v[170:173], 0
    v_mfma_f32_16x16x32_bf16 v[64:67], v[112:115], v[170:173], 0
    v_mfma_f32_16x16x32_bf16 v[68:71], v[116:119], v[170:173], 0
    v_mfma_f32_16x16x32_bf16 v[72:75], v[120:123], v[170:173], 0
    v_mfma_f32_16x16x32_bf16 v[76:79], v[124:127], v[170:173], 0
    v_mfma_f32_16x16x16_bf16 v[16:19], v[128:129], v[168:169], v[16:19]
    v_mfma_f32_16x16x16_bf16 v[20:23], v[130:131], v[168:169], v[20:23]
    v_mfma_f32_16x16x16_bf16 v[24:27], v[132:133], v[168:169], v[24:27]
    v_mfma_f32_16x16x16_bf16 v[28:31], v[134:135], v[168:169], v[28:31]
    v_mfma_f32_16x16x16_bf16 v[32:35], v[136:137], v[168:169], v[32:35]
    v_mfma_f32_16x16x16_bf16 v[36:39], v[138:139], v[168:169], v[36:39]
    v_mfma_f32_16x16x16_bf16 v[40:43], v[140:141], v[168:169], v[40:43]
    v_mfma_f32_16x16x16_bf16 v[44:47], v[142:143], v[168:169], v[44:47]
    v_mfma_f32_16x16x16_bf16 v[48:51], v[128:129], v[174:175], v[48:51]
    v_mfma_f32_16x16x16_bf16 v[52:55], v[130:131], v[174:175], v[52:55]
    v_mfma_f32_16x16x16_bf16 v[56:59], v[132:133], v[174:175], v[56:59]
    v_mfma_f32_16x16x16_bf16 v[60:63], v[134:135], v[174:175], v[60:63]
    v_mfma_f32_16x16x16_bf16 v[64:67], v[136:137], v[174:175], v[64:67]
    v_mfma_f32_16x16x16_bf16 v[68:71], v[138:139], v[174:175], v[68:71]
    v_mfma_f32_16x16x16_bf16 v[72:75], v[140:141], v[174:175], v[72:75]
    v_mfma_f32_16x16x16_bf16 v[76:79], v[142:143], v[174:175], v[76:79]
    s_lshl_b32 s36, s28, 13
    s_nop 7
    v_mul_f32 v16, v16, v176
    v_mul_f32 v20, v20, v176
    v_mul_f32 v17, v17, v176
    v_mul_f32 v21, v21, v176
    v_mul_f32 v18, v18, v176
    v_mul_f32 v22, v22, v176
    v_mul_f32 v19, v19, v176
    v_mul_f32 v23, v23, v176
    v_cvt_pk_bf16_f32 v80, v16, v20
    v_cvt_pk_bf16_f32 v81, v17, v21
    v_cvt_pk_bf16_f32 v82, v18, v22
    v_cvt_pk_bf16_f32 v83, v19, v23
    buffer_store_dwordx4 v[80:83], v14, s[32:35], s36 offen offset:0 sc1
    v_mul_f32 v24, v24, v176
    v_mul_f32 v28, v28, v176
    v_mul_f32 v25, v25, v176
    v_mul_f32 v29, v29, v176
    v_mul_f32 v26, v26, v176
    v_mul_f32 v30, v30, v176
    v_mul_f32 v27, v27, v176
    v_mul_f32 v31, v31, v176
    v_cvt_pk_bf16_f32 v84, v24, v28
    v_cvt_pk_bf16_f32 v85, v25, v29
    v_cvt_pk_bf16_f32 v86, v26, v30
    v_cvt_pk_bf16_f32 v87, v27, v31
    buffer_store_dwordx4 v[84:87], v14, s[32:35], s36 offen offset:2048 sc1
    v_mul_f32 v32, v32, v176
    v_mul_f32 v36, v36, v176
    v_mul_f32 v33, v33, v176
    v_mul_f32 v37, v37, v176
    v_mul_f32 v34, v34, v176
    v_mul_f32 v38, v38, v176
    v_mul_f32 v35, v35, v176
    v_mul_f32 v39, v39, v176
    v_cvt_pk_bf16_f32 v88, v32, v36
    v_cvt_pk_bf16_f32 v89, v33, v37
    v_cvt_pk_bf16_f32 v90, v34, v38
    v_cvt_pk_bf16_f32 v91, v35, v39
    buffer_store_dwordx4 v[88:91], v15, s[32:35], s36 offen offset:0 sc1
    v_mul_f32 v40, v40, v176
    v_mul_f32 v44, v44, v176
    v_mul_f32 v41, v41, v176
    v_mul_f32 v45, v45, v176
    v_mul_f32 v42, v42, v176
    v_mul_f32 v46, v46, v176
    v_mul_f32 v43, v43, v176
    v_mul_f32 v47, v47, v176
    v_cvt_pk_bf16_f32 v92, v40, v44
    v_cvt_pk_bf16_f32 v93, v41, v45
    v_cvt_pk_bf16_f32 v94, v42, v46
    v_cvt_pk_bf16_f32 v95, v43, v47
    buffer_store_dwordx4 v[92:95], v15, s[32:35], s36 offen offset:2048 sc1
    v_mul_f32 v48, v48, v177
    v_mul_f32 v52, v52, v177
    v_mul_f32 v49, v49, v177
    v_mul_f32 v53, v53, v177
    v_mul_f32 v50, v50, v177
    v_mul_f32 v54, v54, v177
    v_mul_f32 v51, v51, v177
    v_mul_f32 v55, v55, v177
    v_cvt_pk_bf16_f32 v96, v48, v52
    v_cvt_pk_bf16_f32 v97, v49, v53
    v_cvt_pk_bf16_f32 v98, v50, v54
    v_cvt_pk_bf16_f32 v99, v51, v55
    buffer_store_dwordx4 v[96:99], v14, s[32:35], s36 offen offset:256 sc1
    v_mul_f32 v56, v56, v177
    v_mul_f32 v60, v60, v177
    v_mul_f32 v57, v57, v177
    v_mul_f32 v61, v61, v177
    v_mul_f32 v58, v58, v177
    v_mul_f32 v62, v62, v177
    v_mul_f32 v59, v59, v177
    v_mul_f32 v63, v63, v177
    v_cvt_pk_bf16_f32 v100, v56, v60
    v_cvt_pk_bf16_f32 v101, v57, v61
    v_cvt_pk_bf16_f32 v102, v58, v62
    v_cvt_pk_bf16_f32 v103, v59, v63
    buffer_store_dwordx4 v[100:103], v14, s[32:35], s36 offen offset:2304 sc1
    v_mul_f32 v64, v64, v177
    v_mul_f32 v68, v68, v177
    v_mul_f32 v65, v65, v177
    v_mul_f32 v69, v69, v177
    v_mul_f32 v66, v66, v177
    v_mul_f32 v70, v70, v177
    v_mul_f32 v67, v67, v177
    v_mul_f32 v71, v71, v177
    v_cvt_pk_bf16_f32 v104, v64, v68
    v_cvt_pk_bf16_f32 v105, v65, v69
    v_cvt_pk_bf16_f32 v106, v66, v70
    v_cvt_pk_bf16_f32 v107, v67, v71
    buffer_store_dwordx4 v[104:107], v15, s[32:35], s36 offen offset:256 sc1
    v_mul_f32 v72, v72, v177
    v_mul_f32 v76, v76, v177
    v_mul_f32 v73, v73, v177
    v_mul_f32 v77, v77, v177
    v_mul_f32 v74, v74, v177
    v_mul_f32 v78, v78, v177
    v_mul_f32 v75, v75, v177
    v_mul_f32 v79, v79, v177
    v_cvt_pk_bf16_f32 v108, v72, v76
    v_cvt_pk_bf16_f32 v109, v73, v77
    v_cvt_pk_bf16_f32 v110, v74, v78
    v_cvt_pk_bf16_f32 v111, v75, v79
    buffer_store_dwordx4 v[108:111], v15, s[32:35], s36 offen offset:2304 sc1
    s_lshl_b32 s65, s41, 4
    s_add_u32 s65, s65, 0xa400
    s_waitcnt vmcnt(0)
    v_mov_b32 v250, 0
    v_mov_b32 v251, 1
    s_mov_b64 exec, 1
    buffer_atomic_add v251, v250, s[44:47], s65 offen sc1
    s_mov_b64 exec, -1
    s_add_u32 s41, s41, 4
    s_cmp_lt_u32 s41, 64
    s_cbranch_scc1 attr_loop
    s_sub_u32 s69, s68, 223
    s_branch main_done
main_op:
    s_sub_u32 s38, s97, 1
    s_lshl_b32 s38, s38, 4
    s_add_u32 s38, s38, s96
    v_lshrrev_b32 v1, 6, v0
    v_and_b32 v0, 63, v0
    v_readfirstlane_b32 s30, v1
    s_and_b32 s29, s38, 15
    s_lshr_b32 s28, s38, 4

    s_load_dwordx2 s[40:41], s[0:1], 0
    s_waitcnt lgkmcnt(0)

    s_add_u32 s8, s4, 0x5a00000
    s_addc_u32 s9, s5, 0
    s_mov_b32 s10, 0x400000
    s_mov_b32 s11, 0x20000
    s_add_u32 s12, s4, 0x4000000
    s_addc_u32 s13, s5, 0
    s_mov_b32 s14, 0x1000000
    s_mov_b32 s15, 0x20000
    s_mov_b32 s16, s40
    s_mov_b32 s17, s41
    s_mov_b32 s18, 0x200000
    s_mov_b32 s19, 0x20000
    s_add_u32 s20, s4, 0x5000000
    s_addc_u32 s21, s5, 0
    s_mov_b32 s22, 0x200000
    s_mov_b32 s23, 0x20000
    s_mov_b32 s24, s4
    s_mov_b32 s25, s5
    s_mov_b32 s26, 0x10000
    s_mov_b32 s27, 0x20000
    s_lshl_b32 s31, s30, 6
    v_and_b32 v1, 31, v0
    v_lshrrev_b32 v2, 5, v0
    v_lshlrev_b32 v3, 4, v0
    s_lshr_b32 s36, s29, 1
    s_mul_i32 s36, s36, 524288
    s_and_b32 s37, s29, 1
    s_lshl_b32 s37, s37, 10
    s_add_u32 s36, s36, s37
    s_lshl_b32 s37, s31, 11
    s_add_u32 s32, s36, s37

    buffer_load_dwordx4 a[0:3], v3, s[8:11], s32 offen offset:0
    buffer_load_dwordx4 a[4:7], v3, s[8:11], s32 offen offset:2048
    s_add_u32 s32, s32, 0x1000
    buffer_load_dwordx4 a[8:11], v3, s[8:11], s32 offen offset:0
    buffer_load_dwordx4 a[12:15], v3, s[8:11], s32 offen offset:2048
    s_add_u32 s32, s32, 0x1000
    buffer_load_dwordx4 a[16:19], v3, s[8:11], s32 offen offset:0
    buffer_load_dwordx4 a[20:23], v3, s[8:11], s32 offen offset:2048
    s_add_u32 s32, s32, 0x1000
    buffer_load_dwordx4 a[24:27], v3, s[8:11], s32 offen offset:0
    buffer_load_dwordx4 a[28:31], v3, s[8:11], s32 offen offset:2048
    s_add_u32 s32, s32, 0x1000
    buffer_load_dwordx4 a[32:35], v3, s[8:11], s32 offen offset:0
    buffer_load_dwordx4 a[36:39], v3, s[8:11], s32 offen offset:2048
    s_add_u32 s32, s32, 0x1000
    buffer_load_dwordx4 a[40:43], v3, s[8:11], s32 offen offset:0
    buffer_load_dwordx4 a[44:47], v3, s[8:11], s32 offen offset:2048
    s_add_u32 s32, s32, 0x1000
    buffer_load_dwordx4 a[48:51], v3, s[8:11], s32 offen offset:0
    buffer_load_dwordx4 a[52:55], v3, s[8:11], s32 offen offset:2048
    s_add_u32 s32, s32, 0x1000
    buffer_load_dwordx4 a[56:59], v3, s[8:11], s32 offen offset:0
    buffer_load_dwordx4 a[60:63], v3, s[8:11], s32 offen offset:2048
    s_add_u32 s32, s32, 0x1000
    buffer_load_dwordx4 a[64:67], v3, s[8:11], s32 offen offset:0
    buffer_load_dwordx4 a[68:71], v3, s[8:11], s32 offen offset:2048
    s_add_u32 s32, s32, 0x1000
    buffer_load_dwordx4 a[72:75], v3, s[8:11], s32 offen offset:0
    buffer_load_dwordx4 a[76:79], v3, s[8:11], s32 offen offset:2048
    s_add_u32 s32, s32, 0x1000
    buffer_load_dwordx4 a[80:83], v3, s[8:11], s32 offen offset:0
    buffer_load_dwordx4 a[84:87], v3, s[8:11], s32 offen offset:2048
    s_add_u32 s32, s32, 0x1000
    buffer_load_dwordx4 a[88:91], v3, s[8:11], s32 offen offset:0
    buffer_load_dwordx4 a[92:95], v3, s[8:11], s32 offen offset:2048
    s_add_u32 s32, s32, 0x1000
    buffer_load_dwordx4 a[96:99], v3, s[8:11], s32 offen offset:0
    buffer_load_dwordx4 a[100:103], v3, s[8:11], s32 offen offset:2048
    s_add_u32 s32, s32, 0x1000
    buffer_load_dwordx4 a[104:107], v3, s[8:11], s32 offen offset:0
    buffer_load_dwordx4 a[108:111], v3, s[8:11], s32 offen offset:2048
    s_add_u32 s32, s32, 0x1000
    buffer_load_dwordx4 a[112:115], v3, s[8:11], s32 offen offset:0
    buffer_load_dwordx4 a[116:119], v3, s[8:11], s32 offen offset:2048
    s_add_u32 s32, s32, 0x1000
    buffer_load_dwordx4 a[120:123], v3, s[8:11], s32 offen offset:0
    buffer_load_dwordx4 a[124:127], v3, s[8:11], s32 offen offset:2048
    s_add_u32 s32, s32, 0x1000
    buffer_load_dwordx4 a[128:131], v3, s[8:11], s32 offen offset:0
    buffer_load_dwordx4 a[132:135], v3, s[8:11], s32 offen offset:2048
    s_add_u32 s32, s32, 0x1000
    buffer_load_dwordx4 a[136:139], v3, s[8:11], s32 offen offset:0
    buffer_load_dwordx4 a[140:143], v3, s[8:11], s32 offen offset:2048
    s_add_u32 s32, s32, 0x1000
    buffer_load_dwordx4 a[144:147], v3, s[8:11], s32 offen offset:0
    buffer_load_dwordx4 a[148:151], v3, s[8:11], s32 offen offset:2048
    s_add_u32 s32, s32, 0x1000
    buffer_load_dwordx4 a[152:155], v3, s[8:11], s32 offen offset:0
    buffer_load_dwordx4 a[156:159], v3, s[8:11], s32 offen offset:2048
    s_add_u32 s32, s32, 0x1000
    buffer_load_dwordx4 a[160:163], v3, s[8:11], s32 offen offset:0
    buffer_load_dwordx4 a[164:167], v3, s[8:11], s32 offen offset:2048
    s_add_u32 s32, s32, 0x1000
    buffer_load_dwordx4 a[168:171], v3, s[8:11], s32 offen offset:0
    buffer_load_dwordx4 a[172:175], v3, s[8:11], s32 offen offset:2048
    s_add_u32 s32, s32, 0x1000
    buffer_load_dwordx4 a[176:179], v3, s[8:11], s32 offen offset:0
    buffer_load_dwordx4 a[180:183], v3, s[8:11], s32 offen offset:2048
    s_add_u32 s32, s32, 0x1000
    buffer_load_dwordx4 a[184:187], v3, s[8:11], s32 offen offset:0
    buffer_load_dwordx4 a[188:191], v3, s[8:11], s32 offen offset:2048
    s_add_u32 s32, s32, 0x1000
    buffer_load_dwordx4 a[192:195], v3, s[8:11], s32 offen offset:0
    buffer_load_dwordx4 a[196:199], v3, s[8:11], s32 offen offset:2048
    s_add_u32 s32, s32, 0x1000
    buffer_load_dwordx4 a[200:203], v3, s[8:11], s32 offen offset:0
    buffer_load_dwordx4 a[204:207], v3, s[8:11], s32 offen offset:2048
    s_add_u32 s32, s32, 0x1000
    buffer_load_dwordx4 a[208:211], v3, s[8:11], s32 offen offset:0
    buffer_load_dwordx4 a[212:215], v3, s[8:11], s32 offen offset:2048
    s_add_u32 s32, s32, 0x1000
    buffer_load_dwordx4 a[216:219], v3, s[8:11], s32 offen offset:0
    buffer_load_dwordx4 a[220:223], v3, s[8:11], s32 offen offset:2048
    s_add_u32 s32, s32, 0x1000
    buffer_load_dwordx4 a[224:227], v3, s[8:11], s32 offen offset:0
    buffer_load_dwordx4 a[228:231], v3, s[8:11], s32 offen offset:2048
    s_add_u32 s32, s32, 0x1000
    buffer_load_dwordx4 a[232:235], v3, s[8:11], s32 offen offset:0
    buffer_load_dwordx4 a[236:239], v3, s[8:11], s32 offen offset:2048
    s_add_u32 s32, s32, 0x1000
    buffer_load_dwordx4 a[240:243], v3, s[8:11], s32 offen offset:0
    buffer_load_dwordx4 a[244:247], v3, s[8:11], s32 offen offset:2048
    s_add_u32 s32, s32, 0x1000
    buffer_load_dwordx4 a[248:251], v3, s[8:11], s32 offen offset:0
    buffer_load_dwordx4 a[252:255], v3, s[8:11], s32 offen offset:2048
    s_add_u32 s32, s32, 0x1000
    s_and_b32 s34, s30, 1
    s_lshl_b32 s34, s34, 5
    s_lshl_b32 s35, s29, 6
    s_add_u32 s35, s35, s34
    s_lshl_b32 s37, s35, 1
    s_add_u32 s37, s37, 4096
    v_lshlrev_b32 v7, 5, v2
    buffer_load_dwordx4 v[8:11], v7, s[24:27], s37 offen
    buffer_load_dwordx4 v[12:15], v7, s[24:27], s37 offen offset:16
    v_lshlrev_b32 v6, 10, v1
    v_lshl_add_u32 v6, v2, 4, v6
    s_lshl_b32 s37, s30, 12
    v_add_u32 v4, s37, v3
    s_lshl_b32 s37, s34, 6
    v_add_u32 v5, s37, v3
    s_mov_b32 s44, 0xffff0000

oprojs_loop:
    s_lshl_b32 s65, s28, 4
    s_add_u32 s65, s65, 0xa400
    v_mov_b32 v250, 0
oprojs_w:
    buffer_load_dword v251, v250, s[24:27], s65 offen sc1
    s_add_u32 s98, s98, 1
    s_waitcnt vmcnt(0)
    v_readfirstlane_b32 s66, v251
    s_cmp_gt_u32 s98, 262144
    s_cbranch_scc1 oprojs_w_x
    s_cmp_lt_u32 s66, 32
    s_cbranch_scc1 oprojs_w
oprojs_w_x:
    s_lshl_b32 s36, s28, 15
    s_add_u32 s36, s36, s35
    s_mul_i32 s33, s28, 256
    s_add_u32 s33, s33, s31
    s_lshl_b32 s33, s33, 10
    buffer_load_dwordx4 v[32:35], v6, s[16:19], s36 offen

    buffer_load_dwordx4 v[40:43], v3, s[12:15], s33 offen offset:0
    buffer_load_dwordx4 v[44:47], v3, s[12:15], s33 offen offset:1024
    buffer_load_dwordx4 v[48:51], v3, s[12:15], s33 offen offset:2048
    buffer_load_dwordx4 v[52:55], v3, s[12:15], s33 offen offset:3072
    s_add_u32 s33, s33, 0x1000
    buffer_load_dwordx4 v[56:59], v3, s[12:15], s33 offen offset:0
    buffer_load_dwordx4 v[60:63], v3, s[12:15], s33 offen offset:1024
    buffer_load_dwordx4 v[64:67], v3, s[12:15], s33 offen offset:2048
    buffer_load_dwordx4 v[68:71], v3, s[12:15], s33 offen offset:3072
    s_add_u32 s33, s33, 0x1000
    buffer_load_dwordx4 v[72:75], v3, s[12:15], s33 offen offset:0
    buffer_load_dwordx4 v[76:79], v3, s[12:15], s33 offen offset:1024
    buffer_load_dwordx4 v[80:83], v3, s[12:15], s33 offen offset:2048
    buffer_load_dwordx4 v[84:87], v3, s[12:15], s33 offen offset:3072
    s_add_u32 s33, s33, 0x1000
    buffer_load_dwordx4 v[88:91], v3, s[12:15], s33 offen offset:0
    buffer_load_dwordx4 v[92:95], v3, s[12:15], s33 offen offset:1024
    buffer_load_dwordx4 v[96:99], v3, s[12:15], s33 offen offset:2048
    buffer_load_dwordx4 v[100:103], v3, s[12:15], s33 offen offset:3072
    s_add_u32 s33, s33, 0x1000
    buffer_load_dwordx4 v[104:107], v3, s[12:15], s33 offen offset:0
    buffer_load_dwordx4 v[108:111], v3, s[12:15], s33 offen offset:1024
    buffer_load_dwordx4 v[112:115], v3, s[12:15], s33 offen offset:2048
    buffer_load_dwordx4 v[116:119], v3, s[12:15], s33 offen offset:3072
    s_add_u32 s33, s33, 0x1000
    buffer_load_dwordx4 v[120:123], v3, s[12:15], s33 offen offset:0
    buffer_load_dwordx4 v[124:127], v3, s[12:15], s33 offen offset:1024
    buffer_load_dwordx4 v[128:131], v3, s[12:15], s33 offen offset:2048
    buffer_load_dwordx4 v[132:135], v3, s[12:15], s33 offen offset:3072
    s_add_u32 s33, s33, 0x1000
    buffer_load_dwordx4 v[136:139], v3, s[12:15], s33 offen offset:0
    buffer_load_dwordx4 v[140:143], v3, s[12:15], s33 offen offset:1024
    buffer_load_dwordx4 v[144:147], v3, s[12:15], s33 offen offset:2048
    buffer_load_dwordx4 v[148:151], v3, s[12:15], s33 offen offset:3072
    s_add_u32 s33, s33, 0x1000
    buffer_load_dwordx4 v[152:155], v3, s[12:15], s33 offen offset:0
    buffer_load_dwordx4 v[156:159], v3, s[12:15], s33 offen offset:1024
    buffer_load_dwordx4 v[160:163], v3, s[12:15], s33 offen offset:2048
    buffer_load_dwordx4 v[164:167], v3, s[12:15], s33 offen offset:3072
    s_add_u32 s33, s33, 0x1000
    buffer_load_dwordx4 v[168:171], v3, s[12:15], s33 offen offset:0
    buffer_load_dwordx4 v[172:175], v3, s[12:15], s33 offen offset:1024
    buffer_load_dwordx4 v[176:179], v3, s[12:15], s33 offen offset:2048
    buffer_load_dwordx4 v[180:183], v3, s[12:15], s33 offen offset:3072
    s_add_u32 s33, s33, 0x1000
    buffer_load_dwordx4 v[184:187], v3, s[12:15], s33 offen offset:0
    buffer_load_dwordx4 v[188:191], v3, s[12:15], s33 offen offset:1024
    buffer_load_dwordx4 v[192:195], v3, s[12:15], s33 offen offset:2048
    buffer_load_dwordx4 v[196:199], v3, s[12:15], s33 offen offset:3072
    s_add_u32 s33, s33, 0x1000
    buffer_load_dwordx4 v[200:203], v3, s[12:15], s33 offen offset:0
    buffer_load_dwordx4 v[204:207], v3, s[12:15], s33 offen offset:1024
    buffer_load_dwordx4 v[208:211], v3, s[12:15], s33 offen offset:2048
    buffer_load_dwordx4 v[212:215], v3, s[12:15], s33 offen offset:3072
    s_add_u32 s33, s33, 0x1000
    buffer_load_dwordx4 v[216:219], v3, s[12:15], s33 offen offset:0
    buffer_load_dwordx4 v[220:223], v3, s[12:15], s33 offen offset:1024
    buffer_load_dwordx4 v[224:227], v3, s[12:15], s33 offen offset:2048
    buffer_load_dwordx4 v[228:231], v3, s[12:15], s33 offen offset:3072
    s_add_u32 s33, s33, 0x1000
    buffer_load_dwordx4 v[232:235], v3, s[12:15], s33 offen offset:0
    buffer_load_dwordx4 v[236:239], v3, s[12:15], s33 offen offset:1024
    buffer_load_dwordx4 v[240:243], v3, s[12:15], s33 offen offset:2048
    buffer_load_dwordx4 v[244:247], v3, s[12:15], s33 offen offset:3072
    s_add_u32 s33, s33, 0x1000
    buffer_load_dwordx4 v[248:251], v3, s[12:15], s33 offen offset:0
    buffer_load_dwordx4 v[252:255], v3, s[12:15], s33 offen offset:1024
    s_waitcnt vmcnt(53)
    v_mfma_f32_32x32x16_bf16 v[16:31], a[0:3], v[40:43], 0
    buffer_load_dwordx4 v[40:43], v3, s[12:15], s33 offen offset:2048
    s_waitcnt vmcnt(53)
    v_mfma_f32_32x32x16_bf16 v[16:31], a[4:7], v[44:47], v[16:31]
    buffer_load_dwordx4 v[44:47], v3, s[12:15], s33 offen offset:3072
    s_add_u32 s33, s33, 0x1000
    s_waitcnt vmcnt(53)
    v_mfma_f32_32x32x16_bf16 v[16:31], a[8:11], v[48:51], v[16:31]
    buffer_load_dwordx4 v[48:51], v3, s[12:15], s33 offen offset:0
    s_waitcnt vmcnt(53)
    v_mfma_f32_32x32x16_bf16 v[16:31], a[12:15], v[52:55], v[16:31]
    buffer_load_dwordx4 v[52:55], v3, s[12:15], s33 offen offset:1024
    s_waitcnt vmcnt(53)
    v_mfma_f32_32x32x16_bf16 v[16:31], a[16:19], v[56:59], v[16:31]
    buffer_load_dwordx4 v[56:59], v3, s[12:15], s33 offen offset:2048
    s_waitcnt vmcnt(53)
    v_mfma_f32_32x32x16_bf16 v[16:31], a[20:23], v[60:63], v[16:31]
    buffer_load_dwordx4 v[60:63], v3, s[12:15], s33 offen offset:3072
    s_add_u32 s33, s33, 0x1000
    s_waitcnt vmcnt(53)
    v_mfma_f32_32x32x16_bf16 v[16:31], a[24:27], v[64:67], v[16:31]
    buffer_load_dwordx4 v[64:67], v3, s[12:15], s33 offen offset:0
    s_waitcnt vmcnt(53)
    v_mfma_f32_32x32x16_bf16 v[16:31], a[28:31], v[68:71], v[16:31]
    buffer_load_dwordx4 v[68:71], v3, s[12:15], s33 offen offset:1024
    s_waitcnt vmcnt(53)
    v_mfma_f32_32x32x16_bf16 v[16:31], a[32:35], v[72:75], v[16:31]
    buffer_load_dwordx4 v[72:75], v3, s[12:15], s33 offen offset:2048
    s_waitcnt vmcnt(53)
    v_mfma_f32_32x32x16_bf16 v[16:31], a[36:39], v[76:79], v[16:31]
    buffer_load_dwordx4 v[76:79], v3, s[12:15], s33 offen offset:3072
    s_add_u32 s33, s33, 0x1000
    s_waitcnt vmcnt(53)
    v_mfma_f32_32x32x16_bf16 v[16:31], a[40:43], v[80:83], v[16:31]
    s_waitcnt vmcnt(52)
    v_mfma_f32_32x32x16_bf16 v[16:31], a[44:47], v[84:87], v[16:31]
    s_waitcnt vmcnt(51)
    v_mfma_f32_32x32x16_bf16 v[16:31], a[48:51], v[88:91], v[16:31]
    s_waitcnt vmcnt(50)
    v_mfma_f32_32x32x16_bf16 v[16:31], a[52:55], v[92:95], v[16:31]
    s_waitcnt vmcnt(49)
    v_mfma_f32_32x32x16_bf16 v[16:31], a[56:59], v[96:99], v[16:31]
    s_waitcnt vmcnt(48)
    v_mfma_f32_32x32x16_bf16 v[16:31], a[60:63], v[100:103], v[16:31]
    s_waitcnt vmcnt(47)
    v_mfma_f32_32x32x16_bf16 v[16:31], a[64:67], v[104:107], v[16:31]
    s_waitcnt vmcnt(46)
    v_mfma_f32_32x32x16_bf16 v[16:31], a[68:71], v[108:111], v[16:31]
    s_waitcnt vmcnt(45)
    v_mfma_f32_32x32x16_bf16 v[16:31], a[72:75], v[112:115], v[16:31]
    s_waitcnt vmcnt(44)
    v_mfma_f32_32x32x16_bf16 v[16:31], a[76:79], v[116:119], v[16:31]
    s_waitcnt vmcnt(43)
    v_mfma_f32_32x32x16_bf16 v[16:31], a[80:83], v[120:123], v[16:31]
    s_waitcnt vmcnt(42)
    v_mfma_f32_32x32x16_bf16 v[16:31], a[84:87], v[124:127], v[16:31]
    s_waitcnt vmcnt(41)
    v_mfma_f32_32x32x16_bf16 v[16:31], a[88:91], v[128:131], v[16:31]
    s_waitcnt vmcnt(40)
    v_mfma_f32_32x32x16_bf16 v[16:31], a[92:95], v[132:135], v[16:31]
    s_waitcnt vmcnt(39)
    v_mfma_f32_32x32x16_bf16 v[16:31], a[96:99], v[136:139], v[16:31]
    s_waitcnt vmcnt(38)
    v_mfma_f32_32x32x16_bf16 v[16:31], a[100:103], v[140:143], v[16:31]
    s_waitcnt vmcnt(37)
    v_mfma_f32_32x32x16_bf16 v[16:31], a[104:107], v[144:147], v[16:31]
    s_waitcnt vmcnt(36)
    v_mfma_f32_32x32x16_bf16 v[16:31], a[108:111], v[148:151], v[16:31]
    s_waitcnt vmcnt(35)
    v_mfma_f32_32x32x16_bf16 v[16:31], a[112:115], v[152:155], v[16:31]
    s_waitcnt vmcnt(34)
    v_mfma_f32_32x32x16_bf16 v[16:31], a[116:119], v[156:159], v[16:31]
    s_waitcnt vmcnt(33)
    v_mfma_f32_32x32x16_bf16 v[16:31], a[120:123], v[160:163], v[16:31]
    s_waitcnt vmcnt(32)
    v_mfma_f32_32x32x16_bf16 v[16:31], a[124:127], v[164:167], v[16:31]
    s_waitcnt vmcnt(31)
    v_mfma_f32_32x32x16_bf16 v[16:31], a[128:131], v[168:171], v[16:31]
    s_waitcnt vmcnt(30)
    v_mfma_f32_32x32x16_bf16 v[16:31], a[132:135], v[172:175], v[16:31]
    s_waitcnt vmcnt(29)
    v_mfma_f32_32x32x16_bf16 v[16:31], a[136:139], v[176:179], v[16:31]
    s_waitcnt vmcnt(28)
    v_mfma_f32_32x32x16_bf16 v[16:31], a[140:143], v[180:183], v[16:31]
    s_waitcnt vmcnt(27)
    v_mfma_f32_32x32x16_bf16 v[16:31], a[144:147], v[184:187], v[16:31]
    s_waitcnt vmcnt(26)
    v_mfma_f32_32x32x16_bf16 v[16:31], a[148:151], v[188:191], v[16:31]
    s_waitcnt vmcnt(25)
    v_mfma_f32_32x32x16_bf16 v[16:31], a[152:155], v[192:195], v[16:31]
    s_waitcnt vmcnt(24)
    v_mfma_f32_32x32x16_bf16 v[16:31], a[156:159], v[196:199], v[16:31]
    s_waitcnt vmcnt(23)
    v_mfma_f32_32x32x16_bf16 v[16:31], a[160:163], v[200:203], v[16:31]
    s_waitcnt vmcnt(22)
    v_mfma_f32_32x32x16_bf16 v[16:31], a[164:167], v[204:207], v[16:31]
    s_waitcnt vmcnt(21)
    v_mfma_f32_32x32x16_bf16 v[16:31], a[168:171], v[208:211], v[16:31]
    s_waitcnt vmcnt(20)
    v_mfma_f32_32x32x16_bf16 v[16:31], a[172:175], v[212:215], v[16:31]
    s_waitcnt vmcnt(19)
    v_mfma_f32_32x32x16_bf16 v[16:31], a[176:179], v[216:219], v[16:31]
    s_waitcnt vmcnt(18)
    v_mfma_f32_32x32x16_bf16 v[16:31], a[180:183], v[220:223], v[16:31]
    s_waitcnt vmcnt(17)
    v_mfma_f32_32x32x16_bf16 v[16:31], a[184:187], v[224:227], v[16:31]
    s_waitcnt vmcnt(16)
    v_mfma_f32_32x32x16_bf16 v[16:31], a[188:191], v[228:231], v[16:31]
    s_waitcnt vmcnt(15)
    v_mfma_f32_32x32x16_bf16 v[16:31], a[192:195], v[232:235], v[16:31]
    s_waitcnt vmcnt(14)
    v_mfma_f32_32x32x16_bf16 v[16:31], a[196:199], v[236:239], v[16:31]
    s_waitcnt vmcnt(13)
    v_mfma_f32_32x32x16_bf16 v[16:31], a[200:203], v[240:243], v[16:31]
    s_waitcnt vmcnt(12)
    v_mfma_f32_32x32x16_bf16 v[16:31], a[204:207], v[244:247], v[16:31]
    s_waitcnt vmcnt(11)
    v_mfma_f32_32x32x16_bf16 v[16:31], a[208:211], v[248:251], v[16:31]
    s_waitcnt vmcnt(10)
    v_mfma_f32_32x32x16_bf16 v[16:31], a[212:215], v[252:255], v[16:31]
    s_waitcnt vmcnt(9)
    v_mfma_f32_32x32x16_bf16 v[16:31], a[216:219], v[40:43], v[16:31]
    s_waitcnt vmcnt(8)
    v_mfma_f32_32x32x16_bf16 v[16:31], a[220:223], v[44:47], v[16:31]
    s_waitcnt vmcnt(7)
    v_mfma_f32_32x32x16_bf16 v[16:31], a[224:227], v[48:51], v[16:31]
    s_waitcnt vmcnt(6)
    v_mfma_f32_32x32x16_bf16 v[16:31], a[228:231], v[52:55], v[16:31]
    s_waitcnt vmcnt(5)
    v_mfma_f32_32x32x16_bf16 v[16:31], a[232:235], v[56:59], v[16:31]
    s_waitcnt vmcnt(4)
    v_mfma_f32_32x32x16_bf16 v[16:31], a[236:239], v[60:63], v[16:31]
    s_waitcnt vmcnt(3)
    v_mfma_f32_32x32x16_bf16 v[16:31], a[240:243], v[64:67], v[16:31]
    s_waitcnt vmcnt(2)
    v_mfma_f32_32x32x16_bf16 v[16:31], a[244:247], v[68:71], v[16:31]
    s_waitcnt vmcnt(1)
    v_mfma_f32_32x32x16_bf16 v[16:31], a[248:251], v[72:75], v[16:31]
    s_waitcnt vmcnt(0)
    v_mfma_f32_32x32x16_bf16 v[16:31], a[252:255], v[76:79], v[16:31]
oprojs_red:
    s_waitcnt vmcnt(0)
    s_nop 7
    s_nop 3
    ds_write_b128 v4, v[16:19] offset:0
    ds_write_b128 v4, v[20:23] offset:1024
    ds_write_b128 v4, v[24:27] offset:2048
    ds_write_b128 v4, v[28:31] offset:3072
    s_waitcnt lgkmcnt(0)
    s_barrier
    s_cmp_ge_u32 s30, 2
    s_cbranch_scc1 oprojs_skip
    ds_read_b128 v[40:43], v5 offset:0
    ds_read_b128 v[44:47], v5 offset:1024
    ds_read_b128 v[48:51], v5 offset:4096
    ds_read_b128 v[52:55], v5 offset:5120
    ds_read_b128 v[56:59], v5 offset:8192
    ds_read_b128 v[60:63], v5 offset:9216
    ds_read_b128 v[64:67], v5 offset:12288
    ds_read_b128 v[68:71], v5 offset:13312
    s_waitcnt lgkmcnt(0)
    v_add_f32 v40, v40, v48
    v_add_f32 v56, v56, v64
    v_add_f32 v41, v41, v49
    v_add_f32 v57, v57, v65
    v_add_f32 v42, v42, v50
    v_add_f32 v58, v58, v66
    v_add_f32 v43, v43, v51
    v_add_f32 v59, v59, v67
    v_add_f32 v44, v44, v52
    v_add_f32 v60, v60, v68
    v_add_f32 v45, v45, v53
    v_add_f32 v61, v61, v69
    v_add_f32 v46, v46, v54
    v_add_f32 v62, v62, v70
    v_add_f32 v47, v47, v55
    v_add_f32 v63, v63, v71
    v_add_f32 v40, v40, v56
    v_add_f32 v41, v41, v57
    v_add_f32 v42, v42, v58
    v_add_f32 v43, v43, v59
    v_add_f32 v44, v44, v60
    v_add_f32 v45, v45, v61
    v_add_f32 v46, v46, v62
    v_add_f32 v47, v47, v63
    v_cvt_pk_bf16_f32 v36, v40, v41
    v_lshlrev_b32 v40, 16, v36
    v_and_b32 v41, s44, v36
    v_mul_f32 v40, v40, v8
    v_mul_f32 v41, v41, v9
    v_cvt_pk_bf16_f32 v36, v40, v41
    v_lshlrev_b32 v40, 16, v36
    v_and_b32 v41, s44, v36
    v_lshlrev_b32 v37, 16, v32
    v_and_b32 v38, s44, v32
    v_add_f32 v40, v40, v37
    v_add_f32 v41, v41, v38
    v_cvt_pk_bf16_f32 v72, v40, v41
    v_cvt_pk_bf16_f32 v36, v42, v43
    v_lshlrev_b32 v42, 16, v36
    v_and_b32 v43, s44, v36
    v_mul_f32 v42, v42, v10
    v_mul_f32 v43, v43, v11
    v_cvt_pk_bf16_f32 v36, v42, v43
    v_lshlrev_b32 v42, 16, v36
    v_and_b32 v43, s44, v36
    v_lshlrev_b32 v37, 16, v33
    v_and_b32 v38, s44, v33
    v_add_f32 v42, v42, v37
    v_add_f32 v43, v43, v38
    v_cvt_pk_bf16_f32 v73, v42, v43
    v_cvt_pk_bf16_f32 v36, v44, v45
    v_lshlrev_b32 v44, 16, v36
    v_and_b32 v45, s44, v36
    v_mul_f32 v44, v44, v12
    v_mul_f32 v45, v45, v13
    v_cvt_pk_bf16_f32 v36, v44, v45
    v_lshlrev_b32 v44, 16, v36
    v_and_b32 v45, s44, v36
    v_lshlrev_b32 v37, 16, v34
    v_and_b32 v38, s44, v34
    v_add_f32 v44, v44, v37
    v_add_f32 v45, v45, v38
    v_cvt_pk_bf16_f32 v74, v44, v45
    v_cvt_pk_bf16_f32 v36, v46, v47
    v_lshlrev_b32 v46, 16, v36
    v_and_b32 v47, s44, v36
    v_mul_f32 v46, v46, v14
    v_mul_f32 v47, v47, v15
    v_cvt_pk_bf16_f32 v36, v46, v47
    v_lshlrev_b32 v46, 16, v36
    v_and_b32 v47, s44, v36
    v_lshlrev_b32 v37, 16, v35
    v_and_b32 v38, s44, v35
    v_add_f32 v46, v46, v37
    v_add_f32 v47, v47, v38
    v_cvt_pk_bf16_f32 v75, v46, v47
    buffer_store_dwordx4 v[72:75], v6, s[20:23], s36 offen sc1
oprojs_skip:
    s_lshl_b32 s65, s28, 4
    s_add_u32 s65, s65, 0xa800
    s_waitcnt vmcnt(0)
    s_barrier
    s_cmp_lg_u32 s30, 0
    s_cbranch_scc1 oprojs_b
    v_mov_b32 v250, 0
    v_mov_b32 v251, 1
    s_mov_b64 exec, 1
    buffer_atomic_add v251, v250, s[24:27], s65 offen sc1
    s_mov_b64 exec, -1
oprojs_b:
    s_add_u32 s28, s28, 4
    s_cmp_lt_u32 s28, 64
    s_cbranch_scc1 oprojs_loop
    s_sub_u32 s69, s68, 108
    s_branch main_done
main_f2:
    s_sub_u32 s38, s97, 5
    s_lshl_b32 s38, s38, 4
    s_add_u32 s38, s38, s96
    v_lshrrev_b32 v1, 6, v0
    v_and_b32 v0, 63, v0
    v_readfirstlane_b32 s30, v1
    s_and_b32 s29, s38, 15
    s_lshr_b32 s28, s38, 4

    s_load_dwordx2 s[40:41], s[0:1], 104
    s_waitcnt lgkmcnt(0)

    s_add_u32 s8, s4, 0x5e00000
    s_addc_u32 s9, s5, 0
    s_mov_b32 s10, 0x158000
    s_mov_b32 s11, 0x20000
    s_add_u32 s12, s4, 0x5400000
    s_addc_u32 s13, s5, 0
    s_mov_b32 s14, 0x560000
    s_mov_b32 s15, 0x20000
    s_add_u32 s16, s4, 0x5000000
    s_addc_u32 s17, s5, 0
    s_mov_b32 s18, 0x200000
    s_mov_b32 s19, 0x20000
    s_mov_b32 s20, s40
    s_mov_b32 s21, s41
    s_mov_b32 s22, 0x200000
    s_mov_b32 s23, 0x20000
    s_mov_b32 s24, s4
    s_mov_b32 s25, s5
    s_mov_b32 s26, 0x10000
    s_mov_b32 s27, 0x20000
    s_mul_i32 s31, s30, 22
    s_cmp_eq_u32 s30, 3
    s_cselect_b32 s36, 1, 0
    s_sub_u32 s31, s31, s36
    v_and_b32 v1, 31, v0
    v_lshrrev_b32 v2, 5, v0
    v_lshlrev_b32 v3, 4, v0
    s_lshr_b32 s36, s29, 1
    s_mul_i32 s36, s36, 176128
    s_and_b32 s37, s29, 1
    s_lshl_b32 s37, s37, 10
    s_add_u32 s36, s36, s37
    s_lshl_b32 s37, s31, 11
    s_add_u32 s32, s36, s37

    buffer_load_dwordx4 a[0:3], v3, s[8:11], s32 offen offset:0
    buffer_load_dwordx4 a[4:7], v3, s[8:11], s32 offen offset:2048
    s_add_u32 s32, s32, 0x1000
    buffer_load_dwordx4 a[8:11], v3, s[8:11], s32 offen offset:0
    buffer_load_dwordx4 a[12:15], v3, s[8:11], s32 offen offset:2048
    s_add_u32 s32, s32, 0x1000
    buffer_load_dwordx4 a[16:19], v3, s[8:11], s32 offen offset:0
    buffer_load_dwordx4 a[20:23], v3, s[8:11], s32 offen offset:2048
    s_add_u32 s32, s32, 0x1000
    buffer_load_dwordx4 a[24:27], v3, s[8:11], s32 offen offset:0
    buffer_load_dwordx4 a[28:31], v3, s[8:11], s32 offen offset:2048
    s_add_u32 s32, s32, 0x1000
    buffer_load_dwordx4 a[32:35], v3, s[8:11], s32 offen offset:0
    buffer_load_dwordx4 a[36:39], v3, s[8:11], s32 offen offset:2048
    s_add_u32 s32, s32, 0x1000
    buffer_load_dwordx4 a[40:43], v3, s[8:11], s32 offen offset:0
    buffer_load_dwordx4 a[44:47], v3, s[8:11], s32 offen offset:2048
    s_add_u32 s32, s32, 0x1000
    buffer_load_dwordx4 a[48:51], v3, s[8:11], s32 offen offset:0
    buffer_load_dwordx4 a[52:55], v3, s[8:11], s32 offen offset:2048
    s_add_u32 s32, s32, 0x1000
    buffer_load_dwordx4 a[56:59], v3, s[8:11], s32 offen offset:0
    buffer_load_dwordx4 a[60:63], v3, s[8:11], s32 offen offset:2048
    s_add_u32 s32, s32, 0x1000
    buffer_load_dwordx4 a[64:67], v3, s[8:11], s32 offen offset:0
    buffer_load_dwordx4 a[68:71], v3, s[8:11], s32 offen offset:2048
    s_add_u32 s32, s32, 0x1000
    buffer_load_dwordx4 a[72:75], v3, s[8:11], s32 offen offset:0
    buffer_load_dwordx4 a[76:79], v3, s[8:11], s32 offen offset:2048
    s_add_u32 s32, s32, 0x1000
    buffer_load_dwordx4 a[80:83], v3, s[8:11], s32 offen offset:0
    buffer_load_dwordx4 a[84:87], v3, s[8:11], s32 offen offset:2048
    s_add_u32 s32, s32, 0x1000
    s_and_b32 s34, s30, 1
    s_lshl_b32 s34, s34, 5
    s_lshl_b32 s35, s29, 6
    s_add_u32 s35, s35, s34
    s_lshl_b32 s37, s35, 1
    s_add_u32 s37, s37, 10240
    v_lshlrev_b32 v7, 5, v2
    buffer_load_dwordx4 v[8:11], v7, s[24:27], s37 offen
    buffer_load_dwordx4 v[12:15], v7, s[24:27], s37 offen offset:16
    v_lshlrev_b32 v6, 10, v1
    v_lshl_add_u32 v6, v2, 4, v6
    s_lshl_b32 s37, s30, 12
    v_add_u32 v4, s37, v3
    s_lshl_b32 s37, s34, 6
    v_add_u32 v5, s37, v3
    s_mov_b32 s44, 0xffff0000

ffn2s_loop:
    s_lshl_b32 s65, s28, 4
    s_add_u32 s65, s65, 0xac00
    v_mov_b32 v250, 0
ffn2s_w:
    buffer_load_dword v251, v250, s[24:27], s65 offen sc1
    s_add_u32 s98, s98, 1
    s_waitcnt vmcnt(0)
    v_readfirstlane_b32 s66, v251
    s_cmp_gt_u32 s98, 262144
    s_cbranch_scc1 ffn2s_w_x
    s_cmp_lt_u32 s66, 11
    s_cbranch_scc1 ffn2s_w
ffn2s_w_x:
    s_lshl_b32 s36, s28, 15
    s_add_u32 s36, s36, s35
    s_mul_i32 s33, s28, 86
    s_add_u32 s33, s33, s31
    s_lshl_b32 s33, s33, 10
    buffer_load_dwordx4 v[32:35], v6, s[16:19], s36 offen sc1

    s_cmp_ge_u32 s30, 2
    s_cbranch_scc1 ffn2s_nl
    s_add_u32 s37, s33, 21504
    buffer_load_dwordx4 v[124:127], v3, s[12:15], s37 offen
ffn2s_nl:
    buffer_load_dwordx4 v[40:43], v3, s[12:15], s33 offen offset:0
    buffer_load_dwordx4 v[44:47], v3, s[12:15], s33 offen offset:1024
    buffer_load_dwordx4 v[48:51], v3, s[12:15], s33 offen offset:2048
    buffer_load_dwordx4 v[52:55], v3, s[12:15], s33 offen offset:3072
    s_add_u32 s33, s33, 0x1000
    buffer_load_dwordx4 v[56:59], v3, s[12:15], s33 offen offset:0
    buffer_load_dwordx4 v[60:63], v3, s[12:15], s33 offen offset:1024
    buffer_load_dwordx4 v[64:67], v3, s[12:15], s33 offen offset:2048
    buffer_load_dwordx4 v[68:71], v3, s[12:15], s33 offen offset:3072
    s_add_u32 s33, s33, 0x1000
    buffer_load_dwordx4 v[72:75], v3, s[12:15], s33 offen offset:0
    buffer_load_dwordx4 v[76:79], v3, s[12:15], s33 offen offset:1024
    buffer_load_dwordx4 v[80:83], v3, s[12:15], s33 offen offset:2048
    buffer_load_dwordx4 v[84:87], v3, s[12:15], s33 offen offset:3072
    s_add_u32 s33, s33, 0x1000
    buffer_load_dwordx4 v[88:91], v3, s[12:15], s33 offen offset:0
    buffer_load_dwordx4 v[92:95], v3, s[12:15], s33 offen offset:1024
    buffer_load_dwordx4 v[96:99], v3, s[12:15], s33 offen offset:2048
    buffer_load_dwordx4 v[100:103], v3, s[12:15], s33 offen offset:3072
    s_add_u32 s33, s33, 0x1000
    buffer_load_dwordx4 v[104:107], v3, s[12:15], s33 offen offset:0
    buffer_load_dwordx4 v[108:111], v3, s[12:15], s33 offen offset:1024
    buffer_load_dwordx4 v[112:115], v3, s[12:15], s33 offen offset:2048
    buffer_load_dwordx4 v[116:119], v3, s[12:15], s33 offen offset:3072
    s_add_u32 s33, s33, 0x1000
    buffer_load_dwordx4 v[120:123], v3, s[12:15], s33 offen offset:0
    s_waitcnt vmcnt(20)
    v_mfma_f32_32x32x16_bf16 v[16:31], a[0:3], v[40:43], 0
    s_waitcnt vmcnt(19)
    v_mfma_f32_32x32x16_bf16 v[16:31], a[4:7], v[44:47], v[16:31]
    s_waitcnt vmcnt(18)
    v_mfma_f32_32x32x16_bf16 v[16:31], a[8:11], v[48:51], v[16:31]
    s_waitcnt vmcnt(17)
    v_mfma_f32_32x32x16_bf16 v[16:31], a[12:15], v[52:55], v[16:31]
    s_waitcnt vmcnt(16)
    v_mfma_f32_32x32x16_bf16 v[16:31], a[16:19], v[56:59], v[16:31]
    s_waitcnt vmcnt(15)
    v_mfma_f32_32x32x16_bf16 v[16:31], a[20:23], v[60:63], v[16:31]
    s_waitcnt vmcnt(14)
    v_mfma_f32_32x32x16_bf16 v[16:31], a[24:27], v[64:67], v[16:31]
    s_waitcnt vmcnt(13)
    v_mfma_f32_32x32x16_bf16 v[16:31], a[28:31], v[68:71], v[16:31]
    s_waitcnt vmcnt(12)
    v_mfma_f32_32x32x16_bf16 v[16:31], a[32:35], v[72:75], v[16:31]
    s_waitcnt vmcnt(11)
    v_mfma_f32_32x32x16_bf16 v[16:31], a[36:39], v[76:79], v[16:31]
    s_waitcnt vmcnt(10)
    v_mfma_f32_32x32x16_bf16 v[16:31], a[40:43], v[80:83], v[16:31]
    s_waitcnt vmcnt(9)
    v_mfma_f32_32x32x16_bf16 v[16:31], a[44:47], v[84:87], v[16:31]
    s_waitcnt vmcnt(8)
    v_mfma_f32_32x32x16_bf16 v[16:31], a[48:51], v[88:91], v[16:31]
    s_waitcnt vmcnt(7)
    v_mfma_f32_32x32x16_bf16 v[16:31], a[52:55], v[92:95], v[16:31]
    s_waitcnt vmcnt(6)
    v_mfma_f32_32x32x16_bf16 v[16:31], a[56:59], v[96:99], v[16:31]
    s_waitcnt vmcnt(5)
    v_mfma_f32_32x32x16_bf16 v[16:31], a[60:63], v[100:103], v[16:31]
    s_waitcnt vmcnt(4)
    v_mfma_f32_32x32x16_bf16 v[16:31], a[64:67], v[104:107], v[16:31]
    s_waitcnt vmcnt(3)
    v_mfma_f32_32x32x16_bf16 v[16:31], a[68:71], v[108:111], v[16:31]
    s_waitcnt vmcnt(2)
    v_mfma_f32_32x32x16_bf16 v[16:31], a[72:75], v[112:115], v[16:31]
    s_waitcnt vmcnt(1)
    v_mfma_f32_32x32x16_bf16 v[16:31], a[76:79], v[116:119], v[16:31]
    s_waitcnt vmcnt(0)
    v_mfma_f32_32x32x16_bf16 v[16:31], a[80:83], v[120:123], v[16:31]
    s_cmp_ge_u32 s30, 2
    s_cbranch_scc1 ffn2s_red
    v_mfma_f32_32x32x16_bf16 v[16:31], a[84:87], v[124:127], v[16:31]
ffn2s_red:
    s_waitcnt vmcnt(0)
    s_nop 7
    s_nop 3
    ds_write_b128 v4, v[16:19] offset:0
    ds_write_b128 v4, v[20:23] offset:1024
    ds_write_b128 v4, v[24:27] offset:2048
    ds_write_b128 v4, v[28:31] offset:3072
    s_waitcnt lgkmcnt(0)
    s_barrier
    s_cmp_ge_u32 s30, 2
    s_cbranch_scc1 ffn2s_skip
    ds_read_b128 v[40:43], v5 offset:0
    ds_read_b128 v[44:47], v5 offset:1024
    ds_read_b128 v[48:51], v5 offset:4096
    ds_read_b128 v[52:55], v5 offset:5120
    ds_read_b128 v[56:59], v5 offset:8192
    ds_read_b128 v[60:63], v5 offset:9216
    ds_read_b128 v[64:67], v5 offset:12288
    ds_read_b128 v[68:71], v5 offset:13312
    s_waitcnt lgkmcnt(0)
    v_add_f32 v40, v40, v48
    v_add_f32 v56, v56, v64
    v_add_f32 v41, v41, v49
    v_add_f32 v57, v57, v65
    v_add_f32 v42, v42, v50
    v_add_f32 v58, v58, v66
    v_add_f32 v43, v43, v51
    v_add_f32 v59, v59, v67
    v_add_f32 v44, v44, v52
    v_add_f32 v60, v60, v68
    v_add_f32 v45, v45, v53
    v_add_f32 v61, v61, v69
    v_add_f32 v46, v46, v54
    v_add_f32 v62, v62, v70
    v_add_f32 v47, v47, v55
    v_add_f32 v63, v63, v71
    v_add_f32 v40, v40, v56
    v_add_f32 v41, v41, v57
    v_add_f32 v42, v42, v58
    v_add_f32 v43, v43, v59
    v_add_f32 v44, v44, v60
    v_add_f32 v45, v45, v61
    v_add_f32 v46, v46, v62
    v_add_f32 v47, v47, v63
    v_cvt_pk_bf16_f32 v36, v40, v41
    v_lshlrev_b32 v40, 16, v36
    v_and_b32 v41, s44, v36
    v_mul_f32 v40, v40, v8
    v_mul_f32 v41, v41, v9
    v_cvt_pk_bf16_f32 v36, v40, v41
    v_lshlrev_b32 v40, 16, v36
    v_and_b32 v41, s44, v36
    v_lshlrev_b32 v37, 16, v32
    v_and_b32 v38, s44, v32
    v_add_f32 v40, v40, v37
    v_add_f32 v41, v41, v38
    v_cvt_pk_bf16_f32 v72, v40, v41
    v_cvt_pk_bf16_f32 v36, v42, v43
    v_lshlrev_b32 v42, 16, v36
    v_and_b32 v43, s44, v36
    v_mul_f32 v42, v42, v10
    v_mul_f32 v43, v43, v11
    v_cvt_pk_bf16_f32 v36, v42, v43
    v_lshlrev_b32 v42, 16, v36
    v_and_b32 v43, s44, v36
    v_lshlrev_b32 v37, 16, v33
    v_and_b32 v38, s44, v33
    v_add_f32 v42, v42, v37
    v_add_f32 v43, v43, v38
    v_cvt_pk_bf16_f32 v73, v42, v43
    v_cvt_pk_bf16_f32 v36, v44, v45
    v_lshlrev_b32 v44, 16, v36
    v_and_b32 v45, s44, v36
    v_mul_f32 v44, v44, v12
    v_mul_f32 v45, v45, v13
    v_cvt_pk_bf16_f32 v36, v44, v45
    v_lshlrev_b32 v44, 16, v36
    v_and_b32 v45, s44, v36
    v_lshlrev_b32 v37, 16, v34
    v_and_b32 v38, s44, v34
    v_add_f32 v44, v44, v37
    v_add_f32 v45, v45, v38
    v_cvt_pk_bf16_f32 v74, v44, v45
    v_cvt_pk_bf16_f32 v36, v46, v47
    v_lshlrev_b32 v46, 16, v36
    v_and_b32 v47, s44, v36
    v_mul_f32 v46, v46, v14
    v_mul_f32 v47, v47, v15
    v_cvt_pk_bf16_f32 v36, v46, v47
    v_lshlrev_b32 v46, 16, v36
    v_and_b32 v47, s44, v36
    v_lshlrev_b32 v37, 16, v35
    v_and_b32 v38, s44, v35
    v_add_f32 v46, v46, v37
    v_add_f32 v47, v47, v38
    v_cvt_pk_bf16_f32 v75, v46, v47
    buffer_store_dwordx4 v[72:75], v6, s[20:23], s36 offen
ffn2s_skip:
    s_barrier
    s_add_u32 s28, s28, 2
    s_cmp_lt_u32 s28, 64
    s_cbranch_scc1 ffn2s_loop
    s_sub_u32 s69, s68, 110
    s_branch main_done
main_f1a:
    s_cmp_ge_u32 s96, 27
    s_cbranch_scc1 main_done
    s_sub_u32 s38, s97, 1
    s_mul_i32 s38, s38, 11
    s_add_u32 s38, s38, s96
    s_sub_u32 s38, s38, 16
    s_load_dwordx2 s[12:13], s[0:1], 64
    s_load_dwordx2 s[14:15], s[0:1], 72
    s_mul_hi_u32 s28, s38, 390451573
    s_mul_i32 s35, s28, 11
    s_sub_u32 s37, s38, s35
    s_waitcnt lgkmcnt(0)

    s_mov_b32 s8, s12
    s_mov_b32 s9, s13
    s_mov_b32 s10, 0x158000
    s_mov_b32 s11, 0x20000
    s_mov_b32 s12, s14
    s_mov_b32 s13, s15
    s_mov_b32 s14, s10
    s_mov_b32 s15, s11
    s_add_u32 s16, s4, 0x5000000
    s_addc_u32 s17, s5, 0
    s_mov_b32 s18, 0x200000
    s_mov_b32 s19, 0x20000
    s_add_u32 s20, s4, 0x5400000
    s_addc_u32 s21, s5, 0
    s_mov_b32 s22, 0x560000
    s_mov_b32 s23, 0x20000
    s_mov_b32 s24, s4
    s_mov_b32 s25, s5
    s_mov_b32 s26, 0x10000
    s_mov_b32 s27, 0x20000
    v_lshrrev_b32 v1, 6, v0
    s_nop 0
    v_readfirstlane_b32 s40, v1
    s_mov_b32 s29, 6
    s_mov_b32 s30, 64

    v_and_b32 v1, 63, v0
    v_lshlrev_b32 v3, 4, v1
    s_lshl_b32 s41, s40, 13
    v_add_u32 v3, s41, v3
    v_add_u32 v4, 0x1000, v3
    s_mul_i32 s41, s40, 8320
    v_lshlrev_b32 v5, 4, v1
    v_add_u32 v5, s41, v5
    v_and_b32 v9, 31, v1
    v_lshrrev_b32 v10, 5, v1
    v_mul_u32_u24 v6, 1040, v9
    v_lshl_add_u32 v6, v10, 4, v6
    v_lshlrev_b32 v11, 5, v1
    v_add_u32 v11, 6144, v11
    buffer_load_dwordx4 v[136:139], v11, s[24:27], 0 offen
    buffer_load_dwordx4 v[140:143], v11, s[24:27], 0 offen offset:16
    buffer_load_dwordx4 v[128:131], v11, s[24:27], 0 offen offset:2048
    buffer_load_dwordx4 v[132:135], v11, s[24:27], 0 offen offset:2064
    s_mov_b32 s42, 0x05040100
    s_mov_b32 s43, 0x07060302
    s_mov_b32 s44, 0xffff0000

    s_lshl_b32 s35, s37, 2
    s_add_u32 s35, s35, s40
    s_cmp_ge_u32 s35, 43
    s_cselect_b32 s32, 1, 0
    s_cselect_b32 s35, 0, s35
    s_lshl_b32 s33, s35, 11
    s_lshl_b32 s41, s35, 6
    v_mul_u32_u24 v2, 22016, v10
    v_and_b32 v12, 15, v1
    v_lshl_add_u32 v2, v12, 2, v2
    v_add_u32 v2, s41, v2
    v_lshlrev_b32 v7, 4, v1
    v_and_b32 v12, 16, v1
    v_cmp_eq_u32 vcc, 0, v12
    s_mov_b64 s[36:37], vcc
    s_not_b64 s[38:39], vcc

    s_mov_b64 exec, s[36:37]
    s_mov_b32 s41, 0
    buffer_load_dword v48, v2, s[8:11], s41 offen
    s_mov_b32 s41, 2752
    buffer_load_dword v49, v2, s[8:11], s41 offen
    s_mov_b32 s41, 5504
    buffer_load_dword v50, v2, s[8:11], s41 offen
    s_mov_b32 s41, 8256
    buffer_load_dword v51, v2, s[8:11], s41 offen
    s_mov_b32 s41, 11008
    buffer_load_dword v52, v2, s[8:11], s41 offen
    s_mov_b32 s41, 13760
    buffer_load_dword v53, v2, s[8:11], s41 offen
    s_mov_b32 s41, 16512
    buffer_load_dword v54, v2, s[8:11], s41 offen
    s_mov_b32 s41, 19264
    buffer_load_dword v55, v2, s[8:11], s41 offen
    s_mov_b32 s41, 44032
    buffer_load_dword v56, v2, s[8:11], s41 offen
    s_mov_b32 s41, 46784
    buffer_load_dword v57, v2, s[8:11], s41 offen
    s_mov_b32 s41, 49536
    buffer_load_dword v58, v2, s[8:11], s41 offen
    s_mov_b32 s41, 52288
    buffer_load_dword v59, v2, s[8:11], s41 offen
    s_mov_b32 s41, 55040
    buffer_load_dword v60, v2, s[8:11], s41 offen
    s_mov_b32 s41, 57792
    buffer_load_dword v61, v2, s[8:11], s41 offen
    s_mov_b32 s41, 60544
    buffer_load_dword v62, v2, s[8:11], s41 offen
    s_mov_b32 s41, 63296
    buffer_load_dword v63, v2, s[8:11], s41 offen
    s_mov_b32 s41, 88064
    buffer_load_dword v64, v2, s[8:11], s41 offen
    s_mov_b32 s41, 90816
    buffer_load_dword v65, v2, s[8:11], s41 offen
    s_mov_b32 s41, 93568
    buffer_load_dword v66, v2, s[8:11], s41 offen
    s_mov_b32 s41, 96320
    buffer_load_dword v67, v2, s[8:11], s41 offen
    s_mov_b32 s41, 99072
    buffer_load_dword v68, v2, s[8:11], s41 offen
    s_mov_b32 s41, 101824
    buffer_load_dword v69, v2, s[8:11], s41 offen
    s_mov_b32 s41, 104576
    buffer_load_dword v70, v2, s[8:11], s41 offen
    s_mov_b32 s41, 107328
    buffer_load_dword v71, v2, s[8:11], s41 offen
    s_mov_b32 s41, 132096
    buffer_load_dword v72, v2, s[8:11], s41 offen
    s_mov_b32 s41, 134848
    buffer_load_dword v73, v2, s[8:11], s41 offen
    s_mov_b32 s41, 137600
    buffer_load_dword v74, v2, s[8:11], s41 offen
    s_mov_b32 s41, 140352
    buffer_load_dword v75, v2, s[8:11], s41 offen
    s_mov_b32 s41, 143104
    buffer_load_dword v76, v2, s[8:11], s41 offen
    s_mov_b32 s41, 145856
    buffer_load_dword v77, v2, s[8:11], s41 offen
    s_mov_b32 s41, 148608
    buffer_load_dword v78, v2, s[8:11], s41 offen
    s_mov_b32 s41, 151360
    buffer_load_dword v79, v2, s[8:11], s41 offen
    s_mov_b64 exec, s[38:39]
    s_mov_b32 s41, 0
    buffer_load_dword v48, v2, s[12:15], s41 offen
    s_mov_b32 s41, 2752
    buffer_load_dword v49, v2, s[12:15], s41 offen
    s_mov_b32 s41, 5504
    buffer_load_dword v50, v2, s[12:15], s41 offen
    s_mov_b32 s41, 8256
    buffer_load_dword v51, v2, s[12:15], s41 offen
    s_mov_b32 s41, 11008
    buffer_load_dword v52, v2, s[12:15], s41 offen
    s_mov_b32 s41, 13760
    buffer_load_dword v53, v2, s[12:15], s41 offen
    s_mov_b32 s41, 16512
    buffer_load_dword v54, v2, s[12:15], s41 offen
    s_mov_b32 s41, 19264
    buffer_load_dword v55, v2, s[12:15], s41 offen
    s_mov_b32 s41, 44032
    buffer_load_dword v56, v2, s[12:15], s41 offen
    s_mov_b32 s41, 46784
    buffer_load_dword v57, v2, s[12:15], s41 offen
    s_mov_b32 s41, 49536
    buffer_load_dword v58, v2, s[12:15], s41 offen
    s_mov_b32 s41, 52288
    buffer_load_dword v59, v2, s[12:15], s41 offen
    s_mov_b32 s41, 55040
    buffer_load_dword v60, v2, s[12:15], s41 offen
    s_mov_b32 s41, 57792
    buffer_load_dword v61, v2, s[12:15], s41 offen
    s_mov_b32 s41, 60544
    buffer_load_dword v62, v2, s[12:15], s41 offen
    s_mov_b32 s41, 63296
    buffer_load_dword v63, v2, s[12:15], s41 offen
    s_mov_b32 s41, 88064
    buffer_load_dword v64, v2, s[12:15], s41 offen
    s_mov_b32 s41, 90816
    buffer_load_dword v65, v2, s[12:15], s41 offen
    s_mov_b32 s41, 93568
    buffer_load_dword v66, v2, s[12:15], s41 offen
    s_mov_b32 s41, 96320
    buffer_load_dword v67, v2, s[12:15], s41 offen
    s_mov_b32 s41, 99072
    buffer_load_dword v68, v2, s[12:15], s41 offen
    s_mov_b32 s41, 101824
    buffer_load_dword v69, v2, s[12:15], s41 offen
    s_mov_b32 s41, 104576
    buffer_load_dword v70, v2, s[12:15], s41 offen
    s_mov_b32 s41, 107328
    buffer_load_dword v71, v2, s[12:15], s41 offen
    s_mov_b32 s41, 132096
    buffer_load_dword v72, v2, s[12:15], s41 offen
    s_mov_b32 s41, 134848
    buffer_load_dword v73, v2, s[12:15], s41 offen
    s_mov_b32 s41, 137600
    buffer_load_dword v74, v2, s[12:15], s41 offen
    s_mov_b32 s41, 140352
    buffer_load_dword v75, v2, s[12:15], s41 offen
    s_mov_b32 s41, 143104
    buffer_load_dword v76, v2, s[12:15], s41 offen
    s_mov_b32 s41, 145856
    buffer_load_dword v77, v2, s[12:15], s41 offen
    s_mov_b32 s41, 148608
    buffer_load_dword v78, v2, s[12:15], s41 offen
    s_mov_b32 s41, 151360
    buffer_load_dword v79, v2, s[12:15], s41 offen
    s_mov_b64 exec, -1
    s_waitcnt vmcnt(0)
    s_mov_b64 exec, s[36:37]
    s_mov_b32 s41, 176128
    buffer_load_dword v80, v2, s[8:11], s41 offen
    s_mov_b32 s41, 178880
    buffer_load_dword v81, v2, s[8:11], s41 offen
    s_mov_b32 s41, 181632
    buffer_load_dword v82, v2, s[8:11], s41 offen
    s_mov_b32 s41, 184384
    buffer_load_dword v83, v2, s[8:11], s41 offen
    s_mov_b32 s41, 187136
    buffer_load_dword v84, v2, s[8:11], s41 offen
    s_mov_b32 s41, 189888
    buffer_load_dword v85, v2, s[8:11], s41 offen
    s_mov_b32 s41, 192640
    buffer_load_dword v86, v2, s[8:11], s41 offen
    s_mov_b32 s41, 195392
    buffer_load_dword v87, v2, s[8:11], s41 offen
    s_mov_b32 s41, 220160
    buffer_load_dword v88, v2, s[8:11], s41 offen
    s_mov_b32 s41, 222912
    buffer_load_dword v89, v2, s[8:11], s41 offen
    s_mov_b32 s41, 225664
    buffer_load_dword v90, v2, s[8:11], s41 offen
    s_mov_b32 s41, 228416
    buffer_load_dword v91, v2, s[8:11], s41 offen
    s_mov_b32 s41, 231168
    buffer_load_dword v92, v2, s[8:11], s41 offen
    s_mov_b32 s41, 233920
    buffer_load_dword v93, v2, s[8:11], s41 offen
    s_mov_b32 s41, 236672
    buffer_load_dword v94, v2, s[8:11], s41 offen
    s_mov_b32 s41, 239424
    buffer_load_dword v95, v2, s[8:11], s41 offen
    s_mov_b32 s41, 264192
    buffer_load_dword v96, v2, s[8:11], s41 offen
    s_mov_b32 s41, 266944
    buffer_load_dword v97, v2, s[8:11], s41 offen
    s_mov_b32 s41, 269696
    buffer_load_dword v98, v2, s[8:11], s41 offen
    s_mov_b32 s41, 272448
    buffer_load_dword v99, v2, s[8:11], s41 offen
    s_mov_b32 s41, 275200
    buffer_load_dword v100, v2, s[8:11], s41 offen
    s_mov_b32 s41, 277952
    buffer_load_dword v101, v2, s[8:11], s41 offen
    s_mov_b32 s41, 280704
    buffer_load_dword v102, v2, s[8:11], s41 offen
    s_mov_b32 s41, 283456
    buffer_load_dword v103, v2, s[8:11], s41 offen
    s_mov_b32 s41, 308224
    buffer_load_dword v104, v2, s[8:11], s41 offen
    s_mov_b32 s41, 310976
    buffer_load_dword v105, v2, s[8:11], s41 offen
    s_mov_b32 s41, 313728
    buffer_load_dword v106, v2, s[8:11], s41 offen
    s_mov_b32 s41, 316480
    buffer_load_dword v107, v2, s[8:11], s41 offen
    s_mov_b32 s41, 319232
    buffer_load_dword v108, v2, s[8:11], s41 offen
    s_mov_b32 s41, 321984
    buffer_load_dword v109, v2, s[8:11], s41 offen
    s_mov_b32 s41, 324736
    buffer_load_dword v110, v2, s[8:11], s41 offen
    s_mov_b32 s41, 327488
    buffer_load_dword v111, v2, s[8:11], s41 offen
    s_mov_b64 exec, s[38:39]
    s_mov_b32 s41, 176128
    buffer_load_dword v80, v2, s[12:15], s41 offen
    s_mov_b32 s41, 178880
    buffer_load_dword v81, v2, s[12:15], s41 offen
    s_mov_b32 s41, 181632
    buffer_load_dword v82, v2, s[12:15], s41 offen
    s_mov_b32 s41, 184384
    buffer_load_dword v83, v2, s[12:15], s41 offen
    s_mov_b32 s41, 187136
    buffer_load_dword v84, v2, s[12:15], s41 offen
    s_mov_b32 s41, 189888
    buffer_load_dword v85, v2, s[12:15], s41 offen
    s_mov_b32 s41, 192640
    buffer_load_dword v86, v2, s[12:15], s41 offen
    s_mov_b32 s41, 195392
    buffer_load_dword v87, v2, s[12:15], s41 offen
    s_mov_b32 s41, 220160
    buffer_load_dword v88, v2, s[12:15], s41 offen
    s_mov_b32 s41, 222912
    buffer_load_dword v89, v2, s[12:15], s41 offen
    s_mov_b32 s41, 225664
    buffer_load_dword v90, v2, s[12:15], s41 offen
    s_mov_b32 s41, 228416
    buffer_load_dword v91, v2, s[12:15], s41 offen
    s_mov_b32 s41, 231168
    buffer_load_dword v92, v2, s[12:15], s41 offen
    s_mov_b32 s41, 233920
    buffer_load_dword v93, v2, s[12:15], s41 offen
    s_mov_b32 s41, 236672
    buffer_load_dword v94, v2, s[12:15], s41 offen
    s_mov_b32 s41, 239424
    buffer_load_dword v95, v2, s[12:15], s41 offen
    s_mov_b32 s41, 264192
    buffer_load_dword v96, v2, s[12:15], s41 offen
    s_mov_b32 s41, 266944
    buffer_load_dword v97, v2, s[12:15], s41 offen
    s_mov_b32 s41, 269696
    buffer_load_dword v98, v2, s[12:15], s41 offen
    s_mov_b32 s41, 272448
    buffer_load_dword v99, v2, s[12:15], s41 offen
    s_mov_b32 s41, 275200
    buffer_load_dword v100, v2, s[12:15], s41 offen
    s_mov_b32 s41, 277952
    buffer_load_dword v101, v2, s[12:15], s41 offen
    s_mov_b32 s41, 280704
    buffer_load_dword v102, v2, s[12:15], s41 offen
    s_mov_b32 s41, 283456
    buffer_load_dword v103, v2, s[12:15], s41 offen
    s_mov_b32 s41, 308224
    buffer_load_dword v104, v2, s[12:15], s41 offen
    s_mov_b32 s41, 310976
    buffer_load_dword v105, v2, s[12:15], s41 offen
    s_mov_b32 s41, 313728
    buffer_load_dword v106, v2, s[12:15], s41 offen
    s_mov_b32 s41, 316480
    buffer_load_dword v107, v2, s[12:15], s41 offen
    s_mov_b32 s41, 319232
    buffer_load_dword v108, v2, s[12:15], s41 offen
    s_mov_b32 s41, 321984
    buffer_load_dword v109, v2, s[12:15], s41 offen
    s_mov_b32 s41, 324736
    buffer_load_dword v110, v2, s[12:15], s41 offen
    s_mov_b32 s41, 327488
    buffer_load_dword v111, v2, s[12:15], s41 offen
    s_mov_b64 exec, -1
    v_perm_b32 v112, v49, v48, s42
    v_perm_b32 v116, v49, v48, s43
    v_perm_b32 v113, v51, v50, s42
    v_perm_b32 v117, v51, v50, s43
    v_perm_b32 v114, v53, v52, s42
    v_perm_b32 v118, v53, v52, s43
    v_perm_b32 v115, v55, v54, s42
    v_perm_b32 v119, v55, v54, s43
    v_accvgpr_write_b32 a0, v112
    v_accvgpr_write_b32 a128, v116
    v_accvgpr_write_b32 a1, v113
    v_accvgpr_write_b32 a129, v117
    v_accvgpr_write_b32 a2, v114
    v_accvgpr_write_b32 a130, v118
    v_accvgpr_write_b32 a3, v115
    v_accvgpr_write_b32 a131, v119
    v_perm_b32 v112, v57, v56, s42
    v_perm_b32 v116, v57, v56, s43
    v_perm_b32 v113, v59, v58, s42
    v_perm_b32 v117, v59, v58, s43
    v_perm_b32 v114, v61, v60, s42
    v_perm_b32 v118, v61, v60, s43
    v_perm_b32 v115, v63, v62, s42
    v_perm_b32 v119, v63, v62, s43
    v_accvgpr_write_b32 a4, v112
    v_accvgpr_write_b32 a132, v116
    v_accvgpr_write_b32 a5, v113
    v_accvgpr_write_b32 a133, v117
    v_accvgpr_write_b32 a6, v114
    v_accvgpr_write_b32 a134, v118
    v_accvgpr_write_b32 a7, v115
    v_accvgpr_write_b32 a135, v119
    v_perm_b32 v112, v65, v64, s42
    v_perm_b32 v116, v65, v64, s43
    v_perm_b32 v113, v67, v66, s42
    v_perm_b32 v117, v67, v66, s43
    v_perm_b32 v114, v69, v68, s42
    v_perm_b32 v118, v69, v68, s43
    v_perm_b32 v115, v71, v70, s42
    v_perm_b32 v119, v71, v70, s43
    v_accvgpr_write_b32 a8, v112
    v_accvgpr_write_b32 a136, v116
    v_accvgpr_write_b32 a9, v113
    v_accvgpr_write_b32 a137, v117
    v_accvgpr_write_b32 a10, v114
    v_accvgpr_write_b32 a138, v118
    v_accvgpr_write_b32 a11, v115
    v_accvgpr_write_b32 a139, v119
    v_perm_b32 v112, v73, v72, s42
    v_perm_b32 v116, v73, v72, s43
    v_perm_b32 v113, v75, v74, s42
    v_perm_b32 v117, v75, v74, s43
    v_perm_b32 v114, v77, v76, s42
    v_perm_b32 v118, v77, v76, s43
    v_perm_b32 v115, v79, v78, s42
    v_perm_b32 v119, v79, v78, s43
    v_accvgpr_write_b32 a12, v112
    v_accvgpr_write_b32 a140, v116
    v_accvgpr_write_b32 a13, v113
    v_accvgpr_write_b32 a141, v117
    v_accvgpr_write_b32 a14, v114
    v_accvgpr_write_b32 a142, v118
    v_accvgpr_write_b32 a15, v115
    v_accvgpr_write_b32 a143, v119
    s_waitcnt vmcnt(0)
    s_mov_b64 exec, s[36:37]
    s_mov_b32 s41, 352256
    buffer_load_dword v48, v2, s[8:11], s41 offen
    s_mov_b32 s41, 355008
    buffer_load_dword v49, v2, s[8:11], s41 offen
    s_mov_b32 s41, 357760
    buffer_load_dword v50, v2, s[8:11], s41 offen
    s_mov_b32 s41, 360512
    buffer_load_dword v51, v2, s[8:11], s41 offen
    s_mov_b32 s41, 363264
    buffer_load_dword v52, v2, s[8:11], s41 offen
    s_mov_b32 s41, 366016
    buffer_load_dword v53, v2, s[8:11], s41 offen
    s_mov_b32 s41, 368768
    buffer_load_dword v54, v2, s[8:11], s41 offen
    s_mov_b32 s41, 371520
    buffer_load_dword v55, v2, s[8:11], s41 offen
    s_mov_b32 s41, 396288
    buffer_load_dword v56, v2, s[8:11], s41 offen
    s_mov_b32 s41, 399040
    buffer_load_dword v57, v2, s[8:11], s41 offen
    s_mov_b32 s41, 401792
    buffer_load_dword v58, v2, s[8:11], s41 offen
    s_mov_b32 s41, 404544
    buffer_load_dword v59, v2, s[8:11], s41 offen
    s_mov_b32 s41, 407296
    buffer_load_dword v60, v2, s[8:11], s41 offen
    s_mov_b32 s41, 410048
    buffer_load_dword v61, v2, s[8:11], s41 offen
    s_mov_b32 s41, 412800
    buffer_load_dword v62, v2, s[8:11], s41 offen
    s_mov_b32 s41, 415552
    buffer_load_dword v63, v2, s[8:11], s41 offen
    s_mov_b32 s41, 440320
    buffer_load_dword v64, v2, s[8:11], s41 offen
    s_mov_b32 s41, 443072
    buffer_load_dword v65, v2, s[8:11], s41 offen
    s_mov_b32 s41, 445824
    buffer_load_dword v66, v2, s[8:11], s41 offen
    s_mov_b32 s41, 448576
    buffer_load_dword v67, v2, s[8:11], s41 offen
    s_mov_b32 s41, 451328
    buffer_load_dword v68, v2, s[8:11], s41 offen
    s_mov_b32 s41, 454080
    buffer_load_dword v69, v2, s[8:11], s41 offen
    s_mov_b32 s41, 456832
    buffer_load_dword v70, v2, s[8:11], s41 offen
    s_mov_b32 s41, 459584
    buffer_load_dword v71, v2, s[8:11], s41 offen
    s_mov_b32 s41, 484352
    buffer_load_dword v72, v2, s[8:11], s41 offen
    s_mov_b32 s41, 487104
    buffer_load_dword v73, v2, s[8:11], s41 offen
    s_mov_b32 s41, 489856
    buffer_load_dword v74, v2, s[8:11], s41 offen
    s_mov_b32 s41, 492608
    buffer_load_dword v75, v2, s[8:11], s41 offen
    s_mov_b32 s41, 495360
    buffer_load_dword v76, v2, s[8:11], s41 offen
    s_mov_b32 s41, 498112
    buffer_load_dword v77, v2, s[8:11], s41 offen
    s_mov_b32 s41, 500864
    buffer_load_dword v78, v2, s[8:11], s41 offen
    s_mov_b32 s41, 503616
    buffer_load_dword v79, v2, s[8:11], s41 offen
    s_mov_b64 exec, s[38:39]
    s_mov_b32 s41, 352256
    buffer_load_dword v48, v2, s[12:15], s41 offen
    s_mov_b32 s41, 355008
    buffer_load_dword v49, v2, s[12:15], s41 offen
    s_mov_b32 s41, 357760
    buffer_load_dword v50, v2, s[12:15], s41 offen
    s_mov_b32 s41, 360512
    buffer_load_dword v51, v2, s[12:15], s41 offen
    s_mov_b32 s41, 363264
    buffer_load_dword v52, v2, s[12:15], s41 offen
    s_mov_b32 s41, 366016
    buffer_load_dword v53, v2, s[12:15], s41 offen
    s_mov_b32 s41, 368768
    buffer_load_dword v54, v2, s[12:15], s41 offen
    s_mov_b32 s41, 371520
    buffer_load_dword v55, v2, s[12:15], s41 offen
    s_mov_b32 s41, 396288
    buffer_load_dword v56, v2, s[12:15], s41 offen
    s_mov_b32 s41, 399040
    buffer_load_dword v57, v2, s[12:15], s41 offen
    s_mov_b32 s41, 401792
    buffer_load_dword v58, v2, s[12:15], s41 offen
    s_mov_b32 s41, 404544
    buffer_load_dword v59, v2, s[12:15], s41 offen
    s_mov_b32 s41, 407296
    buffer_load_dword v60, v2, s[12:15], s41 offen
    s_mov_b32 s41, 410048
    buffer_load_dword v61, v2, s[12:15], s41 offen
    s_mov_b32 s41, 412800
    buffer_load_dword v62, v2, s[12:15], s41 offen
    s_mov_b32 s41, 415552
    buffer_load_dword v63, v2, s[12:15], s41 offen
    s_mov_b32 s41, 440320
    buffer_load_dword v64, v2, s[12:15], s41 offen
    s_mov_b32 s41, 443072
    buffer_load_dword v65, v2, s[12:15], s41 offen
    s_mov_b32 s41, 445824
    buffer_load_dword v66, v2, s[12:15], s41 offen
    s_mov_b32 s41, 448576
    buffer_load_dword v67, v2, s[12:15], s41 offen
    s_mov_b32 s41, 451328
    buffer_load_dword v68, v2, s[12:15], s41 offen
    s_mov_b32 s41, 454080
    buffer_load_dword v69, v2, s[12:15], s41 offen
    s_mov_b32 s41, 456832
    buffer_load_dword v70, v2, s[12:15], s41 offen
    s_mov_b32 s41, 459584
    buffer_load_dword v71, v2, s[12:15], s41 offen
    s_mov_b32 s41, 484352
    buffer_load_dword v72, v2, s[12:15], s41 offen
    s_mov_b32 s41, 487104
    buffer_load_dword v73, v2, s[12:15], s41 offen
    s_mov_b32 s41, 489856
    buffer_load_dword v74, v2, s[12:15], s41 offen
    s_mov_b32 s41, 492608
    buffer_load_dword v75, v2, s[12:15], s41 offen
    s_mov_b32 s41, 495360
    buffer_load_dword v76, v2, s[12:15], s41 offen
    s_mov_b32 s41, 498112
    buffer_load_dword v77, v2, s[12:15], s41 offen
    s_mov_b32 s41, 500864
    buffer_load_dword v78, v2, s[12:15], s41 offen
    s_mov_b32 s41, 503616
    buffer_load_dword v79, v2, s[12:15], s41 offen
    s_mov_b64 exec, -1
    v_perm_b32 v112, v81, v80, s42
    v_perm_b32 v116, v81, v80, s43
    v_perm_b32 v113, v83, v82, s42
    v_perm_b32 v117, v83, v82, s43
    v_perm_b32 v114, v85, v84, s42
    v_perm_b32 v118, v85, v84, s43
    v_perm_b32 v115, v87, v86, s42
    v_perm_b32 v119, v87, v86, s43
    v_accvgpr_write_b32 a16, v112
    v_accvgpr_write_b32 a144, v116
    v_accvgpr_write_b32 a17, v113
    v_accvgpr_write_b32 a145, v117
    v_accvgpr_write_b32 a18, v114
    v_accvgpr_write_b32 a146, v118
    v_accvgpr_write_b32 a19, v115
    v_accvgpr_write_b32 a147, v119
    v_perm_b32 v112, v89, v88, s42
    v_perm_b32 v116, v89, v88, s43
    v_perm_b32 v113, v91, v90, s42
    v_perm_b32 v117, v91, v90, s43
    v_perm_b32 v114, v93, v92, s42
    v_perm_b32 v118, v93, v92, s43
    v_perm_b32 v115, v95, v94, s42
    v_perm_b32 v119, v95, v94, s43
    v_accvgpr_write_b32 a20, v112
    v_accvgpr_write_b32 a148, v116
    v_accvgpr_write_b32 a21, v113
    v_accvgpr_write_b32 a149, v117
    v_accvgpr_write_b32 a22, v114
    v_accvgpr_write_b32 a150, v118
    v_accvgpr_write_b32 a23, v115
    v_accvgpr_write_b32 a151, v119
    v_perm_b32 v112, v97, v96, s42
    v_perm_b32 v116, v97, v96, s43
    v_perm_b32 v113, v99, v98, s42
    v_perm_b32 v117, v99, v98, s43
    v_perm_b32 v114, v101, v100, s42
    v_perm_b32 v118, v101, v100, s43
    v_perm_b32 v115, v103, v102, s42
    v_perm_b32 v119, v103, v102, s43
    v_accvgpr_write_b32 a24, v112
    v_accvgpr_write_b32 a152, v116
    v_accvgpr_write_b32 a25, v113
    v_accvgpr_write_b32 a153, v117
    v_accvgpr_write_b32 a26, v114
    v_accvgpr_write_b32 a154, v118
    v_accvgpr_write_b32 a27, v115
    v_accvgpr_write_b32 a155, v119
    v_perm_b32 v112, v105, v104, s42
    v_perm_b32 v116, v105, v104, s43
    v_perm_b32 v113, v107, v106, s42
    v_perm_b32 v117, v107, v106, s43
    v_perm_b32 v114, v109, v108, s42
    v_perm_b32 v118, v109, v108, s43
    v_perm_b32 v115, v111, v110, s42
    v_perm_b32 v119, v111, v110, s43
    v_accvgpr_write_b32 a28, v112
    v_accvgpr_write_b32 a156, v116
    v_accvgpr_write_b32 a29, v113
    v_accvgpr_write_b32 a157, v117
    v_accvgpr_write_b32 a30, v114
    v_accvgpr_write_b32 a158, v118
    v_accvgpr_write_b32 a31, v115
    v_accvgpr_write_b32 a159, v119
    s_waitcnt vmcnt(0)
    s_mov_b64 exec, s[36:37]
    s_mov_b32 s41, 528384
    buffer_load_dword v80, v2, s[8:11], s41 offen
    s_mov_b32 s41, 531136
    buffer_load_dword v81, v2, s[8:11], s41 offen
    s_mov_b32 s41, 533888
    buffer_load_dword v82, v2, s[8:11], s41 offen
    s_mov_b32 s41, 536640
    buffer_load_dword v83, v2, s[8:11], s41 offen
    s_mov_b32 s41, 539392
    buffer_load_dword v84, v2, s[8:11], s41 offen
    s_mov_b32 s41, 542144
    buffer_load_dword v85, v2, s[8:11], s41 offen
    s_mov_b32 s41, 544896
    buffer_load_dword v86, v2, s[8:11], s41 offen
    s_mov_b32 s41, 547648
    buffer_load_dword v87, v2, s[8:11], s41 offen
    s_mov_b32 s41, 572416
    buffer_load_dword v88, v2, s[8:11], s41 offen
    s_mov_b32 s41, 575168
    buffer_load_dword v89, v2, s[8:11], s41 offen
    s_mov_b32 s41, 577920
    buffer_load_dword v90, v2, s[8:11], s41 offen
    s_mov_b32 s41, 580672
    buffer_load_dword v91, v2, s[8:11], s41 offen
    s_mov_b32 s41, 583424
    buffer_load_dword v92, v2, s[8:11], s41 offen
    s_mov_b32 s41, 586176
    buffer_load_dword v93, v2, s[8:11], s41 offen
    s_mov_b32 s41, 588928
    buffer_load_dword v94, v2, s[8:11], s41 offen
    s_mov_b32 s41, 591680
    buffer_load_dword v95, v2, s[8:11], s41 offen
    s_mov_b32 s41, 616448
    buffer_load_dword v96, v2, s[8:11], s41 offen
    s_mov_b32 s41, 619200
    buffer_load_dword v97, v2, s[8:11], s41 offen
    s_mov_b32 s41, 621952
    buffer_load_dword v98, v2, s[8:11], s41 offen
    s_mov_b32 s41, 624704
    buffer_load_dword v99, v2, s[8:11], s41 offen
    s_mov_b32 s41, 627456
    buffer_load_dword v100, v2, s[8:11], s41 offen
    s_mov_b32 s41, 630208
    buffer_load_dword v101, v2, s[8:11], s41 offen
    s_mov_b32 s41, 632960
    buffer_load_dword v102, v2, s[8:11], s41 offen
    s_mov_b32 s41, 635712
    buffer_load_dword v103, v2, s[8:11], s41 offen
    s_mov_b32 s41, 660480
    buffer_load_dword v104, v2, s[8:11], s41 offen
    s_mov_b32 s41, 663232
    buffer_load_dword v105, v2, s[8:11], s41 offen
    s_mov_b32 s41, 665984
    buffer_load_dword v106, v2, s[8:11], s41 offen
    s_mov_b32 s41, 668736
    buffer_load_dword v107, v2, s[8:11], s41 offen
    s_mov_b32 s41, 671488
    buffer_load_dword v108, v2, s[8:11], s41 offen
    s_mov_b32 s41, 674240
    buffer_load_dword v109, v2, s[8:11], s41 offen
    s_mov_b32 s41, 676992
    buffer_load_dword v110, v2, s[8:11], s41 offen
    s_mov_b32 s41, 679744
    buffer_load_dword v111, v2, s[8:11], s41 offen
    s_mov_b64 exec, s[38:39]
    s_mov_b32 s41, 528384
    buffer_load_dword v80, v2, s[12:15], s41 offen
    s_mov_b32 s41, 531136
    buffer_load_dword v81, v2, s[12:15], s41 offen
    s_mov_b32 s41, 533888
    buffer_load_dword v82, v2, s[12:15], s41 offen
    s_mov_b32 s41, 536640
    buffer_load_dword v83, v2, s[12:15], s41 offen
    s_mov_b32 s41, 539392
    buffer_load_dword v84, v2, s[12:15], s41 offen
    s_mov_b32 s41, 542144
    buffer_load_dword v85, v2, s[12:15], s41 offen
    s_mov_b32 s41, 544896
    buffer_load_dword v86, v2, s[12:15], s41 offen
    s_mov_b32 s41, 547648
    buffer_load_dword v87, v2, s[12:15], s41 offen
    s_mov_b32 s41, 572416
    buffer_load_dword v88, v2, s[12:15], s41 offen
    s_mov_b32 s41, 575168
    buffer_load_dword v89, v2, s[12:15], s41 offen
    s_mov_b32 s41, 577920
    buffer_load_dword v90, v2, s[12:15], s41 offen
    s_mov_b32 s41, 580672
    buffer_load_dword v91, v2, s[12:15], s41 offen
    s_mov_b32 s41, 583424
    buffer_load_dword v92, v2, s[12:15], s41 offen
    s_mov_b32 s41, 586176
    buffer_load_dword v93, v2, s[12:15], s41 offen
    s_mov_b32 s41, 588928
    buffer_load_dword v94, v2, s[12:15], s41 offen
    s_mov_b32 s41, 591680
    buffer_load_dword v95, v2, s[12:15], s41 offen
    s_mov_b32 s41, 616448
    buffer_load_dword v96, v2, s[12:15], s41 offen
    s_mov_b32 s41, 619200
    buffer_load_dword v97, v2, s[12:15], s41 offen
    s_mov_b32 s41, 621952
    buffer_load_dword v98, v2, s[12:15], s41 offen
    s_mov_b32 s41, 624704
    buffer_load_dword v99, v2, s[12:15], s41 offen
    s_mov_b32 s41, 627456
    buffer_load_dword v100, v2, s[12:15], s41 offen
    s_mov_b32 s41, 630208
    buffer_load_dword v101, v2, s[12:15], s41 offen
    s_mov_b32 s41, 632960
    buffer_load_dword v102, v2, s[12:15], s41 offen
    s_mov_b32 s41, 635712
    buffer_load_dword v103, v2, s[12:15], s41 offen
    s_mov_b32 s41, 660480
    buffer_load_dword v104, v2, s[12:15], s41 offen
    s_mov_b32 s41, 663232
    buffer_load_dword v105, v2, s[12:15], s41 offen
    s_mov_b32 s41, 665984
    buffer_load_dword v106, v2, s[12:15], s41 offen
    s_mov_b32 s41, 668736
    buffer_load_dword v107, v2, s[12:15], s41 offen
    s_mov_b32 s41, 671488
    buffer_load_dword v108, v2, s[12:15], s41 offen
    s_mov_b32 s41, 674240
    buffer_load_dword v109, v2, s[12:15], s41 offen
    s_mov_b32 s41, 676992
    buffer_load_dword v110, v2, s[12:15], s41 offen
    s_mov_b32 s41, 679744
    buffer_load_dword v111, v2, s[12:15], s41 offen
    s_mov_b64 exec, -1
    v_perm_b32 v112, v49, v48, s42
    v_perm_b32 v116, v49, v48, s43
    v_perm_b32 v113, v51, v50, s42
    v_perm_b32 v117, v51, v50, s43
    v_perm_b32 v114, v53, v52, s42
    v_perm_b32 v118, v53, v52, s43
    v_perm_b32 v115, v55, v54, s42
    v_perm_b32 v119, v55, v54, s43
    v_accvgpr_write_b32 a32, v112
    v_accvgpr_write_b32 a160, v116
    v_accvgpr_write_b32 a33, v113
    v_accvgpr_write_b32 a161, v117
    v_accvgpr_write_b32 a34, v114
    v_accvgpr_write_b32 a162, v118
    v_accvgpr_write_b32 a35, v115
    v_accvgpr_write_b32 a163, v119
    v_perm_b32 v112, v57, v56, s42
    v_perm_b32 v116, v57, v56, s43
    v_perm_b32 v113, v59, v58, s42
    v_perm_b32 v117, v59, v58, s43
    v_perm_b32 v114, v61, v60, s42
    v_perm_b32 v118, v61, v60, s43
    v_perm_b32 v115, v63, v62, s42
    v_perm_b32 v119, v63, v62, s43
    v_accvgpr_write_b32 a36, v112
    v_accvgpr_write_b32 a164, v116
    v_accvgpr_write_b32 a37, v113
    v_accvgpr_write_b32 a165, v117
    v_accvgpr_write_b32 a38, v114
    v_accvgpr_write_b32 a166, v118
    v_accvgpr_write_b32 a39, v115
    v_accvgpr_write_b32 a167, v119
    v_perm_b32 v112, v65, v64, s42
    v_perm_b32 v116, v65, v64, s43
    v_perm_b32 v113, v67, v66, s42
    v_perm_b32 v117, v67, v66, s43
    v_perm_b32 v114, v69, v68, s42
    v_perm_b32 v118, v69, v68, s43
    v_perm_b32 v115, v71, v70, s42
    v_perm_b32 v119, v71, v70, s43
    v_accvgpr_write_b32 a40, v112
    v_accvgpr_write_b32 a168, v116
    v_accvgpr_write_b32 a41, v113
    v_accvgpr_write_b32 a169, v117
    v_accvgpr_write_b32 a42, v114
    v_accvgpr_write_b32 a170, v118
    v_accvgpr_write_b32 a43, v115
    v_accvgpr_write_b32 a171, v119
    v_perm_b32 v112, v73, v72, s42
    v_perm_b32 v116, v73, v72, s43
    v_perm_b32 v113, v75, v74, s42
    v_perm_b32 v117, v75, v74, s43
    v_perm_b32 v114, v77, v76, s42
    v_perm_b32 v118, v77, v76, s43
    v_perm_b32 v115, v79, v78, s42
    v_perm_b32 v119, v79, v78, s43
    v_accvgpr_write_b32 a44, v112
    v_accvgpr_write_b32 a172, v116
    v_accvgpr_write_b32 a45, v113
    v_accvgpr_write_b32 a173, v117
    v_accvgpr_write_b32 a46, v114
    v_accvgpr_write_b32 a174, v118
    v_accvgpr_write_b32 a47, v115
    v_accvgpr_write_b32 a175, v119
    s_waitcnt vmcnt(0)
    s_mov_b64 exec, s[36:37]
    s_mov_b32 s41, 704512
    buffer_load_dword v48, v2, s[8:11], s41 offen
    s_mov_b32 s41, 707264
    buffer_load_dword v49, v2, s[8:11], s41 offen
    s_mov_b32 s41, 710016
    buffer_load_dword v50, v2, s[8:11], s41 offen
    s_mov_b32 s41, 712768
    buffer_load_dword v51, v2, s[8:11], s41 offen
    s_mov_b32 s41, 715520
    buffer_load_dword v52, v2, s[8:11], s41 offen
    s_mov_b32 s41, 718272
    buffer_load_dword v53, v2, s[8:11], s41 offen
    s_mov_b32 s41, 721024
    buffer_load_dword v54, v2, s[8:11], s41 offen
    s_mov_b32 s41, 723776
    buffer_load_dword v55, v2, s[8:11], s41 offen
    s_mov_b32 s41, 748544
    buffer_load_dword v56, v2, s[8:11], s41 offen
    s_mov_b32 s41, 751296
    buffer_load_dword v57, v2, s[8:11], s41 offen
    s_mov_b32 s41, 754048
    buffer_load_dword v58, v2, s[8:11], s41 offen
    s_mov_b32 s41, 756800
    buffer_load_dword v59, v2, s[8:11], s41 offen
    s_mov_b32 s41, 759552
    buffer_load_dword v60, v2, s[8:11], s41 offen
    s_mov_b32 s41, 762304
    buffer_load_dword v61, v2, s[8:11], s41 offen
    s_mov_b32 s41, 765056
    buffer_load_dword v62, v2, s[8:11], s41 offen
    s_mov_b32 s41, 767808
    buffer_load_dword v63, v2, s[8:11], s41 offen
    s_mov_b32 s41, 792576
    buffer_load_dword v64, v2, s[8:11], s41 offen
    s_mov_b32 s41, 795328
    buffer_load_dword v65, v2, s[8:11], s41 offen
    s_mov_b32 s41, 798080
    buffer_load_dword v66, v2, s[8:11], s41 offen
    s_mov_b32 s41, 800832
    buffer_load_dword v67, v2, s[8:11], s41 offen
    s_mov_b32 s41, 803584
    buffer_load_dword v68, v2, s[8:11], s41 offen
    s_mov_b32 s41, 806336
    buffer_load_dword v69, v2, s[8:11], s41 offen
    s_mov_b32 s41, 809088
    buffer_load_dword v70, v2, s[8:11], s41 offen
    s_mov_b32 s41, 811840
    buffer_load_dword v71, v2, s[8:11], s41 offen
    s_mov_b32 s41, 836608
    buffer_load_dword v72, v2, s[8:11], s41 offen
    s_mov_b32 s41, 839360
    buffer_load_dword v73, v2, s[8:11], s41 offen
    s_mov_b32 s41, 842112
    buffer_load_dword v74, v2, s[8:11], s41 offen
    s_mov_b32 s41, 844864
    buffer_load_dword v75, v2, s[8:11], s41 offen
    s_mov_b32 s41, 847616
    buffer_load_dword v76, v2, s[8:11], s41 offen
    s_mov_b32 s41, 850368
    buffer_load_dword v77, v2, s[8:11], s41 offen
    s_mov_b32 s41, 853120
    buffer_load_dword v78, v2, s[8:11], s41 offen
    s_mov_b32 s41, 855872
    buffer_load_dword v79, v2, s[8:11], s41 offen
    s_mov_b64 exec, s[38:39]
    s_mov_b32 s41, 704512
    buffer_load_dword v48, v2, s[12:15], s41 offen
    s_mov_b32 s41, 707264
    buffer_load_dword v49, v2, s[12:15], s41 offen
    s_mov_b32 s41, 710016
    buffer_load_dword v50, v2, s[12:15], s41 offen
    s_mov_b32 s41, 712768
    buffer_load_dword v51, v2, s[12:15], s41 offen
    s_mov_b32 s41, 715520
    buffer_load_dword v52, v2, s[12:15], s41 offen
    s_mov_b32 s41, 718272
    buffer_load_dword v53, v2, s[12:15], s41 offen
    s_mov_b32 s41, 721024
    buffer_load_dword v54, v2, s[12:15], s41 offen
    s_mov_b32 s41, 723776
    buffer_load_dword v55, v2, s[12:15], s41 offen
    s_mov_b32 s41, 748544
    buffer_load_dword v56, v2, s[12:15], s41 offen
    s_mov_b32 s41, 751296
    buffer_load_dword v57, v2, s[12:15], s41 offen
    s_mov_b32 s41, 754048
    buffer_load_dword v58, v2, s[12:15], s41 offen
    s_mov_b32 s41, 756800
    buffer_load_dword v59, v2, s[12:15], s41 offen
    s_mov_b32 s41, 759552
    buffer_load_dword v60, v2, s[12:15], s41 offen
    s_mov_b32 s41, 762304
    buffer_load_dword v61, v2, s[12:15], s41 offen
    s_mov_b32 s41, 765056
    buffer_load_dword v62, v2, s[12:15], s41 offen
    s_mov_b32 s41, 767808
    buffer_load_dword v63, v2, s[12:15], s41 offen
    s_mov_b32 s41, 792576
    buffer_load_dword v64, v2, s[12:15], s41 offen
    s_mov_b32 s41, 795328
    buffer_load_dword v65, v2, s[12:15], s41 offen
    s_mov_b32 s41, 798080
    buffer_load_dword v66, v2, s[12:15], s41 offen
    s_mov_b32 s41, 800832
    buffer_load_dword v67, v2, s[12:15], s41 offen
    s_mov_b32 s41, 803584
    buffer_load_dword v68, v2, s[12:15], s41 offen
    s_mov_b32 s41, 806336
    buffer_load_dword v69, v2, s[12:15], s41 offen
    s_mov_b32 s41, 809088
    buffer_load_dword v70, v2, s[12:15], s41 offen
    s_mov_b32 s41, 811840
    buffer_load_dword v71, v2, s[12:15], s41 offen
    s_mov_b32 s41, 836608
    buffer_load_dword v72, v2, s[12:15], s41 offen
    s_mov_b32 s41, 839360
    buffer_load_dword v73, v2, s[12:15], s41 offen
    s_mov_b32 s41, 842112
    buffer_load_dword v74, v2, s[12:15], s41 offen
    s_mov_b32 s41, 844864
    buffer_load_dword v75, v2, s[12:15], s41 offen
    s_mov_b32 s41, 847616
    buffer_load_dword v76, v2, s[12:15], s41 offen
    s_mov_b32 s41, 850368
    buffer_load_dword v77, v2, s[12:15], s41 offen
    s_mov_b32 s41, 853120
    buffer_load_dword v78, v2, s[12:15], s41 offen
    s_mov_b32 s41, 855872
    buffer_load_dword v79, v2, s[12:15], s41 offen
    s_mov_b64 exec, -1
    v_perm_b32 v112, v81, v80, s42
    v_perm_b32 v116, v81, v80, s43
    v_perm_b32 v113, v83, v82, s42
    v_perm_b32 v117, v83, v82, s43
    v_perm_b32 v114, v85, v84, s42
    v_perm_b32 v118, v85, v84, s43
    v_perm_b32 v115, v87, v86, s42
    v_perm_b32 v119, v87, v86, s43
    v_accvgpr_write_b32 a48, v112
    v_accvgpr_write_b32 a176, v116
    v_accvgpr_write_b32 a49, v113
    v_accvgpr_write_b32 a177, v117
    v_accvgpr_write_b32 a50, v114
    v_accvgpr_write_b32 a178, v118
    v_accvgpr_write_b32 a51, v115
    v_accvgpr_write_b32 a179, v119
    v_perm_b32 v112, v89, v88, s42
    v_perm_b32 v116, v89, v88, s43
    v_perm_b32 v113, v91, v90, s42
    v_perm_b32 v117, v91, v90, s43
    v_perm_b32 v114, v93, v92, s42
    v_perm_b32 v118, v93, v92, s43
    v_perm_b32 v115, v95, v94, s42
    v_perm_b32 v119, v95, v94, s43
    v_accvgpr_write_b32 a52, v112
    v_accvgpr_write_b32 a180, v116
    v_accvgpr_write_b32 a53, v113
    v_accvgpr_write_b32 a181, v117
    v_accvgpr_write_b32 a54, v114
    v_accvgpr_write_b32 a182, v118
    v_accvgpr_write_b32 a55, v115
    v_accvgpr_write_b32 a183, v119
    v_perm_b32 v112, v97, v96, s42
    v_perm_b32 v116, v97, v96, s43
    v_perm_b32 v113, v99, v98, s42
    v_perm_b32 v117, v99, v98, s43
    v_perm_b32 v114, v101, v100, s42
    v_perm_b32 v118, v101, v100, s43
    v_perm_b32 v115, v103, v102, s42
    v_perm_b32 v119, v103, v102, s43
    v_accvgpr_write_b32 a56, v112
    v_accvgpr_write_b32 a184, v116
    v_accvgpr_write_b32 a57, v113
    v_accvgpr_write_b32 a185, v117
    v_accvgpr_write_b32 a58, v114
    v_accvgpr_write_b32 a186, v118
    v_accvgpr_write_b32 a59, v115
    v_accvgpr_write_b32 a187, v119
    v_perm_b32 v112, v105, v104, s42
    v_perm_b32 v116, v105, v104, s43
    v_perm_b32 v113, v107, v106, s42
    v_perm_b32 v117, v107, v106, s43
    v_perm_b32 v114, v109, v108, s42
    v_perm_b32 v118, v109, v108, s43
    v_perm_b32 v115, v111, v110, s42
    v_perm_b32 v119, v111, v110, s43
    v_accvgpr_write_b32 a60, v112
    v_accvgpr_write_b32 a188, v116
    v_accvgpr_write_b32 a61, v113
    v_accvgpr_write_b32 a189, v117
    v_accvgpr_write_b32 a62, v114
    v_accvgpr_write_b32 a190, v118
    v_accvgpr_write_b32 a63, v115
    v_accvgpr_write_b32 a191, v119
    s_waitcnt vmcnt(0)
    s_mov_b64 exec, s[36:37]
    s_mov_b32 s41, 880640
    buffer_load_dword v80, v2, s[8:11], s41 offen
    s_mov_b32 s41, 883392
    buffer_load_dword v81, v2, s[8:11], s41 offen
    s_mov_b32 s41, 886144
    buffer_load_dword v82, v2, s[8:11], s41 offen
    s_mov_b32 s41, 888896
    buffer_load_dword v83, v2, s[8:11], s41 offen
    s_mov_b32 s41, 891648
    buffer_load_dword v84, v2, s[8:11], s41 offen
    s_mov_b32 s41, 894400
    buffer_load_dword v85, v2, s[8:11], s41 offen
    s_mov_b32 s41, 897152
    buffer_load_dword v86, v2, s[8:11], s41 offen
    s_mov_b32 s41, 899904
    buffer_load_dword v87, v2, s[8:11], s41 offen
    s_mov_b32 s41, 924672
    buffer_load_dword v88, v2, s[8:11], s41 offen
    s_mov_b32 s41, 927424
    buffer_load_dword v89, v2, s[8:11], s41 offen
    s_mov_b32 s41, 930176
    buffer_load_dword v90, v2, s[8:11], s41 offen
    s_mov_b32 s41, 932928
    buffer_load_dword v91, v2, s[8:11], s41 offen
    s_mov_b32 s41, 935680
    buffer_load_dword v92, v2, s[8:11], s41 offen
    s_mov_b32 s41, 938432
    buffer_load_dword v93, v2, s[8:11], s41 offen
    s_mov_b32 s41, 941184
    buffer_load_dword v94, v2, s[8:11], s41 offen
    s_mov_b32 s41, 943936
    buffer_load_dword v95, v2, s[8:11], s41 offen
    s_mov_b32 s41, 968704
    buffer_load_dword v96, v2, s[8:11], s41 offen
    s_mov_b32 s41, 971456
    buffer_load_dword v97, v2, s[8:11], s41 offen
    s_mov_b32 s41, 974208
    buffer_load_dword v98, v2, s[8:11], s41 offen
    s_mov_b32 s41, 976960
    buffer_load_dword v99, v2, s[8:11], s41 offen
    s_mov_b32 s41, 979712
    buffer_load_dword v100, v2, s[8:11], s41 offen
    s_mov_b32 s41, 982464
    buffer_load_dword v101, v2, s[8:11], s41 offen
    s_mov_b32 s41, 985216
    buffer_load_dword v102, v2, s[8:11], s41 offen
    s_mov_b32 s41, 987968
    buffer_load_dword v103, v2, s[8:11], s41 offen
    s_mov_b32 s41, 1012736
    buffer_load_dword v104, v2, s[8:11], s41 offen
    s_mov_b32 s41, 1015488
    buffer_load_dword v105, v2, s[8:11], s41 offen
    s_mov_b32 s41, 1018240
    buffer_load_dword v106, v2, s[8:11], s41 offen
    s_mov_b32 s41, 1020992
    buffer_load_dword v107, v2, s[8:11], s41 offen
    s_mov_b32 s41, 1023744
    buffer_load_dword v108, v2, s[8:11], s41 offen
    s_mov_b32 s41, 1026496
    buffer_load_dword v109, v2, s[8:11], s41 offen
    s_mov_b32 s41, 1029248
    buffer_load_dword v110, v2, s[8:11], s41 offen
    s_mov_b32 s41, 1032000
    buffer_load_dword v111, v2, s[8:11], s41 offen
    s_mov_b64 exec, s[38:39]
    s_mov_b32 s41, 880640
    buffer_load_dword v80, v2, s[12:15], s41 offen
    s_mov_b32 s41, 883392
    buffer_load_dword v81, v2, s[12:15], s41 offen
    s_mov_b32 s41, 886144
    buffer_load_dword v82, v2, s[12:15], s41 offen
    s_mov_b32 s41, 888896
    buffer_load_dword v83, v2, s[12:15], s41 offen
    s_mov_b32 s41, 891648
    buffer_load_dword v84, v2, s[12:15], s41 offen
    s_mov_b32 s41, 894400
    buffer_load_dword v85, v2, s[12:15], s41 offen
    s_mov_b32 s41, 897152
    buffer_load_dword v86, v2, s[12:15], s41 offen
    s_mov_b32 s41, 899904
    buffer_load_dword v87, v2, s[12:15], s41 offen
    s_mov_b32 s41, 924672
    buffer_load_dword v88, v2, s[12:15], s41 offen
    s_mov_b32 s41, 927424
    buffer_load_dword v89, v2, s[12:15], s41 offen
    s_mov_b32 s41, 930176
    buffer_load_dword v90, v2, s[12:15], s41 offen
    s_mov_b32 s41, 932928
    buffer_load_dword v91, v2, s[12:15], s41 offen
    s_mov_b32 s41, 935680
    buffer_load_dword v92, v2, s[12:15], s41 offen
    s_mov_b32 s41, 938432
    buffer_load_dword v93, v2, s[12:15], s41 offen
    s_mov_b32 s41, 941184
    buffer_load_dword v94, v2, s[12:15], s41 offen
    s_mov_b32 s41, 943936
    buffer_load_dword v95, v2, s[12:15], s41 offen
    s_mov_b32 s41, 968704
    buffer_load_dword v96, v2, s[12:15], s41 offen
    s_mov_b32 s41, 971456
    buffer_load_dword v97, v2, s[12:15], s41 offen
    s_mov_b32 s41, 974208
    buffer_load_dword v98, v2, s[12:15], s41 offen
    s_mov_b32 s41, 976960
    buffer_load_dword v99, v2, s[12:15], s41 offen
    s_mov_b32 s41, 979712
    buffer_load_dword v100, v2, s[12:15], s41 offen
    s_mov_b32 s41, 982464
    buffer_load_dword v101, v2, s[12:15], s41 offen
    s_mov_b32 s41, 985216
    buffer_load_dword v102, v2, s[12:15], s41 offen
    s_mov_b32 s41, 987968
    buffer_load_dword v103, v2, s[12:15], s41 offen
    s_mov_b32 s41, 1012736
    buffer_load_dword v104, v2, s[12:15], s41 offen
    s_mov_b32 s41, 1015488
    buffer_load_dword v105, v2, s[12:15], s41 offen
    s_mov_b32 s41, 1018240
    buffer_load_dword v106, v2, s[12:15], s41 offen
    s_mov_b32 s41, 1020992
    buffer_load_dword v107, v2, s[12:15], s41 offen
    s_mov_b32 s41, 1023744
    buffer_load_dword v108, v2, s[12:15], s41 offen
    s_mov_b32 s41, 1026496
    buffer_load_dword v109, v2, s[12:15], s41 offen
    s_mov_b32 s41, 1029248
    buffer_load_dword v110, v2, s[12:15], s41 offen
    s_mov_b32 s41, 1032000
    buffer_load_dword v111, v2, s[12:15], s41 offen
    s_mov_b64 exec, -1
    v_perm_b32 v112, v49, v48, s42
    v_perm_b32 v116, v49, v48, s43
    v_perm_b32 v113, v51, v50, s42
    v_perm_b32 v117, v51, v50, s43
    v_perm_b32 v114, v53, v52, s42
    v_perm_b32 v118, v53, v52, s43
    v_perm_b32 v115, v55, v54, s42
    v_perm_b32 v119, v55, v54, s43
    v_accvgpr_write_b32 a64, v112
    v_accvgpr_write_b32 a192, v116
    v_accvgpr_write_b32 a65, v113
    v_accvgpr_write_b32 a193, v117
    v_accvgpr_write_b32 a66, v114
    v_accvgpr_write_b32 a194, v118
    v_accvgpr_write_b32 a67, v115
    v_accvgpr_write_b32 a195, v119
    v_perm_b32 v112, v57, v56, s42
    v_perm_b32 v116, v57, v56, s43
    v_perm_b32 v113, v59, v58, s42
    v_perm_b32 v117, v59, v58, s43
    v_perm_b32 v114, v61, v60, s42
    v_perm_b32 v118, v61, v60, s43
    v_perm_b32 v115, v63, v62, s42
    v_perm_b32 v119, v63, v62, s43
    v_accvgpr_write_b32 a68, v112
    v_accvgpr_write_b32 a196, v116
    v_accvgpr_write_b32 a69, v113
    v_accvgpr_write_b32 a197, v117
    v_accvgpr_write_b32 a70, v114
    v_accvgpr_write_b32 a198, v118
    v_accvgpr_write_b32 a71, v115
    v_accvgpr_write_b32 a199, v119
    v_perm_b32 v112, v65, v64, s42
    v_perm_b32 v116, v65, v64, s43
    v_perm_b32 v113, v67, v66, s42
    v_perm_b32 v117, v67, v66, s43
    v_perm_b32 v114, v69, v68, s42
    v_perm_b32 v118, v69, v68, s43
    v_perm_b32 v115, v71, v70, s42
    v_perm_b32 v119, v71, v70, s43
    v_accvgpr_write_b32 a72, v112
    v_accvgpr_write_b32 a200, v116
    v_accvgpr_write_b32 a73, v113
    v_accvgpr_write_b32 a201, v117
    v_accvgpr_write_b32 a74, v114
    v_accvgpr_write_b32 a202, v118
    v_accvgpr_write_b32 a75, v115
    v_accvgpr_write_b32 a203, v119
    v_perm_b32 v112, v73, v72, s42
    v_perm_b32 v116, v73, v72, s43
    v_perm_b32 v113, v75, v74, s42
    v_perm_b32 v117, v75, v74, s43
    v_perm_b32 v114, v77, v76, s42
    v_perm_b32 v118, v77, v76, s43
    v_perm_b32 v115, v79, v78, s42
    v_perm_b32 v119, v79, v78, s43
    v_accvgpr_write_b32 a76, v112
    v_accvgpr_write_b32 a204, v116
    v_accvgpr_write_b32 a77, v113
    v_accvgpr_write_b32 a205, v117
    v_accvgpr_write_b32 a78, v114
    v_accvgpr_write_b32 a206, v118
    v_accvgpr_write_b32 a79, v115
    v_accvgpr_write_b32 a207, v119
    s_waitcnt vmcnt(0)
    s_mov_b64 exec, s[36:37]
    s_mov_b32 s41, 1056768
    buffer_load_dword v48, v2, s[8:11], s41 offen
    s_mov_b32 s41, 1059520
    buffer_load_dword v49, v2, s[8:11], s41 offen
    s_mov_b32 s41, 1062272
    buffer_load_dword v50, v2, s[8:11], s41 offen
    s_mov_b32 s41, 1065024
    buffer_load_dword v51, v2, s[8:11], s41 offen
    s_mov_b32 s41, 1067776
    buffer_load_dword v52, v2, s[8:11], s41 offen
    s_mov_b32 s41, 1070528
    buffer_load_dword v53, v2, s[8:11], s41 offen
    s_mov_b32 s41, 1073280
    buffer_load_dword v54, v2, s[8:11], s41 offen
    s_mov_b32 s41, 1076032
    buffer_load_dword v55, v2, s[8:11], s41 offen
    s_mov_b32 s41, 1100800
    buffer_load_dword v56, v2, s[8:11], s41 offen
    s_mov_b32 s41, 1103552
    buffer_load_dword v57, v2, s[8:11], s41 offen
    s_mov_b32 s41, 1106304
    buffer_load_dword v58, v2, s[8:11], s41 offen
    s_mov_b32 s41, 1109056
    buffer_load_dword v59, v2, s[8:11], s41 offen
    s_mov_b32 s41, 1111808
    buffer_load_dword v60, v2, s[8:11], s41 offen
    s_mov_b32 s41, 1114560
    buffer_load_dword v61, v2, s[8:11], s41 offen
    s_mov_b32 s41, 1117312
    buffer_load_dword v62, v2, s[8:11], s41 offen
    s_mov_b32 s41, 1120064
    buffer_load_dword v63, v2, s[8:11], s41 offen
    s_mov_b32 s41, 1144832
    buffer_load_dword v64, v2, s[8:11], s41 offen
    s_mov_b32 s41, 1147584
    buffer_load_dword v65, v2, s[8:11], s41 offen
    s_mov_b32 s41, 1150336
    buffer_load_dword v66, v2, s[8:11], s41 offen
    s_mov_b32 s41, 1153088
    buffer_load_dword v67, v2, s[8:11], s41 offen
    s_mov_b32 s41, 1155840
    buffer_load_dword v68, v2, s[8:11], s41 offen
    s_mov_b32 s41, 1158592
    buffer_load_dword v69, v2, s[8:11], s41 offen
    s_mov_b32 s41, 1161344
    buffer_load_dword v70, v2, s[8:11], s41 offen
    s_mov_b32 s41, 1164096
    buffer_load_dword v71, v2, s[8:11], s41 offen
    s_mov_b32 s41, 1188864
    buffer_load_dword v72, v2, s[8:11], s41 offen
    s_mov_b32 s41, 1191616
    buffer_load_dword v73, v2, s[8:11], s41 offen
    s_mov_b32 s41, 1194368
    buffer_load_dword v74, v2, s[8:11], s41 offen
    s_mov_b32 s41, 1197120
    buffer_load_dword v75, v2, s[8:11], s41 offen
    s_mov_b32 s41, 1199872
    buffer_load_dword v76, v2, s[8:11], s41 offen
    s_mov_b32 s41, 1202624
    buffer_load_dword v77, v2, s[8:11], s41 offen
    s_mov_b32 s41, 1205376
    buffer_load_dword v78, v2, s[8:11], s41 offen
    s_mov_b32 s41, 1208128
    buffer_load_dword v79, v2, s[8:11], s41 offen
    s_mov_b64 exec, s[38:39]
    s_mov_b32 s41, 1056768
    buffer_load_dword v48, v2, s[12:15], s41 offen
    s_mov_b32 s41, 1059520
    buffer_load_dword v49, v2, s[12:15], s41 offen
    s_mov_b32 s41, 1062272
    buffer_load_dword v50, v2, s[12:15], s41 offen
    s_mov_b32 s41, 1065024
    buffer_load_dword v51, v2, s[12:15], s41 offen
    s_mov_b32 s41, 1067776
    buffer_load_dword v52, v2, s[12:15], s41 offen
    s_mov_b32 s41, 1070528
    buffer_load_dword v53, v2, s[12:15], s41 offen
    s_mov_b32 s41, 1073280
    buffer_load_dword v54, v2, s[12:15], s41 offen
    s_mov_b32 s41, 1076032
    buffer_load_dword v55, v2, s[12:15], s41 offen
    s_mov_b32 s41, 1100800
    buffer_load_dword v56, v2, s[12:15], s41 offen
    s_mov_b32 s41, 1103552
    buffer_load_dword v57, v2, s[12:15], s41 offen
    s_mov_b32 s41, 1106304
    buffer_load_dword v58, v2, s[12:15], s41 offen
    s_mov_b32 s41, 1109056
    buffer_load_dword v59, v2, s[12:15], s41 offen
    s_mov_b32 s41, 1111808
    buffer_load_dword v60, v2, s[12:15], s41 offen
    s_mov_b32 s41, 1114560
    buffer_load_dword v61, v2, s[12:15], s41 offen
    s_mov_b32 s41, 1117312
    buffer_load_dword v62, v2, s[12:15], s41 offen
    s_mov_b32 s41, 1120064
    buffer_load_dword v63, v2, s[12:15], s41 offen
    s_mov_b32 s41, 1144832
    buffer_load_dword v64, v2, s[12:15], s41 offen
    s_mov_b32 s41, 1147584
    buffer_load_dword v65, v2, s[12:15], s41 offen
    s_mov_b32 s41, 1150336
    buffer_load_dword v66, v2, s[12:15], s41 offen
    s_mov_b32 s41, 1153088
    buffer_load_dword v67, v2, s[12:15], s41 offen
    s_mov_b32 s41, 1155840
    buffer_load_dword v68, v2, s[12:15], s41 offen
    s_mov_b32 s41, 1158592
    buffer_load_dword v69, v2, s[12:15], s41 offen
    s_mov_b32 s41, 1161344
    buffer_load_dword v70, v2, s[12:15], s41 offen
    s_mov_b32 s41, 1164096
    buffer_load_dword v71, v2, s[12:15], s41 offen
    s_mov_b32 s41, 1188864
    buffer_load_dword v72, v2, s[12:15], s41 offen
    s_mov_b32 s41, 1191616
    buffer_load_dword v73, v2, s[12:15], s41 offen
    s_mov_b32 s41, 1194368
    buffer_load_dword v74, v2, s[12:15], s41 offen
    s_mov_b32 s41, 1197120
    buffer_load_dword v75, v2, s[12:15], s41 offen
    s_mov_b32 s41, 1199872
    buffer_load_dword v76, v2, s[12:15], s41 offen
    s_mov_b32 s41, 1202624
    buffer_load_dword v77, v2, s[12:15], s41 offen
    s_mov_b32 s41, 1205376
    buffer_load_dword v78, v2, s[12:15], s41 offen
    s_mov_b32 s41, 1208128
    buffer_load_dword v79, v2, s[12:15], s41 offen
    s_mov_b64 exec, -1
    v_perm_b32 v112, v81, v80, s42
    v_perm_b32 v116, v81, v80, s43
    v_perm_b32 v113, v83, v82, s42
    v_perm_b32 v117, v83, v82, s43
    v_perm_b32 v114, v85, v84, s42
    v_perm_b32 v118, v85, v84, s43
    v_perm_b32 v115, v87, v86, s42
    v_perm_b32 v119, v87, v86, s43
    v_accvgpr_write_b32 a80, v112
    v_accvgpr_write_b32 a208, v116
    v_accvgpr_write_b32 a81, v113
    v_accvgpr_write_b32 a209, v117
    v_accvgpr_write_b32 a82, v114
    v_accvgpr_write_b32 a210, v118
    v_accvgpr_write_b32 a83, v115
    v_accvgpr_write_b32 a211, v119
    v_perm_b32 v112, v89, v88, s42
    v_perm_b32 v116, v89, v88, s43
    v_perm_b32 v113, v91, v90, s42
    v_perm_b32 v117, v91, v90, s43
    v_perm_b32 v114, v93, v92, s42
    v_perm_b32 v118, v93, v92, s43
    v_perm_b32 v115, v95, v94, s42
    v_perm_b32 v119, v95, v94, s43
    v_accvgpr_write_b32 a84, v112
    v_accvgpr_write_b32 a212, v116
    v_accvgpr_write_b32 a85, v113
    v_accvgpr_write_b32 a213, v117
    v_accvgpr_write_b32 a86, v114
    v_accvgpr_write_b32 a214, v118
    v_accvgpr_write_b32 a87, v115
    v_accvgpr_write_b32 a215, v119
    v_perm_b32 v112, v97, v96, s42
    v_perm_b32 v116, v97, v96, s43
    v_perm_b32 v113, v99, v98, s42
    v_perm_b32 v117, v99, v98, s43
    v_perm_b32 v114, v101, v100, s42
    v_perm_b32 v118, v101, v100, s43
    v_perm_b32 v115, v103, v102, s42
    v_perm_b32 v119, v103, v102, s43
    v_accvgpr_write_b32 a88, v112
    v_accvgpr_write_b32 a216, v116
    v_accvgpr_write_b32 a89, v113
    v_accvgpr_write_b32 a217, v117
    v_accvgpr_write_b32 a90, v114
    v_accvgpr_write_b32 a218, v118
    v_accvgpr_write_b32 a91, v115
    v_accvgpr_write_b32 a219, v119
    v_perm_b32 v112, v105, v104, s42
    v_perm_b32 v116, v105, v104, s43
    v_perm_b32 v113, v107, v106, s42
    v_perm_b32 v117, v107, v106, s43
    v_perm_b32 v114, v109, v108, s42
    v_perm_b32 v118, v109, v108, s43
    v_perm_b32 v115, v111, v110, s42
    v_perm_b32 v119, v111, v110, s43
    v_accvgpr_write_b32 a92, v112
    v_accvgpr_write_b32 a220, v116
    v_accvgpr_write_b32 a93, v113
    v_accvgpr_write_b32 a221, v117
    v_accvgpr_write_b32 a94, v114
    v_accvgpr_write_b32 a222, v118
    v_accvgpr_write_b32 a95, v115
    v_accvgpr_write_b32 a223, v119
    s_waitcnt vmcnt(0)
    s_mov_b64 exec, s[36:37]
    s_mov_b32 s41, 1232896
    buffer_load_dword v80, v2, s[8:11], s41 offen
    s_mov_b32 s41, 1235648
    buffer_load_dword v81, v2, s[8:11], s41 offen
    s_mov_b32 s41, 1238400
    buffer_load_dword v82, v2, s[8:11], s41 offen
    s_mov_b32 s41, 1241152
    buffer_load_dword v83, v2, s[8:11], s41 offen
    s_mov_b32 s41, 1243904
    buffer_load_dword v84, v2, s[8:11], s41 offen
    s_mov_b32 s41, 1246656
    buffer_load_dword v85, v2, s[8:11], s41 offen
    s_mov_b32 s41, 1249408
    buffer_load_dword v86, v2, s[8:11], s41 offen
    s_mov_b32 s41, 1252160
    buffer_load_dword v87, v2, s[8:11], s41 offen
    s_mov_b32 s41, 1276928
    buffer_load_dword v88, v2, s[8:11], s41 offen
    s_mov_b32 s41, 1279680
    buffer_load_dword v89, v2, s[8:11], s41 offen
    s_mov_b32 s41, 1282432
    buffer_load_dword v90, v2, s[8:11], s41 offen
    s_mov_b32 s41, 1285184
    buffer_load_dword v91, v2, s[8:11], s41 offen
    s_mov_b32 s41, 1287936
    buffer_load_dword v92, v2, s[8:11], s41 offen
    s_mov_b32 s41, 1290688
    buffer_load_dword v93, v2, s[8:11], s41 offen
    s_mov_b32 s41, 1293440
    buffer_load_dword v94, v2, s[8:11], s41 offen
    s_mov_b32 s41, 1296192
    buffer_load_dword v95, v2, s[8:11], s41 offen
    s_mov_b32 s41, 1320960
    buffer_load_dword v96, v2, s[8:11], s41 offen
    s_mov_b32 s41, 1323712
    buffer_load_dword v97, v2, s[8:11], s41 offen
    s_mov_b32 s41, 1326464
    buffer_load_dword v98, v2, s[8:11], s41 offen
    s_mov_b32 s41, 1329216
    buffer_load_dword v99, v2, s[8:11], s41 offen
    s_mov_b32 s41, 1331968
    buffer_load_dword v100, v2, s[8:11], s41 offen
    s_mov_b32 s41, 1334720
    buffer_load_dword v101, v2, s[8:11], s41 offen
    s_mov_b32 s41, 1337472
    buffer_load_dword v102, v2, s[8:11], s41 offen
    s_mov_b32 s41, 1340224
    buffer_load_dword v103, v2, s[8:11], s41 offen
    s_mov_b32 s41, 1364992
    buffer_load_dword v104, v2, s[8:11], s41 offen
    s_mov_b32 s41, 1367744
    buffer_load_dword v105, v2, s[8:11], s41 offen
    s_mov_b32 s41, 1370496
    buffer_load_dword v106, v2, s[8:11], s41 offen
    s_mov_b32 s41, 1373248
    buffer_load_dword v107, v2, s[8:11], s41 offen
    s_mov_b32 s41, 1376000
    buffer_load_dword v108, v2, s[8:11], s41 offen
    s_mov_b32 s41, 1378752
    buffer_load_dword v109, v2, s[8:11], s41 offen
    s_mov_b32 s41, 1381504
    buffer_load_dword v110, v2, s[8:11], s41 offen
    s_mov_b32 s41, 1384256
    buffer_load_dword v111, v2, s[8:11], s41 offen
    s_mov_b64 exec, s[38:39]
    s_mov_b32 s41, 1232896
    buffer_load_dword v80, v2, s[12:15], s41 offen
    s_mov_b32 s41, 1235648
    buffer_load_dword v81, v2, s[12:15], s41 offen
    s_mov_b32 s41, 1238400
    buffer_load_dword v82, v2, s[12:15], s41 offen
    s_mov_b32 s41, 1241152
    buffer_load_dword v83, v2, s[12:15], s41 offen
    s_mov_b32 s41, 1243904
    buffer_load_dword v84, v2, s[12:15], s41 offen
    s_mov_b32 s41, 1246656
    buffer_load_dword v85, v2, s[12:15], s41 offen
    s_mov_b32 s41, 1249408
    buffer_load_dword v86, v2, s[12:15], s41 offen
    s_mov_b32 s41, 1252160
    buffer_load_dword v87, v2, s[12:15], s41 offen
    s_mov_b32 s41, 1276928
    buffer_load_dword v88, v2, s[12:15], s41 offen
    s_mov_b32 s41, 1279680
    buffer_load_dword v89, v2, s[12:15], s41 offen
    s_mov_b32 s41, 1282432
    buffer_load_dword v90, v2, s[12:15], s41 offen
    s_mov_b32 s41, 1285184
    buffer_load_dword v91, v2, s[12:15], s41 offen
    s_mov_b32 s41, 1287936
    buffer_load_dword v92, v2, s[12:15], s41 offen
    s_mov_b32 s41, 1290688
    buffer_load_dword v93, v2, s[12:15], s41 offen
    s_mov_b32 s41, 1293440
    buffer_load_dword v94, v2, s[12:15], s41 offen
    s_mov_b32 s41, 1296192
    buffer_load_dword v95, v2, s[12:15], s41 offen
    s_mov_b32 s41, 1320960
    buffer_load_dword v96, v2, s[12:15], s41 offen
    s_mov_b32 s41, 1323712
    buffer_load_dword v97, v2, s[12:15], s41 offen
    s_mov_b32 s41, 1326464
    buffer_load_dword v98, v2, s[12:15], s41 offen
    s_mov_b32 s41, 1329216
    buffer_load_dword v99, v2, s[12:15], s41 offen
    s_mov_b32 s41, 1331968
    buffer_load_dword v100, v2, s[12:15], s41 offen
    s_mov_b32 s41, 1334720
    buffer_load_dword v101, v2, s[12:15], s41 offen
    s_mov_b32 s41, 1337472
    buffer_load_dword v102, v2, s[12:15], s41 offen
    s_mov_b32 s41, 1340224
    buffer_load_dword v103, v2, s[12:15], s41 offen
    s_mov_b32 s41, 1364992
    buffer_load_dword v104, v2, s[12:15], s41 offen
    s_mov_b32 s41, 1367744
    buffer_load_dword v105, v2, s[12:15], s41 offen
    s_mov_b32 s41, 1370496
    buffer_load_dword v106, v2, s[12:15], s41 offen
    s_mov_b32 s41, 1373248
    buffer_load_dword v107, v2, s[12:15], s41 offen
    s_mov_b32 s41, 1376000
    buffer_load_dword v108, v2, s[12:15], s41 offen
    s_mov_b32 s41, 1378752
    buffer_load_dword v109, v2, s[12:15], s41 offen
    s_mov_b32 s41, 1381504
    buffer_load_dword v110, v2, s[12:15], s41 offen
    s_mov_b32 s41, 1384256
    buffer_load_dword v111, v2, s[12:15], s41 offen
    s_mov_b64 exec, -1
    v_perm_b32 v112, v49, v48, s42
    v_perm_b32 v116, v49, v48, s43
    v_perm_b32 v113, v51, v50, s42
    v_perm_b32 v117, v51, v50, s43
    v_perm_b32 v114, v53, v52, s42
    v_perm_b32 v118, v53, v52, s43
    v_perm_b32 v115, v55, v54, s42
    v_perm_b32 v119, v55, v54, s43
    v_accvgpr_write_b32 a96, v112
    v_accvgpr_write_b32 a224, v116
    v_accvgpr_write_b32 a97, v113
    v_accvgpr_write_b32 a225, v117
    v_accvgpr_write_b32 a98, v114
    v_accvgpr_write_b32 a226, v118
    v_accvgpr_write_b32 a99, v115
    v_accvgpr_write_b32 a227, v119
    v_perm_b32 v112, v57, v56, s42
    v_perm_b32 v116, v57, v56, s43
    v_perm_b32 v113, v59, v58, s42
    v_perm_b32 v117, v59, v58, s43
    v_perm_b32 v114, v61, v60, s42
    v_perm_b32 v118, v61, v60, s43
    v_perm_b32 v115, v63, v62, s42
    v_perm_b32 v119, v63, v62, s43
    v_accvgpr_write_b32 a100, v112
    v_accvgpr_write_b32 a228, v116
    v_accvgpr_write_b32 a101, v113
    v_accvgpr_write_b32 a229, v117
    v_accvgpr_write_b32 a102, v114
    v_accvgpr_write_b32 a230, v118
    v_accvgpr_write_b32 a103, v115
    v_accvgpr_write_b32 a231, v119
    v_perm_b32 v112, v65, v64, s42
    v_perm_b32 v116, v65, v64, s43
    v_perm_b32 v113, v67, v66, s42
    v_perm_b32 v117, v67, v66, s43
    v_perm_b32 v114, v69, v68, s42
    v_perm_b32 v118, v69, v68, s43
    v_perm_b32 v115, v71, v70, s42
    v_perm_b32 v119, v71, v70, s43
    v_accvgpr_write_b32 a104, v112
    v_accvgpr_write_b32 a232, v116
    v_accvgpr_write_b32 a105, v113
    v_accvgpr_write_b32 a233, v117
    v_accvgpr_write_b32 a106, v114
    v_accvgpr_write_b32 a234, v118
    v_accvgpr_write_b32 a107, v115
    v_accvgpr_write_b32 a235, v119
    v_perm_b32 v112, v73, v72, s42
    v_perm_b32 v116, v73, v72, s43
    v_perm_b32 v113, v75, v74, s42
    v_perm_b32 v117, v75, v74, s43
    v_perm_b32 v114, v77, v76, s42
    v_perm_b32 v118, v77, v76, s43
    v_perm_b32 v115, v79, v78, s42
    v_perm_b32 v119, v79, v78, s43
    v_accvgpr_write_b32 a108, v112
    v_accvgpr_write_b32 a236, v116
    v_accvgpr_write_b32 a109, v113
    v_accvgpr_write_b32 a237, v117
    v_accvgpr_write_b32 a110, v114
    v_accvgpr_write_b32 a238, v118
    v_accvgpr_write_b32 a111, v115
    v_accvgpr_write_b32 a239, v119
    s_waitcnt vmcnt(0)
    v_perm_b32 v112, v81, v80, s42
    v_perm_b32 v116, v81, v80, s43
    v_perm_b32 v113, v83, v82, s42
    v_perm_b32 v117, v83, v82, s43
    v_perm_b32 v114, v85, v84, s42
    v_perm_b32 v118, v85, v84, s43
    v_perm_b32 v115, v87, v86, s42
    v_perm_b32 v119, v87, v86, s43
    v_accvgpr_write_b32 a112, v112
    v_accvgpr_write_b32 a240, v116
    v_accvgpr_write_b32 a113, v113
    v_accvgpr_write_b32 a241, v117
    v_accvgpr_write_b32 a114, v114
    v_accvgpr_write_b32 a242, v118
    v_accvgpr_write_b32 a115, v115
    v_accvgpr_write_b32 a243, v119
    v_perm_b32 v112, v89, v88, s42
    v_perm_b32 v116, v89, v88, s43
    v_perm_b32 v113, v91, v90, s42
    v_perm_b32 v117, v91, v90, s43
    v_perm_b32 v114, v93, v92, s42
    v_perm_b32 v118, v93, v92, s43
    v_perm_b32 v115, v95, v94, s42
    v_perm_b32 v119, v95, v94, s43
    v_accvgpr_write_b32 a116, v112
    v_accvgpr_write_b32 a244, v116
    v_accvgpr_write_b32 a117, v113
    v_accvgpr_write_b32 a245, v117
    v_accvgpr_write_b32 a118, v114
    v_accvgpr_write_b32 a246, v118
    v_accvgpr_write_b32 a119, v115
    v_accvgpr_write_b32 a247, v119
    v_perm_b32 v112, v97, v96, s42
    v_perm_b32 v116, v97, v96, s43
    v_perm_b32 v113, v99, v98, s42
    v_perm_b32 v117, v99, v98, s43
    v_perm_b32 v114, v101, v100, s42
    v_perm_b32 v118, v101, v100, s43
    v_perm_b32 v115, v103, v102, s42
    v_perm_b32 v119, v103, v102, s43
    v_accvgpr_write_b32 a120, v112
    v_accvgpr_write_b32 a248, v116
    v_accvgpr_write_b32 a121, v113
    v_accvgpr_write_b32 a249, v117
    v_accvgpr_write_b32 a122, v114
    v_accvgpr_write_b32 a250, v118
    v_accvgpr_write_b32 a123, v115
    v_accvgpr_write_b32 a251, v119
    v_perm_b32 v112, v105, v104, s42
    v_perm_b32 v116, v105, v104, s43
    v_perm_b32 v113, v107, v106, s42
    v_perm_b32 v117, v107, v106, s43
    v_perm_b32 v114, v109, v108, s42
    v_perm_b32 v118, v109, v108, s43
    v_perm_b32 v115, v111, v110, s42
    v_perm_b32 v119, v111, v110, s43
    v_accvgpr_write_b32 a124, v112
    v_accvgpr_write_b32 a252, v116
    v_accvgpr_write_b32 a125, v113
    v_accvgpr_write_b32 a253, v117
    v_accvgpr_write_b32 a126, v114
    v_accvgpr_write_b32 a254, v118
    v_accvgpr_write_b32 a127, v115
    v_accvgpr_write_b32 a255, v119
    s_waitcnt vmcnt(0)
f1r_loop:
    s_lshl_b32 s65, s28, 4
    s_add_u32 s65, s65, 0xa800
    v_mov_b32 v250, 0
f1r_w:
    buffer_load_dword v251, v250, s[24:27], s65 offen sc1
    s_add_u32 s98, s98, 1
    s_waitcnt vmcnt(0)
    v_readfirstlane_b32 s66, v251
    s_cmp_gt_u32 s98, 262144
    s_cbranch_scc1 f1r_w_x
    s_cmp_lt_u32 s66, 16
    s_cbranch_scc1 f1r_w
f1r_w_x:
    s_lshl_b32 s41, s28, 15
    buffer_load_dwordx4 v[16:19], v3, s[16:19], s41 offen offset:0
    buffer_load_dwordx4 v[20:23], v3, s[16:19], s41 offen offset:1024
    buffer_load_dwordx4 v[24:27], v3, s[16:19], s41 offen offset:2048
    buffer_load_dwordx4 v[28:31], v3, s[16:19], s41 offen offset:3072
    buffer_load_dwordx4 v[32:35], v4, s[16:19], s41 offen offset:0
    buffer_load_dwordx4 v[36:39], v4, s[16:19], s41 offen offset:1024
    buffer_load_dwordx4 v[40:43], v4, s[16:19], s41 offen offset:2048
    buffer_load_dwordx4 v[44:47], v4, s[16:19], s41 offen offset:3072
    s_waitcnt vmcnt(0)
    v_lshlrev_b32 v48, 16, v16
    v_and_b32 v49, s44, v16
    v_lshlrev_b32 v50, 16, v17
    v_and_b32 v51, s44, v17
    v_lshlrev_b32 v52, 16, v18
    v_and_b32 v53, s44, v18
    v_lshlrev_b32 v54, 16, v19
    v_and_b32 v55, s44, v19
    v_lshlrev_b32 v56, 16, v20
    v_and_b32 v57, s44, v20
    v_lshlrev_b32 v58, 16, v21
    v_and_b32 v59, s44, v21
    v_lshlrev_b32 v60, 16, v22
    v_and_b32 v61, s44, v22
    v_lshlrev_b32 v62, 16, v23
    v_and_b32 v63, s44, v23
    v_lshlrev_b32 v64, 16, v24
    v_and_b32 v65, s44, v24
    v_lshlrev_b32 v66, 16, v25
    v_and_b32 v67, s44, v25
    v_lshlrev_b32 v68, 16, v26
    v_and_b32 v69, s44, v26
    v_lshlrev_b32 v70, 16, v27
    v_and_b32 v71, s44, v27
    v_lshlrev_b32 v72, 16, v28
    v_and_b32 v73, s44, v28
    v_lshlrev_b32 v74, 16, v29
    v_and_b32 v75, s44, v29
    v_lshlrev_b32 v76, 16, v30
    v_and_b32 v77, s44, v30
    v_lshlrev_b32 v78, 16, v31
    v_and_b32 v79, s44, v31
    v_lshlrev_b32 v80, 16, v32
    v_and_b32 v81, s44, v32
    v_lshlrev_b32 v82, 16, v33
    v_and_b32 v83, s44, v33
    v_lshlrev_b32 v84, 16, v34
    v_and_b32 v85, s44, v34
    v_lshlrev_b32 v86, 16, v35
    v_and_b32 v87, s44, v35
    v_lshlrev_b32 v88, 16, v36
    v_and_b32 v89, s44, v36
    v_lshlrev_b32 v90, 16, v37
    v_and_b32 v91, s44, v37
    v_lshlrev_b32 v92, 16, v38
    v_and_b32 v93, s44, v38
    v_lshlrev_b32 v94, 16, v39
    v_and_b32 v95, s44, v39
    v_lshlrev_b32 v96, 16, v40
    v_and_b32 v97, s44, v40
    v_lshlrev_b32 v98, 16, v41
    v_and_b32 v99, s44, v41
    v_lshlrev_b32 v100, 16, v42
    v_and_b32 v101, s44, v42
    v_lshlrev_b32 v102, 16, v43
    v_and_b32 v103, s44, v43
    v_lshlrev_b32 v104, 16, v44
    v_and_b32 v105, s44, v44
    v_lshlrev_b32 v106, 16, v45
    v_and_b32 v107, s44, v45
    v_lshlrev_b32 v108, 16, v46
    v_and_b32 v109, s44, v46
    v_lshlrev_b32 v110, 16, v47
    v_and_b32 v111, s44, v47
    v_add_f32 v112, v48, v49
    v_mul_f32 v120, v48, v48
    v_add_f32 v113, v56, v57
    v_mul_f32 v121, v56, v56
    v_add_f32 v114, v64, v65
    v_mul_f32 v122, v64, v64
    v_add_f32 v115, v72, v73
    v_mul_f32 v123, v72, v72
    v_add_f32 v116, v80, v81
    v_mul_f32 v124, v80, v80
    v_add_f32 v117, v88, v89
    v_mul_f32 v125, v88, v88
    v_add_f32 v118, v96, v97
    v_mul_f32 v126, v96, v96
    v_add_f32 v119, v104, v105
    v_mul_f32 v127, v104, v104
    v_fma_f32 v120, v49, v49, v120
    v_fma_f32 v121, v57, v57, v121
    v_fma_f32 v122, v65, v65, v122
    v_fma_f32 v123, v73, v73, v123
    v_fma_f32 v124, v81, v81, v124
    v_fma_f32 v125, v89, v89, v125
    v_fma_f32 v126, v97, v97, v126
    v_fma_f32 v127, v105, v105, v127
    v_add_f32 v112, v112, v50
    v_fma_f32 v120, v50, v50, v120
    v_add_f32 v113, v113, v58
    v_fma_f32 v121, v58, v58, v121
    v_add_f32 v114, v114, v66
    v_fma_f32 v122, v66, v66, v122
    v_add_f32 v115, v115, v74
    v_fma_f32 v123, v74, v74, v123
    v_add_f32 v116, v116, v82
    v_fma_f32 v124, v82, v82, v124
    v_add_f32 v117, v117, v90
    v_fma_f32 v125, v90, v90, v125
    v_add_f32 v118, v118, v98
    v_fma_f32 v126, v98, v98, v126
    v_add_f32 v119, v119, v106
    v_fma_f32 v127, v106, v106, v127
    v_add_f32 v112, v112, v51
    v_fma_f32 v120, v51, v51, v120
    v_add_f32 v113, v113, v59
    v_fma_f32 v121, v59, v59, v121
    v_add_f32 v114, v114, v67
    v_fma_f32 v122, v67, v67, v122
    v_add_f32 v115, v115, v75
    v_fma_f32 v123, v75, v75, v123
    v_add_f32 v116, v116, v83
    v_fma_f32 v124, v83, v83, v124
    v_add_f32 v117, v117, v91
    v_fma_f32 v125, v91, v91, v125
    v_add_f32 v118, v118, v99
    v_fma_f32 v126, v99, v99, v126
    v_add_f32 v119, v119, v107
    v_fma_f32 v127, v107, v107, v127
    v_add_f32 v112, v112, v52
    v_fma_f32 v120, v52, v52, v120
    v_add_f32 v113, v113, v60
    v_fma_f32 v121, v60, v60, v121
    v_add_f32 v114, v114, v68
    v_fma_f32 v122, v68, v68, v122
    v_add_f32 v115, v115, v76
    v_fma_f32 v123, v76, v76, v123
    v_add_f32 v116, v116, v84
    v_fma_f32 v124, v84, v84, v124
    v_add_f32 v117, v117, v92
    v_fma_f32 v125, v92, v92, v125
    v_add_f32 v118, v118, v100
    v_fma_f32 v126, v100, v100, v126
    v_add_f32 v119, v119, v108
    v_fma_f32 v127, v108, v108, v127
    v_add_f32 v112, v112, v53
    v_fma_f32 v120, v53, v53, v120
    v_add_f32 v113, v113, v61
    v_fma_f32 v121, v61, v61, v121
    v_add_f32 v114, v114, v69
    v_fma_f32 v122, v69, v69, v122
    v_add_f32 v115, v115, v77
    v_fma_f32 v123, v77, v77, v123
    v_add_f32 v116, v116, v85
    v_fma_f32 v124, v85, v85, v124
    v_add_f32 v117, v117, v93
    v_fma_f32 v125, v93, v93, v125
    v_add_f32 v118, v118, v101
    v_fma_f32 v126, v101, v101, v126
    v_add_f32 v119, v119, v109
    v_fma_f32 v127, v109, v109, v127
    v_add_f32 v112, v112, v54
    v_fma_f32 v120, v54, v54, v120
    v_add_f32 v113, v113, v62
    v_fma_f32 v121, v62, v62, v121
    v_add_f32 v114, v114, v70
    v_fma_f32 v122, v70, v70, v122
    v_add_f32 v115, v115, v78
    v_fma_f32 v123, v78, v78, v123
    v_add_f32 v116, v116, v86
    v_fma_f32 v124, v86, v86, v124
    v_add_f32 v117, v117, v94
    v_fma_f32 v125, v94, v94, v125
    v_add_f32 v118, v118, v102
    v_fma_f32 v126, v102, v102, v126
    v_add_f32 v119, v119, v110
    v_fma_f32 v127, v110, v110, v127
    v_add_f32 v112, v112, v55
    v_fma_f32 v120, v55, v55, v120
    v_add_f32 v113, v113, v63
    v_fma_f32 v121, v63, v63, v121
    v_add_f32 v114, v114, v71
    v_fma_f32 v122, v71, v71, v122
    v_add_f32 v115, v115, v79
    v_fma_f32 v123, v79, v79, v123
    v_add_f32 v116, v116, v87
    v_fma_f32 v124, v87, v87, v124
    v_add_f32 v117, v117, v95
    v_fma_f32 v125, v95, v95, v125
    v_add_f32 v118, v118, v103
    v_fma_f32 v126, v103, v103, v126
    v_add_f32 v119, v119, v111
    v_fma_f32 v127, v111, v111, v127
    v_add_f32_dpp v112, v112, v112 row_shr:1 bound_ctrl:0
    v_add_f32_dpp v113, v113, v113 row_shr:1 bound_ctrl:0
    v_add_f32_dpp v114, v114, v114 row_shr:1 bound_ctrl:0
    v_add_f32_dpp v115, v115, v115 row_shr:1 bound_ctrl:0
    v_add_f32_dpp v116, v116, v116 row_shr:1 bound_ctrl:0
    v_add_f32_dpp v117, v117, v117 row_shr:1 bound_ctrl:0
    v_add_f32_dpp v118, v118, v118 row_shr:1 bound_ctrl:0
    v_add_f32_dpp v119, v119, v119 row_shr:1 bound_ctrl:0
    v_add_f32_dpp v120, v120, v120 row_shr:1 bound_ctrl:0
    v_add_f32_dpp v121, v121, v121 row_shr:1 bound_ctrl:0
    v_add_f32_dpp v122, v122, v122 row_shr:1 bound_ctrl:0
    v_add_f32_dpp v123, v123, v123 row_shr:1 bound_ctrl:0
    v_add_f32_dpp v124, v124, v124 row_shr:1 bound_ctrl:0
    v_add_f32_dpp v125, v125, v125 row_shr:1 bound_ctrl:0
    v_add_f32_dpp v126, v126, v126 row_shr:1 bound_ctrl:0
    v_add_f32_dpp v127, v127, v127 row_shr:1 bound_ctrl:0
    v_add_f32_dpp v112, v112, v112 row_shr:2 bound_ctrl:0
    v_add_f32_dpp v113, v113, v113 row_shr:2 bound_ctrl:0
    v_add_f32_dpp v114, v114, v114 row_shr:2 bound_ctrl:0
    v_add_f32_dpp v115, v115, v115 row_shr:2 bound_ctrl:0
    v_add_f32_dpp v116, v116, v116 row_shr:2 bound_ctrl:0
    v_add_f32_dpp v117, v117, v117 row_shr:2 bound_ctrl:0
    v_add_f32_dpp v118, v118, v118 row_shr:2 bound_ctrl:0
    v_add_f32_dpp v119, v119, v119 row_shr:2 bound_ctrl:0
    v_add_f32_dpp v120, v120, v120 row_shr:2 bound_ctrl:0
    v_add_f32_dpp v121, v121, v121 row_shr:2 bound_ctrl:0
    v_add_f32_dpp v122, v122, v122 row_shr:2 bound_ctrl:0
    v_add_f32_dpp v123, v123, v123 row_shr:2 bound_ctrl:0
    v_add_f32_dpp v124, v124, v124 row_shr:2 bound_ctrl:0
    v_add_f32_dpp v125, v125, v125 row_shr:2 bound_ctrl:0
    v_add_f32_dpp v126, v126, v126 row_shr:2 bound_ctrl:0
    v_add_f32_dpp v127, v127, v127 row_shr:2 bound_ctrl:0
    v_add_f32_dpp v112, v112, v112 row_shr:4 bound_ctrl:0
    v_add_f32_dpp v113, v113, v113 row_shr:4 bound_ctrl:0
    v_add_f32_dpp v114, v114, v114 row_shr:4 bound_ctrl:0
    v_add_f32_dpp v115, v115, v115 row_shr:4 bound_ctrl:0
    v_add_f32_dpp v116, v116, v116 row_shr:4 bound_ctrl:0
    v_add_f32_dpp v117, v117, v117 row_shr:4 bound_ctrl:0
    v_add_f32_dpp v118, v118, v118 row_shr:4 bound_ctrl:0
    v_add_f32_dpp v119, v119, v119 row_shr:4 bound_ctrl:0
    v_add_f32_dpp v120, v120, v120 row_shr:4 bound_ctrl:0
    v_add_f32_dpp v121, v121, v121 row_shr:4 bound_ctrl:0
    v_add_f32_dpp v122, v122, v122 row_shr:4 bound_ctrl:0
    v_add_f32_dpp v123, v123, v123 row_shr:4 bound_ctrl:0
    v_add_f32_dpp v124, v124, v124 row_shr:4 bound_ctrl:0
    v_add_f32_dpp v125, v125, v125 row_shr:4 bound_ctrl:0
    v_add_f32_dpp v126, v126, v126 row_shr:4 bound_ctrl:0
    v_add_f32_dpp v127, v127, v127 row_shr:4 bound_ctrl:0
    v_add_f32_dpp v112, v112, v112 row_shr:8 bound_ctrl:0
    v_add_f32_dpp v113, v113, v113 row_shr:8 bound_ctrl:0
    v_add_f32_dpp v114, v114, v114 row_shr:8 bound_ctrl:0
    v_add_f32_dpp v115, v115, v115 row_shr:8 bound_ctrl:0
    v_add_f32_dpp v116, v116, v116 row_shr:8 bound_ctrl:0
    v_add_f32_dpp v117, v117, v117 row_shr:8 bound_ctrl:0
    v_add_f32_dpp v118, v118, v118 row_shr:8 bound_ctrl:0
    v_add_f32_dpp v119, v119, v119 row_shr:8 bound_ctrl:0
    v_add_f32_dpp v120, v120, v120 row_shr:8 bound_ctrl:0
    v_add_f32_dpp v121, v121, v121 row_shr:8 bound_ctrl:0
    v_add_f32_dpp v122, v122, v122 row_shr:8 bound_ctrl:0
    v_add_f32_dpp v123, v123, v123 row_shr:8 bound_ctrl:0
    v_add_f32_dpp v124, v124, v124 row_shr:8 bound_ctrl:0
    v_add_f32_dpp v125, v125, v125 row_shr:8 bound_ctrl:0
    v_add_f32_dpp v126, v126, v126 row_shr:8 bound_ctrl:0
    v_add_f32_dpp v127, v127, v127 row_shr:8 bound_ctrl:0
    v_add_f32_dpp v112, v112, v112 row_bcast:15 row_mask:0xa
    v_add_f32_dpp v113, v113, v113 row_bcast:15 row_mask:0xa
    v_add_f32_dpp v114, v114, v114 row_bcast:15 row_mask:0xa
    v_add_f32_dpp v115, v115, v115 row_bcast:15 row_mask:0xa
    v_add_f32_dpp v116, v116, v116 row_bcast:15 row_mask:0xa
    v_add_f32_dpp v117, v117, v117 row_bcast:15 row_mask:0xa
    v_add_f32_dpp v118, v118, v118 row_bcast:15 row_mask:0xa
    v_add_f32_dpp v119, v119, v119 row_bcast:15 row_mask:0xa
    v_add_f32_dpp v120, v120, v120 row_bcast:15 row_mask:0xa
    v_add_f32_dpp v121, v121, v121 row_bcast:15 row_mask:0xa
    v_add_f32_dpp v122, v122, v122 row_bcast:15 row_mask:0xa
    v_add_f32_dpp v123, v123, v123 row_bcast:15 row_mask:0xa
    v_add_f32_dpp v124, v124, v124 row_bcast:15 row_mask:0xa
    v_add_f32_dpp v125, v125, v125 row_bcast:15 row_mask:0xa
    v_add_f32_dpp v126, v126, v126 row_bcast:15 row_mask:0xa
    v_add_f32_dpp v127, v127, v127 row_bcast:15 row_mask:0xa
    v_add_f32_dpp v112, v112, v112 row_bcast:31 row_mask:0xc
    v_add_f32_dpp v113, v113, v113 row_bcast:31 row_mask:0xc
    v_add_f32_dpp v114, v114, v114 row_bcast:31 row_mask:0xc
    v_add_f32_dpp v115, v115, v115 row_bcast:31 row_mask:0xc
    v_add_f32_dpp v116, v116, v116 row_bcast:31 row_mask:0xc
    v_add_f32_dpp v117, v117, v117 row_bcast:31 row_mask:0xc
    v_add_f32_dpp v118, v118, v118 row_bcast:31 row_mask:0xc
    v_add_f32_dpp v119, v119, v119 row_bcast:31 row_mask:0xc
    v_add_f32_dpp v120, v120, v120 row_bcast:31 row_mask:0xc
    v_add_f32_dpp v121, v121, v121 row_bcast:31 row_mask:0xc
    v_add_f32_dpp v122, v122, v122 row_bcast:31 row_mask:0xc
    v_add_f32_dpp v123, v123, v123 row_bcast:31 row_mask:0xc
    v_add_f32_dpp v124, v124, v124 row_bcast:31 row_mask:0xc
    v_add_f32_dpp v125, v125, v125 row_bcast:31 row_mask:0xc
    v_add_f32_dpp v126, v126, v126 row_bcast:31 row_mask:0xc
    v_add_f32_dpp v127, v127, v127 row_bcast:31 row_mask:0xc
    s_mov_b32 s45, 0x3b000000
    s_mov_b32 s46, 0x3727c5ac
    v_mul_f32 v112, s45, v112
    v_mul_f32 v113, s45, v113
    v_mul_f32 v114, s45, v114
    v_mul_f32 v115, s45, v115
    v_mul_f32 v116, s45, v116
    v_mul_f32 v117, s45, v117
    v_mul_f32 v118, s45, v118
    v_mul_f32 v119, s45, v119
    v_mul_f32 v120, s45, v120
    v_mul_f32 v121, s45, v121
    v_mul_f32 v122, s45, v122
    v_mul_f32 v123, s45, v123
    v_mul_f32 v124, s45, v124
    v_mul_f32 v125, s45, v125
    v_mul_f32 v126, s45, v126
    v_mul_f32 v127, s45, v127
    v_fma_f32 v120, -v112, v112, v120
    v_fma_f32 v121, -v113, v113, v121
    v_fma_f32 v122, -v114, v114, v122
    v_fma_f32 v123, -v115, v115, v123
    v_fma_f32 v124, -v116, v116, v124
    v_fma_f32 v125, -v117, v117, v125
    v_fma_f32 v126, -v118, v118, v126
    v_fma_f32 v127, -v119, v119, v127
    v_max_f32 v120, 0, v120
    v_max_f32 v121, 0, v121
    v_max_f32 v122, 0, v122
    v_max_f32 v123, 0, v123
    v_max_f32 v124, 0, v124
    v_max_f32 v125, 0, v125
    v_max_f32 v126, 0, v126
    v_max_f32 v127, 0, v127
    v_add_f32 v120, s46, v120
    v_add_f32 v121, s46, v121
    v_add_f32 v122, s46, v122
    v_add_f32 v123, s46, v123
    v_add_f32 v124, s46, v124
    v_add_f32 v125, s46, v125
    v_add_f32 v126, s46, v126
    v_add_f32 v127, s46, v127
    v_rsq_f32 v120, v120
    v_rsq_f32 v121, v121
    v_rsq_f32 v122, v122
    v_rsq_f32 v123, v123
    v_rsq_f32 v124, v124
    v_rsq_f32 v125, v125
    v_rsq_f32 v126, v126
    v_rsq_f32 v127, v127
    s_nop 1
    v_readlane_b32 s48, v112, 63
    v_readlane_b32 s56, v120, 63
    v_readlane_b32 s49, v113, 63
    v_readlane_b32 s57, v121, 63
    v_readlane_b32 s50, v114, 63
    v_readlane_b32 s58, v122, 63
    v_readlane_b32 s51, v115, 63
    v_readlane_b32 s59, v123, 63
    v_readlane_b32 s52, v116, 63
    v_readlane_b32 s60, v124, 63
    v_readlane_b32 s53, v117, 63
    v_readlane_b32 s61, v125, 63
    v_readlane_b32 s54, v118, 63
    v_readlane_b32 s62, v126, 63
    v_readlane_b32 s55, v119, 63
    v_readlane_b32 s63, v127, 63
    s_nop 1
    v_subrev_f32 v48, s48, v48
    v_subrev_f32 v49, s48, v49
    v_subrev_f32 v50, s48, v50
    v_subrev_f32 v51, s48, v51
    v_subrev_f32 v52, s48, v52
    v_subrev_f32 v53, s48, v53
    v_subrev_f32 v54, s48, v54
    v_subrev_f32 v55, s48, v55
    v_mul_f32 v48, s56, v48
    v_mul_f32 v49, s56, v49
    v_mul_f32 v50, s56, v50
    v_mul_f32 v51, s56, v51
    v_mul_f32 v52, s56, v52
    v_mul_f32 v53, s56, v53
    v_mul_f32 v54, s56, v54
    v_mul_f32 v55, s56, v55
    v_fma_f32 v48, v48, v128, v136
    v_fma_f32 v49, v49, v129, v137
    v_fma_f32 v50, v50, v130, v138
    v_fma_f32 v51, v51, v131, v139
    v_fma_f32 v52, v52, v132, v140
    v_fma_f32 v53, v53, v133, v141
    v_fma_f32 v54, v54, v134, v142
    v_fma_f32 v55, v55, v135, v143
    v_cvt_pk_bf16_f32 v48, v48, v49
    v_cvt_pk_bf16_f32 v49, v50, v51
    v_cvt_pk_bf16_f32 v50, v52, v53
    v_cvt_pk_bf16_f32 v51, v54, v55
    ds_write_b128 v5, v[48:51] offset:0
    v_subrev_f32 v56, s49, v56
    v_subrev_f32 v57, s49, v57
    v_subrev_f32 v58, s49, v58
    v_subrev_f32 v59, s49, v59
    v_subrev_f32 v60, s49, v60
    v_subrev_f32 v61, s49, v61
    v_subrev_f32 v62, s49, v62
    v_subrev_f32 v63, s49, v63
    v_mul_f32 v56, s57, v56
    v_mul_f32 v57, s57, v57
    v_mul_f32 v58, s57, v58
    v_mul_f32 v59, s57, v59
    v_mul_f32 v60, s57, v60
    v_mul_f32 v61, s57, v61
    v_mul_f32 v62, s57, v62
    v_mul_f32 v63, s57, v63
    v_fma_f32 v56, v56, v128, v136
    v_fma_f32 v57, v57, v129, v137
    v_fma_f32 v58, v58, v130, v138
    v_fma_f32 v59, v59, v131, v139
    v_fma_f32 v60, v60, v132, v140
    v_fma_f32 v61, v61, v133, v141
    v_fma_f32 v62, v62, v134, v142
    v_fma_f32 v63, v63, v135, v143
    v_cvt_pk_bf16_f32 v56, v56, v57
    v_cvt_pk_bf16_f32 v57, v58, v59
    v_cvt_pk_bf16_f32 v58, v60, v61
    v_cvt_pk_bf16_f32 v59, v62, v63
    ds_write_b128 v5, v[56:59] offset:1040
    v_subrev_f32 v64, s50, v64
    v_subrev_f32 v65, s50, v65
    v_subrev_f32 v66, s50, v66
    v_subrev_f32 v67, s50, v67
    v_subrev_f32 v68, s50, v68
    v_subrev_f32 v69, s50, v69
    v_subrev_f32 v70, s50, v70
    v_subrev_f32 v71, s50, v71
    v_mul_f32 v64, s58, v64
    v_mul_f32 v65, s58, v65
    v_mul_f32 v66, s58, v66
    v_mul_f32 v67, s58, v67
    v_mul_f32 v68, s58, v68
    v_mul_f32 v69, s58, v69
    v_mul_f32 v70, s58, v70
    v_mul_f32 v71, s58, v71
    v_fma_f32 v64, v64, v128, v136
    v_fma_f32 v65, v65, v129, v137
    v_fma_f32 v66, v66, v130, v138
    v_fma_f32 v67, v67, v131, v139
    v_fma_f32 v68, v68, v132, v140
    v_fma_f32 v69, v69, v133, v141
    v_fma_f32 v70, v70, v134, v142
    v_fma_f32 v71, v71, v135, v143
    v_cvt_pk_bf16_f32 v64, v64, v65
    v_cvt_pk_bf16_f32 v65, v66, v67
    v_cvt_pk_bf16_f32 v66, v68, v69
    v_cvt_pk_bf16_f32 v67, v70, v71
    ds_write_b128 v5, v[64:67] offset:2080
    v_subrev_f32 v72, s51, v72
    v_subrev_f32 v73, s51, v73
    v_subrev_f32 v74, s51, v74
    v_subrev_f32 v75, s51, v75
    v_subrev_f32 v76, s51, v76
    v_subrev_f32 v77, s51, v77
    v_subrev_f32 v78, s51, v78
    v_subrev_f32 v79, s51, v79
    v_mul_f32 v72, s59, v72
    v_mul_f32 v73, s59, v73
    v_mul_f32 v74, s59, v74
    v_mul_f32 v75, s59, v75
    v_mul_f32 v76, s59, v76
    v_mul_f32 v77, s59, v77
    v_mul_f32 v78, s59, v78
    v_mul_f32 v79, s59, v79
    v_fma_f32 v72, v72, v128, v136
    v_fma_f32 v73, v73, v129, v137
    v_fma_f32 v74, v74, v130, v138
    v_fma_f32 v75, v75, v131, v139
    v_fma_f32 v76, v76, v132, v140
    v_fma_f32 v77, v77, v133, v141
    v_fma_f32 v78, v78, v134, v142
    v_fma_f32 v79, v79, v135, v143
    v_cvt_pk_bf16_f32 v72, v72, v73
    v_cvt_pk_bf16_f32 v73, v74, v75
    v_cvt_pk_bf16_f32 v74, v76, v77
    v_cvt_pk_bf16_f32 v75, v78, v79
    ds_write_b128 v5, v[72:75] offset:3120
    v_subrev_f32 v80, s52, v80
    v_subrev_f32 v81, s52, v81
    v_subrev_f32 v82, s52, v82
    v_subrev_f32 v83, s52, v83
    v_subrev_f32 v84, s52, v84
    v_subrev_f32 v85, s52, v85
    v_subrev_f32 v86, s52, v86
    v_subrev_f32 v87, s52, v87
    v_mul_f32 v80, s60, v80
    v_mul_f32 v81, s60, v81
    v_mul_f32 v82, s60, v82
    v_mul_f32 v83, s60, v83
    v_mul_f32 v84, s60, v84
    v_mul_f32 v85, s60, v85
    v_mul_f32 v86, s60, v86
    v_mul_f32 v87, s60, v87
    v_fma_f32 v80, v80, v128, v136
    v_fma_f32 v81, v81, v129, v137
    v_fma_f32 v82, v82, v130, v138
    v_fma_f32 v83, v83, v131, v139
    v_fma_f32 v84, v84, v132, v140
    v_fma_f32 v85, v85, v133, v141
    v_fma_f32 v86, v86, v134, v142
    v_fma_f32 v87, v87, v135, v143
    v_cvt_pk_bf16_f32 v80, v80, v81
    v_cvt_pk_bf16_f32 v81, v82, v83
    v_cvt_pk_bf16_f32 v82, v84, v85
    v_cvt_pk_bf16_f32 v83, v86, v87
    ds_write_b128 v5, v[80:83] offset:4160
    v_subrev_f32 v88, s53, v88
    v_subrev_f32 v89, s53, v89
    v_subrev_f32 v90, s53, v90
    v_subrev_f32 v91, s53, v91
    v_subrev_f32 v92, s53, v92
    v_subrev_f32 v93, s53, v93
    v_subrev_f32 v94, s53, v94
    v_subrev_f32 v95, s53, v95
    v_mul_f32 v88, s61, v88
    v_mul_f32 v89, s61, v89
    v_mul_f32 v90, s61, v90
    v_mul_f32 v91, s61, v91
    v_mul_f32 v92, s61, v92
    v_mul_f32 v93, s61, v93
    v_mul_f32 v94, s61, v94
    v_mul_f32 v95, s61, v95
    v_fma_f32 v88, v88, v128, v136
    v_fma_f32 v89, v89, v129, v137
    v_fma_f32 v90, v90, v130, v138
    v_fma_f32 v91, v91, v131, v139
    v_fma_f32 v92, v92, v132, v140
    v_fma_f32 v93, v93, v133, v141
    v_fma_f32 v94, v94, v134, v142
    v_fma_f32 v95, v95, v135, v143
    v_cvt_pk_bf16_f32 v88, v88, v89
    v_cvt_pk_bf16_f32 v89, v90, v91
    v_cvt_pk_bf16_f32 v90, v92, v93
    v_cvt_pk_bf16_f32 v91, v94, v95
    ds_write_b128 v5, v[88:91] offset:5200
    v_subrev_f32 v96, s54, v96
    v_subrev_f32 v97, s54, v97
    v_subrev_f32 v98, s54, v98
    v_subrev_f32 v99, s54, v99
    v_subrev_f32 v100, s54, v100
    v_subrev_f32 v101, s54, v101
    v_subrev_f32 v102, s54, v102
    v_subrev_f32 v103, s54, v103
    v_mul_f32 v96, s62, v96
    v_mul_f32 v97, s62, v97
    v_mul_f32 v98, s62, v98
    v_mul_f32 v99, s62, v99
    v_mul_f32 v100, s62, v100
    v_mul_f32 v101, s62, v101
    v_mul_f32 v102, s62, v102
    v_mul_f32 v103, s62, v103
    v_fma_f32 v96, v96, v128, v136
    v_fma_f32 v97, v97, v129, v137
    v_fma_f32 v98, v98, v130, v138
    v_fma_f32 v99, v99, v131, v139
    v_fma_f32 v100, v100, v132, v140
    v_fma_f32 v101, v101, v133, v141
    v_fma_f32 v102, v102, v134, v142
    v_fma_f32 v103, v103, v135, v143
    v_cvt_pk_bf16_f32 v96, v96, v97
    v_cvt_pk_bf16_f32 v97, v98, v99
    v_cvt_pk_bf16_f32 v98, v100, v101
    v_cvt_pk_bf16_f32 v99, v102, v103
    ds_write_b128 v5, v[96:99] offset:6240
    v_subrev_f32 v104, s55, v104
    v_subrev_f32 v105, s55, v105
    v_subrev_f32 v106, s55, v106
    v_subrev_f32 v107, s55, v107
    v_subrev_f32 v108, s55, v108
    v_subrev_f32 v109, s55, v109
    v_subrev_f32 v110, s55, v110
    v_subrev_f32 v111, s55, v111
    v_mul_f32 v104, s63, v104
    v_mul_f32 v105, s63, v105
    v_mul_f32 v106, s63, v106
    v_mul_f32 v107, s63, v107
    v_mul_f32 v108, s63, v108
    v_mul_f32 v109, s63, v109
    v_mul_f32 v110, s63, v110
    v_mul_f32 v111, s63, v111
    v_fma_f32 v104, v104, v128, v136
    v_fma_f32 v105, v105, v129, v137
    v_fma_f32 v106, v106, v130, v138
    v_fma_f32 v107, v107, v131, v139
    v_fma_f32 v108, v108, v132, v140
    v_fma_f32 v109, v109, v133, v141
    v_fma_f32 v110, v110, v134, v142
    v_fma_f32 v111, v111, v135, v143
    v_cvt_pk_bf16_f32 v104, v104, v105
    v_cvt_pk_bf16_f32 v105, v106, v107
    v_cvt_pk_bf16_f32 v106, v108, v109
    v_cvt_pk_bf16_f32 v107, v110, v111
    ds_write_b128 v5, v[104:107] offset:7280
    s_waitcnt lgkmcnt(0)
    s_barrier
    s_mul_i32 s47, s28, 88064
    s_add_u32 s47, s47, s33
    ds_read_b128 v[176:179], v6 offset:0
    ds_read_b128 v[180:183], v6 offset:32
    ds_read_b128 v[184:187], v6 offset:64
    ds_read_b128 v[188:191], v6 offset:96
    ds_read_b128 v[192:195], v6 offset:128
    ds_read_b128 v[196:199], v6 offset:160
    ds_read_b128 v[200:203], v6 offset:192
    ds_read_b128 v[204:207], v6 offset:224
    s_waitcnt lgkmcnt(7)
    v_mfma_f32_32x32x16_bf16 v[144:159], a[0:3], v[176:179], 0
    v_mfma_f32_32x32x16_bf16 v[160:175], a[128:131], v[176:179], 0
    ds_read_b128 v[176:179], v6 offset:256
    s_waitcnt lgkmcnt(7)
    v_mfma_f32_32x32x16_bf16 v[144:159], a[4:7], v[180:183], v[144:159]
    v_mfma_f32_32x32x16_bf16 v[160:175], a[132:135], v[180:183], v[160:175]
    ds_read_b128 v[180:183], v6 offset:288
    s_waitcnt lgkmcnt(7)
    v_mfma_f32_32x32x16_bf16 v[144:159], a[8:11], v[184:187], v[144:159]
    v_mfma_f32_32x32x16_bf16 v[160:175], a[136:139], v[184:187], v[160:175]
    ds_read_b128 v[184:187], v6 offset:320
    s_waitcnt lgkmcnt(7)
    v_mfma_f32_32x32x16_bf16 v[144:159], a[12:15], v[188:191], v[144:159]
    v_mfma_f32_32x32x16_bf16 v[160:175], a[140:143], v[188:191], v[160:175]
    ds_read_b128 v[188:191], v6 offset:352
    s_waitcnt lgkmcnt(7)
    v_mfma_f32_32x32x16_bf16 v[144:159], a[16:19], v[192:195], v[144:159]
    v_mfma_f32_32x32x16_bf16 v[160:175], a[144:147], v[192:195], v[160:175]
    ds_read_b128 v[192:195], v6 offset:384
    s_waitcnt lgkmcnt(7)
    v_mfma_f32_32x32x16_bf16 v[144:159], a[20:23], v[196:199], v[144:159]
    v_mfma_f32_32x32x16_bf16 v[160:175], a[148:151], v[196:199], v[160:175]
    ds_read_b128 v[196:199], v6 offset:416
    s_waitcnt lgkmcnt(7)
    v_mfma_f32_32x32x16_bf16 v[144:159], a[24:27], v[200:203], v[144:159]
    v_mfma_f32_32x32x16_bf16 v[160:175], a[152:155], v[200:203], v[160:175]
    ds_read_b128 v[200:203], v6 offset:448
    s_waitcnt lgkmcnt(7)
    v_mfma_f32_32x32x16_bf16 v[144:159], a[28:31], v[204:207], v[144:159]
    v_mfma_f32_32x32x16_bf16 v[160:175], a[156:159], v[204:207], v[160:175]
    ds_read_b128 v[204:207], v6 offset:480
    s_waitcnt lgkmcnt(7)
    v_mfma_f32_32x32x16_bf16 v[144:159], a[32:35], v[176:179], v[144:159]
    v_mfma_f32_32x32x16_bf16 v[160:175], a[160:163], v[176:179], v[160:175]
    ds_read_b128 v[176:179], v6 offset:512
    s_waitcnt lgkmcnt(7)
    v_mfma_f32_32x32x16_bf16 v[144:159], a[36:39], v[180:183], v[144:159]
    v_mfma_f32_32x32x16_bf16 v[160:175], a[164:167], v[180:183], v[160:175]
    ds_read_b128 v[180:183], v6 offset:544
    s_waitcnt lgkmcnt(7)
    v_mfma_f32_32x32x16_bf16 v[144:159], a[40:43], v[184:187], v[144:159]
    v_mfma_f32_32x32x16_bf16 v[160:175], a[168:171], v[184:187], v[160:175]
    ds_read_b128 v[184:187], v6 offset:576
    s_waitcnt lgkmcnt(7)
    v_mfma_f32_32x32x16_bf16 v[144:159], a[44:47], v[188:191], v[144:159]
    v_mfma_f32_32x32x16_bf16 v[160:175], a[172:175], v[188:191], v[160:175]
    ds_read_b128 v[188:191], v6 offset:608
    s_waitcnt lgkmcnt(7)
    v_mfma_f32_32x32x16_bf16 v[144:159], a[48:51], v[192:195], v[144:159]
    v_mfma_f32_32x32x16_bf16 v[160:175], a[176:179], v[192:195], v[160:175]
    ds_read_b128 v[192:195], v6 offset:640
    s_waitcnt lgkmcnt(7)
    v_mfma_f32_32x32x16_bf16 v[144:159], a[52:55], v[196:199], v[144:159]
    v_mfma_f32_32x32x16_bf16 v[160:175], a[180:183], v[196:199], v[160:175]
    ds_read_b128 v[196:199], v6 offset:672
    s_waitcnt lgkmcnt(7)
    v_mfma_f32_32x32x16_bf16 v[144:159], a[56:59], v[200:203], v[144:159]
    v_mfma_f32_32x32x16_bf16 v[160:175], a[184:187], v[200:203], v[160:175]
    ds_read_b128 v[200:203], v6 offset:704
    s_waitcnt lgkmcnt(7)
    v_mfma_f32_32x32x16_bf16 v[144:159], a[60:63], v[204:207], v[144:159]
    v_mfma_f32_32x32x16_bf16 v[160:175], a[188:191], v[204:207], v[160:175]
    ds_read_b128 v[204:207], v6 offset:736
    s_waitcnt lgkmcnt(7)
    v_mfma_f32_32x32x16_bf16 v[144:159], a[64:67], v[176:179], v[144:159]
    v_mfma_f32_32x32x16_bf16 v[160:175], a[192:195], v[176:179], v[160:175]
    ds_read_b128 v[176:179], v6 offset:768
    s_waitcnt lgkmcnt(7)
    v_mfma_f32_32x32x16_bf16 v[144:159], a[68:71], v[180:183], v[144:159]
    v_mfma_f32_32x32x16_bf16 v[160:175], a[196:199], v[180:183], v[160:175]
    ds_read_b128 v[180:183], v6 offset:800
    s_waitcnt lgkmcnt(7)
    v_mfma_f32_32x32x16_bf16 v[144:159], a[72:75], v[184:187], v[144:159]
    v_mfma_f32_32x32x16_bf16 v[160:175], a[200:203], v[184:187], v[160:175]
    ds_read_b128 v[184:187], v6 offset:832
    s_waitcnt lgkmcnt(7)
    v_mfma_f32_32x32x16_bf16 v[144:159], a[76:79], v[188:191], v[144:159]
    v_mfma_f32_32x32x16_bf16 v[160:175], a[204:207], v[188:191], v[160:175]
    ds_read_b128 v[188:191], v6 offset:864
    s_waitcnt lgkmcnt(7)
    v_mfma_f32_32x32x16_bf16 v[144:159], a[80:83], v[192:195], v[144:159]
    v_mfma_f32_32x32x16_bf16 v[160:175], a[208:211], v[192:195], v[160:175]
    ds_read_b128 v[192:195], v6 offset:896
    s_waitcnt lgkmcnt(7)
    v_mfma_f32_32x32x16_bf16 v[144:159], a[84:87], v[196:199], v[144:159]
    v_mfma_f32_32x32x16_bf16 v[160:175], a[212:215], v[196:199], v[160:175]
    ds_read_b128 v[196:199], v6 offset:928
    s_waitcnt lgkmcnt(7)
    v_mfma_f32_32x32x16_bf16 v[144:159], a[88:91], v[200:203], v[144:159]
    v_mfma_f32_32x32x16_bf16 v[160:175], a[216:219], v[200:203], v[160:175]
    ds_read_b128 v[200:203], v6 offset:960
    s_waitcnt lgkmcnt(7)
    v_mfma_f32_32x32x16_bf16 v[144:159], a[92:95], v[204:207], v[144:159]
    v_mfma_f32_32x32x16_bf16 v[160:175], a[220:223], v[204:207], v[160:175]
    ds_read_b128 v[204:207], v6 offset:992
    s_waitcnt lgkmcnt(7)
    v_mfma_f32_32x32x16_bf16 v[144:159], a[96:99], v[176:179], v[144:159]
    v_mfma_f32_32x32x16_bf16 v[160:175], a[224:227], v[176:179], v[160:175]
    s_waitcnt lgkmcnt(6)
    v_mfma_f32_32x32x16_bf16 v[144:159], a[100:103], v[180:183], v[144:159]
    v_mfma_f32_32x32x16_bf16 v[160:175], a[228:231], v[180:183], v[160:175]
    s_waitcnt lgkmcnt(5)
    v_mfma_f32_32x32x16_bf16 v[144:159], a[104:107], v[184:187], v[144:159]
    v_mfma_f32_32x32x16_bf16 v[160:175], a[232:235], v[184:187], v[160:175]
    s_waitcnt lgkmcnt(4)
    v_mfma_f32_32x32x16_bf16 v[144:159], a[108:111], v[188:191], v[144:159]
    v_mfma_f32_32x32x16_bf16 v[160:175], a[236:239], v[188:191], v[160:175]
    s_waitcnt lgkmcnt(3)
    v_mfma_f32_32x32x16_bf16 v[144:159], a[112:115], v[192:195], v[144:159]
    v_mfma_f32_32x32x16_bf16 v[160:175], a[240:243], v[192:195], v[160:175]
    s_waitcnt lgkmcnt(2)
    v_mfma_f32_32x32x16_bf16 v[144:159], a[116:119], v[196:199], v[144:159]
    v_mfma_f32_32x32x16_bf16 v[160:175], a[244:247], v[196:199], v[160:175]
    s_waitcnt lgkmcnt(1)
    v_mfma_f32_32x32x16_bf16 v[144:159], a[120:123], v[200:203], v[144:159]
    v_mfma_f32_32x32x16_bf16 v[160:175], a[248:251], v[200:203], v[160:175]
    s_waitcnt lgkmcnt(0)
    v_mfma_f32_32x32x16_bf16 v[144:159], a[124:127], v[204:207], v[144:159]
    v_mfma_f32_32x32x16_bf16 v[160:175], a[252:255], v[204:207], v[160:175]
    s_nop 13
    s_cmp_eq_u32 s32, 1
    s_cbranch_scc1 f1r_fin
    s_mov_b32 s48, 0x3d372713
    s_mov_b32 s49, 0x40135761
    v_cvt_pk_bf16_f32 v208, v144, v160
    v_lshlrev_b32 v144, 16, v208
    v_and_b32 v160, s44, v208
    v_cvt_pk_bf16_f32 v209, v152, v168
    v_lshlrev_b32 v152, 16, v209
    v_and_b32 v168, s44, v209
    v_cvt_pk_bf16_f32 v208, v145, v161
    v_lshlrev_b32 v145, 16, v208
    v_and_b32 v161, s44, v208
    v_cvt_pk_bf16_f32 v209, v153, v169
    v_lshlrev_b32 v153, 16, v209
    v_and_b32 v169, s44, v209
    v_cvt_pk_bf16_f32 v208, v146, v162
    v_lshlrev_b32 v146, 16, v208
    v_and_b32 v162, s44, v208
    v_cvt_pk_bf16_f32 v209, v154, v170
    v_lshlrev_b32 v154, 16, v209
    v_and_b32 v170, s44, v209
    v_cvt_pk_bf16_f32 v208, v147, v163
    v_lshlrev_b32 v147, 16, v208
    v_and_b32 v163, s44, v208
    v_cvt_pk_bf16_f32 v209, v155, v171
    v_lshlrev_b32 v155, 16, v209
    v_and_b32 v171, s44, v209
    v_mul_f32 v210, v144, v144
    v_fma_f32 v210, v210, s48, 1.0
    v_mul_f32 v210, v210, v144
    v_mul_f32 v210, s49, v210
    v_mul_f32 v211, v160, v160
    v_fma_f32 v211, v211, s48, 1.0
    v_mul_f32 v211, v211, v160
    v_mul_f32 v211, s49, v211
    v_mul_f32 v212, v145, v145
    v_fma_f32 v212, v212, s48, 1.0
    v_mul_f32 v212, v212, v145
    v_mul_f32 v212, s49, v212
    v_mul_f32 v213, v161, v161
    v_fma_f32 v213, v213, s48, 1.0
    v_mul_f32 v213, v213, v161
    v_mul_f32 v213, s49, v213
    v_mul_f32 v214, v146, v146
    v_fma_f32 v214, v214, s48, 1.0
    v_mul_f32 v214, v214, v146
    v_mul_f32 v214, s49, v214
    v_mul_f32 v215, v162, v162
    v_fma_f32 v215, v215, s48, 1.0
    v_mul_f32 v215, v215, v162
    v_mul_f32 v215, s49, v215
    v_mul_f32 v216, v147, v147
    v_fma_f32 v216, v216, s48, 1.0
    v_mul_f32 v216, v216, v147
    v_mul_f32 v216, s49, v216
    v_mul_f32 v217, v163, v163
    v_fma_f32 v217, v217, s48, 1.0
    v_mul_f32 v217, v217, v163
    v_mul_f32 v217, s49, v217
    v_exp_f32 v210, v210
    v_exp_f32 v211, v211
    v_exp_f32 v212, v212
    v_exp_f32 v213, v213
    v_exp_f32 v214, v214
    v_exp_f32 v215, v215
    v_exp_f32 v216, v216
    v_exp_f32 v217, v217
    s_nop 0
    v_add_f32 v210, 1.0, v210
    v_add_f32 v211, 1.0, v211
    v_add_f32 v212, 1.0, v212
    v_add_f32 v213, 1.0, v213
    v_add_f32 v214, 1.0, v214
    v_add_f32 v215, 1.0, v215
    v_add_f32 v216, 1.0, v216
    v_add_f32 v217, 1.0, v217
    v_rcp_f32 v210, v210
    v_rcp_f32 v211, v211
    v_rcp_f32 v212, v212
    v_rcp_f32 v213, v213
    v_rcp_f32 v214, v214
    v_rcp_f32 v215, v215
    v_rcp_f32 v216, v216
    v_rcp_f32 v217, v217
    s_nop 0
    v_fma_f32 v144, -v144, v210, v144
    v_fma_f32 v160, -v160, v211, v160
    v_fma_f32 v145, -v145, v212, v145
    v_fma_f32 v161, -v161, v213, v161
    v_fma_f32 v146, -v146, v214, v146
    v_fma_f32 v162, -v162, v215, v162
    v_fma_f32 v147, -v147, v216, v147
    v_fma_f32 v163, -v163, v217, v163
    v_cvt_pk_bf16_f32 v208, v144, v160
    v_lshlrev_b32 v144, 16, v208
    v_and_b32 v160, s44, v208
    v_mul_f32 v144, v144, v152
    v_mul_f32 v160, v160, v168
    v_cvt_pk_bf16_f32 v220, v144, v160
    v_cvt_pk_bf16_f32 v208, v145, v161
    v_lshlrev_b32 v145, 16, v208
    v_and_b32 v161, s44, v208
    v_mul_f32 v145, v145, v153
    v_mul_f32 v161, v161, v169
    v_cvt_pk_bf16_f32 v221, v145, v161
    v_cvt_pk_bf16_f32 v208, v146, v162
    v_lshlrev_b32 v146, 16, v208
    v_and_b32 v162, s44, v208
    v_mul_f32 v146, v146, v154
    v_mul_f32 v162, v162, v170
    v_cvt_pk_bf16_f32 v222, v146, v162
    v_cvt_pk_bf16_f32 v208, v147, v163
    v_lshlrev_b32 v147, 16, v208
    v_and_b32 v163, s44, v208
    v_mul_f32 v147, v147, v155
    v_mul_f32 v163, v163, v171
    v_cvt_pk_bf16_f32 v223, v147, v163
    buffer_store_dwordx4 v[220:223], v7, s[20:23], s47 offen offset:0 sc1
    v_cvt_pk_bf16_f32 v208, v148, v164
    v_lshlrev_b32 v148, 16, v208
    v_and_b32 v164, s44, v208
    v_cvt_pk_bf16_f32 v209, v156, v172
    v_lshlrev_b32 v156, 16, v209
    v_and_b32 v172, s44, v209
    v_cvt_pk_bf16_f32 v208, v149, v165
    v_lshlrev_b32 v149, 16, v208
    v_and_b32 v165, s44, v208
    v_cvt_pk_bf16_f32 v209, v157, v173
    v_lshlrev_b32 v157, 16, v209
    v_and_b32 v173, s44, v209
    v_cvt_pk_bf16_f32 v208, v150, v166
    v_lshlrev_b32 v150, 16, v208
    v_and_b32 v166, s44, v208
    v_cvt_pk_bf16_f32 v209, v158, v174
    v_lshlrev_b32 v158, 16, v209
    v_and_b32 v174, s44, v209
    v_cvt_pk_bf16_f32 v208, v151, v167
    v_lshlrev_b32 v151, 16, v208
    v_and_b32 v167, s44, v208
    v_cvt_pk_bf16_f32 v209, v159, v175
    v_lshlrev_b32 v159, 16, v209
    v_and_b32 v175, s44, v209
    v_mul_f32 v210, v148, v148
    v_fma_f32 v210, v210, s48, 1.0
    v_mul_f32 v210, v210, v148
    v_mul_f32 v210, s49, v210
    v_mul_f32 v211, v164, v164
    v_fma_f32 v211, v211, s48, 1.0
    v_mul_f32 v211, v211, v164
    v_mul_f32 v211, s49, v211
    v_mul_f32 v212, v149, v149
    v_fma_f32 v212, v212, s48, 1.0
    v_mul_f32 v212, v212, v149
    v_mul_f32 v212, s49, v212
    v_mul_f32 v213, v165, v165
    v_fma_f32 v213, v213, s48, 1.0
    v_mul_f32 v213, v213, v165
    v_mul_f32 v213, s49, v213
    v_mul_f32 v214, v150, v150
    v_fma_f32 v214, v214, s48, 1.0
    v_mul_f32 v214, v214, v150
    v_mul_f32 v214, s49, v214
    v_mul_f32 v215, v166, v166
    v_fma_f32 v215, v215, s48, 1.0
    v_mul_f32 v215, v215, v166
    v_mul_f32 v215, s49, v215
    v_mul_f32 v216, v151, v151
    v_fma_f32 v216, v216, s48, 1.0
    v_mul_f32 v216, v216, v151
    v_mul_f32 v216, s49, v216
    v_mul_f32 v217, v167, v167
    v_fma_f32 v217, v217, s48, 1.0
    v_mul_f32 v217, v217, v167
    v_mul_f32 v217, s49, v217
    v_exp_f32 v210, v210
    v_exp_f32 v211, v211
    v_exp_f32 v212, v212
    v_exp_f32 v213, v213
    v_exp_f32 v214, v214
    v_exp_f32 v215, v215
    v_exp_f32 v216, v216
    v_exp_f32 v217, v217
    s_nop 0
    v_add_f32 v210, 1.0, v210
    v_add_f32 v211, 1.0, v211
    v_add_f32 v212, 1.0, v212
    v_add_f32 v213, 1.0, v213
    v_add_f32 v214, 1.0, v214
    v_add_f32 v215, 1.0, v215
    v_add_f32 v216, 1.0, v216
    v_add_f32 v217, 1.0, v217
    v_rcp_f32 v210, v210
    v_rcp_f32 v211, v211
    v_rcp_f32 v212, v212
    v_rcp_f32 v213, v213
    v_rcp_f32 v214, v214
    v_rcp_f32 v215, v215
    v_rcp_f32 v216, v216
    v_rcp_f32 v217, v217
    s_nop 0
    v_fma_f32 v148, -v148, v210, v148
    v_fma_f32 v164, -v164, v211, v164
    v_fma_f32 v149, -v149, v212, v149
    v_fma_f32 v165, -v165, v213, v165
    v_fma_f32 v150, -v150, v214, v150
    v_fma_f32 v166, -v166, v215, v166
    v_fma_f32 v151, -v151, v216, v151
    v_fma_f32 v167, -v167, v217, v167
    v_cvt_pk_bf16_f32 v208, v148, v164
    v_lshlrev_b32 v148, 16, v208
    v_and_b32 v164, s44, v208
    v_mul_f32 v148, v148, v156
    v_mul_f32 v164, v164, v172
    v_cvt_pk_bf16_f32 v224, v148, v164
    v_cvt_pk_bf16_f32 v208, v149, v165
    v_lshlrev_b32 v149, 16, v208
    v_and_b32 v165, s44, v208
    v_mul_f32 v149, v149, v157
    v_mul_f32 v165, v165, v173
    v_cvt_pk_bf16_f32 v225, v149, v165
    v_cvt_pk_bf16_f32 v208, v150, v166
    v_lshlrev_b32 v150, 16, v208
    v_and_b32 v166, s44, v208
    v_mul_f32 v150, v150, v158
    v_mul_f32 v166, v166, v174
    v_cvt_pk_bf16_f32 v226, v150, v166
    v_cvt_pk_bf16_f32 v208, v151, v167
    v_lshlrev_b32 v151, 16, v208
    v_and_b32 v167, s44, v208
    v_mul_f32 v151, v151, v159
    v_mul_f32 v167, v167, v175
    v_cvt_pk_bf16_f32 v227, v151, v167
    buffer_store_dwordx4 v[224:227], v7, s[20:23], s47 offen offset:1024 sc1
f1r_fin:
    s_lshl_b32 s65, s28, 4
    s_add_u32 s65, s65, 0xac00
    s_waitcnt vmcnt(0)
    s_barrier
    s_cmp_lg_u32 s40, 0
    s_cbranch_scc1 f1r_b
    v_mov_b32 v250, 0
    v_mov_b32 v251, 1
    s_mov_b64 exec, 1
    buffer_atomic_add v251, v250, s[24:27], s65 offen sc1
    s_mov_b64 exec, -1
f1r_b:
    s_add_u32 s28, s28, s29
    s_cmp_lt_u32 s28, s30
    s_cbranch_scc1 f1r_loop
    s_sub_u32 s69, s68, 115
    s_branch main_done
main_chain:
    s_load_dwordx2 s[46:47], s[0:1], 16
    s_load_dwordx2 s[48:49], s[0:1], 24
    s_load_dwordx2 s[50:51], s[0:1], 32
    s_load_dwordx2 s[52:53], s[0:1], 40
    s_load_dwordx2 s[54:55], s[0:1], 112
    v_lshrrev_b32 v1, 6, v0
    s_nop 0
    v_readfirstlane_b32 s30, v1
    s_mov_b32 s44, 0x05040100
    s_mov_b32 s45, 0x07060302
    s_waitcnt lgkmcnt(0)

    s_mov_b32 s8, s4
    s_mov_b32 s9, s5
    s_mov_b32 s10, 0x200000
    s_mov_b32 s11, 0x20000
    s_add_u32 s12, s4, 0x2000000
    s_addc_u32 s13, s5, 0
    s_mov_b32 s14, 0x1000000
    s_mov_b32 s15, 0x20000
    s_add_u32 s16, s4, 0x3000000
    s_addc_u32 s17, s5, 0
    s_mov_b32 s18, 0x1000000
    s_mov_b32 s19, 0x20000
    s_add_u32 s20, s4, 0x200000
    s_addc_u32 s21, s5, 0
    s_mov_b32 s22, 0x800000
    s_mov_b32 s23, 0x20000
    s_add_u32 s24, s4, 0xa00000
    s_addc_u32 s25, s5, 0
    s_mov_b32 s26, 0x400000
    s_mov_b32 s27, 0x20000
    s_mov_b32 s56, s54
    s_mov_b32 s57, s55
    s_mov_b32 s58, 0x100
    s_mov_b32 s59, 0x20000
    s_getreg_b32 s62, hwreg(HW_REG_XCC_ID)
    s_and_b32 s62, s62, 7
    s_lshl_b32 s62, s62, 3
    s_lshl_b64 s[60:61], 1, s62
    v_and_b32 v0, 63, v0
    s_cmp_lg_u32 s30, 0
    s_cbranch_scc1 chain_r0
    v_mov_b32 v2, s60
    v_mov_b32 v3, s61
    v_mov_b32 v4, 0
    s_mov_b64 exec, 1
    buffer_atomic_add_x2 v[2:3], v4, s[56:59], 0 offen sc1
    s_mov_b64 exec, -1

chain_r0:
    v_and_b32 v20, 15, v0
    v_lshrrev_b32 v21, 4, v0
    v_lshrrev_b32 v22, 1, v21
    v_and_b32 v23, 1, v21
    v_lshl_add_u32 v19, v23, 3, v22
    v_lshlrev_b32 v19, 13, v19
    v_lshl_add_u32 v19, v20, 2, v19
    s_lshl_b32 s36, s29, 8
    s_lshl_b32 s38, s30, 6
    s_add_u32 s36, s36, s38
    v_add_u32 v19, s36, v19

    s_mov_b32 s64, s46
    s_mov_b32 s65, s47
    s_mov_b32 s66, 0x400000
    s_mov_b32 s67, 0x20000
    s_mov_b32 s36, 0
    buffer_load_dword v28, v19, s[64:67], s36 offen
    s_mov_b32 s36, 16384
    buffer_load_dword v29, v19, s[64:67], s36 offen
    s_mov_b32 s36, 131072
    buffer_load_dword v30, v19, s[64:67], s36 offen
    s_mov_b32 s36, 147456
    buffer_load_dword v31, v19, s[64:67], s36 offen
    s_mov_b32 s36, 32768
    buffer_load_dword v32, v19, s[64:67], s36 offen
    s_mov_b32 s36, 49152
    buffer_load_dword v33, v19, s[64:67], s36 offen
    s_mov_b32 s36, 163840
    buffer_load_dword v34, v19, s[64:67], s36 offen
    s_mov_b32 s36, 180224
    buffer_load_dword v35, v19, s[64:67], s36 offen
    s_mov_b32 s36, 262144
    buffer_load_dword v36, v19, s[64:67], s36 offen
    s_mov_b32 s36, 278528
    buffer_load_dword v37, v19, s[64:67], s36 offen
    s_mov_b32 s36, 393216
    buffer_load_dword v38, v19, s[64:67], s36 offen
    s_mov_b32 s36, 409600
    buffer_load_dword v39, v19, s[64:67], s36 offen
    s_mov_b32 s36, 294912
    buffer_load_dword v40, v19, s[64:67], s36 offen
    s_mov_b32 s36, 311296
    buffer_load_dword v41, v19, s[64:67], s36 offen
    s_mov_b32 s36, 425984
    buffer_load_dword v42, v19, s[64:67], s36 offen
    s_mov_b32 s36, 442368
    buffer_load_dword v43, v19, s[64:67], s36 offen
    s_mov_b32 s36, 524288
    buffer_load_dword v44, v19, s[64:67], s36 offen
    s_mov_b32 s36, 540672
    buffer_load_dword v45, v19, s[64:67], s36 offen
    s_mov_b32 s36, 655360
    buffer_load_dword v46, v19, s[64:67], s36 offen
    s_mov_b32 s36, 671744
    buffer_load_dword v47, v19, s[64:67], s36 offen
    s_mov_b32 s36, 557056
    buffer_load_dword v48, v19, s[64:67], s36 offen
    s_mov_b32 s36, 573440
    buffer_load_dword v49, v19, s[64:67], s36 offen
    s_mov_b32 s36, 688128
    buffer_load_dword v50, v19, s[64:67], s36 offen
    s_mov_b32 s36, 704512
    buffer_load_dword v51, v19, s[64:67], s36 offen
    s_mov_b32 s36, 786432
    buffer_load_dword v52, v19, s[64:67], s36 offen
    s_mov_b32 s36, 802816
    buffer_load_dword v53, v19, s[64:67], s36 offen
    s_mov_b32 s36, 917504
    buffer_load_dword v54, v19, s[64:67], s36 offen
    s_mov_b32 s36, 933888
    buffer_load_dword v55, v19, s[64:67], s36 offen
    s_mov_b32 s36, 819200
    buffer_load_dword v56, v19, s[64:67], s36 offen
    s_mov_b32 s36, 835584
    buffer_load_dword v57, v19, s[64:67], s36 offen
    s_mov_b32 s36, 950272
    buffer_load_dword v58, v19, s[64:67], s36 offen
    s_mov_b32 s36, 966656
    buffer_load_dword v59, v19, s[64:67], s36 offen
    s_mov_b32 s36, 1048576
    buffer_load_dword v60, v19, s[64:67], s36 offen
    s_mov_b32 s36, 1064960
    buffer_load_dword v61, v19, s[64:67], s36 offen
    s_mov_b32 s36, 1179648
    buffer_load_dword v62, v19, s[64:67], s36 offen
    s_mov_b32 s36, 1196032
    buffer_load_dword v63, v19, s[64:67], s36 offen
    s_mov_b32 s36, 1081344
    buffer_load_dword v64, v19, s[64:67], s36 offen
    s_mov_b32 s36, 1097728
    buffer_load_dword v65, v19, s[64:67], s36 offen
    s_mov_b32 s36, 1212416
    buffer_load_dword v66, v19, s[64:67], s36 offen
    s_mov_b32 s36, 1228800
    buffer_load_dword v67, v19, s[64:67], s36 offen
    s_mov_b32 s36, 1310720
    buffer_load_dword v68, v19, s[64:67], s36 offen
    s_mov_b32 s36, 1327104
    buffer_load_dword v69, v19, s[64:67], s36 offen
    s_mov_b32 s36, 1441792
    buffer_load_dword v70, v19, s[64:67], s36 offen
    s_mov_b32 s36, 1458176
    buffer_load_dword v71, v19, s[64:67], s36 offen
    s_mov_b32 s36, 1343488
    buffer_load_dword v72, v19, s[64:67], s36 offen
    s_mov_b32 s36, 1359872
    buffer_load_dword v73, v19, s[64:67], s36 offen
    s_mov_b32 s36, 1474560
    buffer_load_dword v74, v19, s[64:67], s36 offen
    s_mov_b32 s36, 1490944
    buffer_load_dword v75, v19, s[64:67], s36 offen
    s_waitcnt vmcnt(32)
    v_perm_b32 v76, v29, v28, s44
    v_perm_b32 v77, v31, v30, s44
    v_perm_b32 v78, v33, v32, s44
    v_perm_b32 v79, v35, v34, s44
    v_perm_b32 v80, v37, v36, s44
    v_perm_b32 v81, v39, v38, s44
    v_perm_b32 v82, v41, v40, s44
    v_perm_b32 v83, v43, v42, s44
    v_perm_b32 v84, v29, v28, s45
    v_perm_b32 v85, v31, v30, s45
    v_perm_b32 v86, v33, v32, s45
    v_perm_b32 v87, v35, v34, s45
    v_perm_b32 v88, v37, v36, s45
    v_perm_b32 v89, v39, v38, s45
    v_perm_b32 v90, v41, v40, s45
    v_perm_b32 v91, v43, v42, s45
    v_accvgpr_write_b32 a0, v76
    v_accvgpr_write_b32 a1, v77
    v_accvgpr_write_b32 a2, v78
    v_accvgpr_write_b32 a3, v79
    v_accvgpr_write_b32 a4, v80
    v_accvgpr_write_b32 a5, v81
    v_accvgpr_write_b32 a6, v82
    v_accvgpr_write_b32 a7, v83
    v_accvgpr_write_b32 a64, v84
    v_accvgpr_write_b32 a65, v85
    v_accvgpr_write_b32 a66, v86
    v_accvgpr_write_b32 a67, v87
    v_accvgpr_write_b32 a68, v88
    v_accvgpr_write_b32 a69, v89
    v_accvgpr_write_b32 a70, v90
    v_accvgpr_write_b32 a71, v91
    s_mov_b32 s36, 1572864
    buffer_load_dword v28, v19, s[64:67], s36 offen
    s_mov_b32 s36, 1589248
    buffer_load_dword v29, v19, s[64:67], s36 offen
    s_mov_b32 s36, 1703936
    buffer_load_dword v30, v19, s[64:67], s36 offen
    s_mov_b32 s36, 1720320
    buffer_load_dword v31, v19, s[64:67], s36 offen
    s_mov_b32 s36, 1605632
    buffer_load_dword v32, v19, s[64:67], s36 offen
    s_mov_b32 s36, 1622016
    buffer_load_dword v33, v19, s[64:67], s36 offen
    s_mov_b32 s36, 1736704
    buffer_load_dword v34, v19, s[64:67], s36 offen
    s_mov_b32 s36, 1753088
    buffer_load_dword v35, v19, s[64:67], s36 offen
    s_mov_b32 s36, 1835008
    buffer_load_dword v36, v19, s[64:67], s36 offen
    s_mov_b32 s36, 1851392
    buffer_load_dword v37, v19, s[64:67], s36 offen
    s_mov_b32 s36, 1966080
    buffer_load_dword v38, v19, s[64:67], s36 offen
    s_mov_b32 s36, 1982464
    buffer_load_dword v39, v19, s[64:67], s36 offen
    s_mov_b32 s36, 1867776
    buffer_load_dword v40, v19, s[64:67], s36 offen
    s_mov_b32 s36, 1884160
    buffer_load_dword v41, v19, s[64:67], s36 offen
    s_mov_b32 s36, 1998848
    buffer_load_dword v42, v19, s[64:67], s36 offen
    s_mov_b32 s36, 2015232
    buffer_load_dword v43, v19, s[64:67], s36 offen
    s_waitcnt vmcnt(32)
    v_perm_b32 v76, v45, v44, s44
    v_perm_b32 v77, v47, v46, s44
    v_perm_b32 v78, v49, v48, s44
    v_perm_b32 v79, v51, v50, s44
    v_perm_b32 v80, v53, v52, s44
    v_perm_b32 v81, v55, v54, s44
    v_perm_b32 v82, v57, v56, s44
    v_perm_b32 v83, v59, v58, s44
    v_perm_b32 v84, v45, v44, s45
    v_perm_b32 v85, v47, v46, s45
    v_perm_b32 v86, v49, v48, s45
    v_perm_b32 v87, v51, v50, s45
    v_perm_b32 v88, v53, v52, s45
    v_perm_b32 v89, v55, v54, s45
    v_perm_b32 v90, v57, v56, s45
    v_perm_b32 v91, v59, v58, s45
    v_accvgpr_write_b32 a8, v76
    v_accvgpr_write_b32 a9, v77
    v_accvgpr_write_b32 a10, v78
    v_accvgpr_write_b32 a11, v79
    v_accvgpr_write_b32 a12, v80
    v_accvgpr_write_b32 a13, v81
    v_accvgpr_write_b32 a14, v82
    v_accvgpr_write_b32 a15, v83
    v_accvgpr_write_b32 a72, v84
    v_accvgpr_write_b32 a73, v85
    v_accvgpr_write_b32 a74, v86
    v_accvgpr_write_b32 a75, v87
    v_accvgpr_write_b32 a76, v88
    v_accvgpr_write_b32 a77, v89
    v_accvgpr_write_b32 a78, v90
    v_accvgpr_write_b32 a79, v91
    s_mov_b32 s36, 2097152
    buffer_load_dword v44, v19, s[64:67], s36 offen
    s_mov_b32 s36, 2113536
    buffer_load_dword v45, v19, s[64:67], s36 offen
    s_mov_b32 s36, 2228224
    buffer_load_dword v46, v19, s[64:67], s36 offen
    s_mov_b32 s36, 2244608
    buffer_load_dword v47, v19, s[64:67], s36 offen
    s_mov_b32 s36, 2129920
    buffer_load_dword v48, v19, s[64:67], s36 offen
    s_mov_b32 s36, 2146304
    buffer_load_dword v49, v19, s[64:67], s36 offen
    s_mov_b32 s36, 2260992
    buffer_load_dword v50, v19, s[64:67], s36 offen
    s_mov_b32 s36, 2277376
    buffer_load_dword v51, v19, s[64:67], s36 offen
    s_mov_b32 s36, 2359296
    buffer_load_dword v52, v19, s[64:67], s36 offen
    s_mov_b32 s36, 2375680
    buffer_load_dword v53, v19, s[64:67], s36 offen
    s_mov_b32 s36, 2490368
    buffer_load_dword v54, v19, s[64:67], s36 offen
    s_mov_b32 s36, 2506752
    buffer_load_dword v55, v19, s[64:67], s36 offen
    s_mov_b32 s36, 2392064
    buffer_load_dword v56, v19, s[64:67], s36 offen
    s_mov_b32 s36, 2408448
    buffer_load_dword v57, v19, s[64:67], s36 offen
    s_mov_b32 s36, 2523136
    buffer_load_dword v58, v19, s[64:67], s36 offen
    s_mov_b32 s36, 2539520
    buffer_load_dword v59, v19, s[64:67], s36 offen
    s_waitcnt vmcnt(32)
    v_perm_b32 v76, v61, v60, s44
    v_perm_b32 v77, v63, v62, s44
    v_perm_b32 v78, v65, v64, s44
    v_perm_b32 v79, v67, v66, s44
    v_perm_b32 v80, v69, v68, s44
    v_perm_b32 v81, v71, v70, s44
    v_perm_b32 v82, v73, v72, s44
    v_perm_b32 v83, v75, v74, s44
    v_perm_b32 v84, v61, v60, s45
    v_perm_b32 v85, v63, v62, s45
    v_perm_b32 v86, v65, v64, s45
    v_perm_b32 v87, v67, v66, s45
    v_perm_b32 v88, v69, v68, s45
    v_perm_b32 v89, v71, v70, s45
    v_perm_b32 v90, v73, v72, s45
    v_perm_b32 v91, v75, v74, s45
    v_accvgpr_write_b32 a16, v76
    v_accvgpr_write_b32 a17, v77
    v_accvgpr_write_b32 a18, v78
    v_accvgpr_write_b32 a19, v79
    v_accvgpr_write_b32 a20, v80
    v_accvgpr_write_b32 a21, v81
    v_accvgpr_write_b32 a22, v82
    v_accvgpr_write_b32 a23, v83
    v_accvgpr_write_b32 a80, v84
    v_accvgpr_write_b32 a81, v85
    v_accvgpr_write_b32 a82, v86
    v_accvgpr_write_b32 a83, v87
    v_accvgpr_write_b32 a84, v88
    v_accvgpr_write_b32 a85, v89
    v_accvgpr_write_b32 a86, v90
    v_accvgpr_write_b32 a87, v91
    s_mov_b32 s36, 2621440
    buffer_load_dword v60, v19, s[64:67], s36 offen
    s_mov_b32 s36, 2637824
    buffer_load_dword v61, v19, s[64:67], s36 offen
    s_mov_b32 s36, 2752512
    buffer_load_dword v62, v19, s[64:67], s36 offen
    s_mov_b32 s36, 2768896
    buffer_load_dword v63, v19, s[64:67], s36 offen
    s_mov_b32 s36, 2654208
    buffer_load_dword v64, v19, s[64:67], s36 offen
    s_mov_b32 s36, 2670592
    buffer_load_dword v65, v19, s[64:67], s36 offen
    s_mov_b32 s36, 2785280
    buffer_load_dword v66, v19, s[64:67], s36 offen
    s_mov_b32 s36, 2801664
    buffer_load_dword v67, v19, s[64:67], s36 offen
    s_mov_b32 s36, 2883584
    buffer_load_dword v68, v19, s[64:67], s36 offen
    s_mov_b32 s36, 2899968
    buffer_load_dword v69, v19, s[64:67], s36 offen
    s_mov_b32 s36, 3014656
    buffer_load_dword v70, v19, s[64:67], s36 offen
    s_mov_b32 s36, 3031040
    buffer_load_dword v71, v19, s[64:67], s36 offen
    s_mov_b32 s36, 2916352
    buffer_load_dword v72, v19, s[64:67], s36 offen
    s_mov_b32 s36, 2932736
    buffer_load_dword v73, v19, s[64:67], s36 offen
    s_mov_b32 s36, 3047424
    buffer_load_dword v74, v19, s[64:67], s36 offen
    s_mov_b32 s36, 3063808
    buffer_load_dword v75, v19, s[64:67], s36 offen
    s_waitcnt vmcnt(32)
    v_perm_b32 v76, v29, v28, s44
    v_perm_b32 v77, v31, v30, s44
    v_perm_b32 v78, v33, v32, s44
    v_perm_b32 v79, v35, v34, s44
    v_perm_b32 v80, v37, v36, s44
    v_perm_b32 v81, v39, v38, s44
    v_perm_b32 v82, v41, v40, s44
    v_perm_b32 v83, v43, v42, s44
    v_perm_b32 v84, v29, v28, s45
    v_perm_b32 v85, v31, v30, s45
    v_perm_b32 v86, v33, v32, s45
    v_perm_b32 v87, v35, v34, s45
    v_perm_b32 v88, v37, v36, s45
    v_perm_b32 v89, v39, v38, s45
    v_perm_b32 v90, v41, v40, s45
    v_perm_b32 v91, v43, v42, s45
    v_accvgpr_write_b32 a24, v76
    v_accvgpr_write_b32 a25, v77
    v_accvgpr_write_b32 a26, v78
    v_accvgpr_write_b32 a27, v79
    v_accvgpr_write_b32 a28, v80
    v_accvgpr_write_b32 a29, v81
    v_accvgpr_write_b32 a30, v82
    v_accvgpr_write_b32 a31, v83
    v_accvgpr_write_b32 a88, v84
    v_accvgpr_write_b32 a89, v85
    v_accvgpr_write_b32 a90, v86
    v_accvgpr_write_b32 a91, v87
    v_accvgpr_write_b32 a92, v88
    v_accvgpr_write_b32 a93, v89
    v_accvgpr_write_b32 a94, v90
    v_accvgpr_write_b32 a95, v91
    s_mov_b32 s36, 3145728
    buffer_load_dword v28, v19, s[64:67], s36 offen
    s_mov_b32 s36, 3162112
    buffer_load_dword v29, v19, s[64:67], s36 offen
    s_mov_b32 s36, 3276800
    buffer_load_dword v30, v19, s[64:67], s36 offen
    s_mov_b32 s36, 3293184
    buffer_load_dword v31, v19, s[64:67], s36 offen
    s_mov_b32 s36, 3178496
    buffer_load_dword v32, v19, s[64:67], s36 offen
    s_mov_b32 s36, 3194880
    buffer_load_dword v33, v19, s[64:67], s36 offen
    s_mov_b32 s36, 3309568
    buffer_load_dword v34, v19, s[64:67], s36 offen
    s_mov_b32 s36, 3325952
    buffer_load_dword v35, v19, s[64:67], s36 offen
    s_mov_b32 s36, 3407872
    buffer_load_dword v36, v19, s[64:67], s36 offen
    s_mov_b32 s36, 3424256
    buffer_load_dword v37, v19, s[64:67], s36 offen
    s_mov_b32 s36, 3538944
    buffer_load_dword v38, v19, s[64:67], s36 offen
    s_mov_b32 s36, 3555328
    buffer_load_dword v39, v19, s[64:67], s36 offen
    s_mov_b32 s36, 3440640
    buffer_load_dword v40, v19, s[64:67], s36 offen
    s_mov_b32 s36, 3457024
    buffer_load_dword v41, v19, s[64:67], s36 offen
    s_mov_b32 s36, 3571712
    buffer_load_dword v42, v19, s[64:67], s36 offen
    s_mov_b32 s36, 3588096
    buffer_load_dword v43, v19, s[64:67], s36 offen
    s_waitcnt vmcnt(32)
    v_perm_b32 v76, v45, v44, s44
    v_perm_b32 v77, v47, v46, s44
    v_perm_b32 v78, v49, v48, s44
    v_perm_b32 v79, v51, v50, s44
    v_perm_b32 v80, v53, v52, s44
    v_perm_b32 v81, v55, v54, s44
    v_perm_b32 v82, v57, v56, s44
    v_perm_b32 v83, v59, v58, s44
    v_perm_b32 v84, v45, v44, s45
    v_perm_b32 v85, v47, v46, s45
    v_perm_b32 v86, v49, v48, s45
    v_perm_b32 v87, v51, v50, s45
    v_perm_b32 v88, v53, v52, s45
    v_perm_b32 v89, v55, v54, s45
    v_perm_b32 v90, v57, v56, s45
    v_perm_b32 v91, v59, v58, s45
    v_accvgpr_write_b32 a32, v76
    v_accvgpr_write_b32 a33, v77
    v_accvgpr_write_b32 a34, v78
    v_accvgpr_write_b32 a35, v79
    v_accvgpr_write_b32 a36, v80
    v_accvgpr_write_b32 a37, v81
    v_accvgpr_write_b32 a38, v82
    v_accvgpr_write_b32 a39, v83
    v_accvgpr_write_b32 a96, v84
    v_accvgpr_write_b32 a97, v85
    v_accvgpr_write_b32 a98, v86
    v_accvgpr_write_b32 a99, v87
    v_accvgpr_write_b32 a100, v88
    v_accvgpr_write_b32 a101, v89
    v_accvgpr_write_b32 a102, v90
    v_accvgpr_write_b32 a103, v91
    s_mov_b32 s36, 3670016
    buffer_load_dword v44, v19, s[64:67], s36 offen
    s_mov_b32 s36, 3686400
    buffer_load_dword v45, v19, s[64:67], s36 offen
    s_mov_b32 s36, 3801088
    buffer_load_dword v46, v19, s[64:67], s36 offen
    s_mov_b32 s36, 3817472
    buffer_load_dword v47, v19, s[64:67], s36 offen
    s_mov_b32 s36, 3702784
    buffer_load_dword v48, v19, s[64:67], s36 offen
    s_mov_b32 s36, 3719168
    buffer_load_dword v49, v19, s[64:67], s36 offen
    s_mov_b32 s36, 3833856
    buffer_load_dword v50, v19, s[64:67], s36 offen
    s_mov_b32 s36, 3850240
    buffer_load_dword v51, v19, s[64:67], s36 offen
    s_mov_b32 s36, 3932160
    buffer_load_dword v52, v19, s[64:67], s36 offen
    s_mov_b32 s36, 3948544
    buffer_load_dword v53, v19, s[64:67], s36 offen
    s_mov_b32 s36, 4063232
    buffer_load_dword v54, v19, s[64:67], s36 offen
    s_mov_b32 s36, 4079616
    buffer_load_dword v55, v19, s[64:67], s36 offen
    s_mov_b32 s36, 3964928
    buffer_load_dword v56, v19, s[64:67], s36 offen
    s_mov_b32 s36, 3981312
    buffer_load_dword v57, v19, s[64:67], s36 offen
    s_mov_b32 s36, 4096000
    buffer_load_dword v58, v19, s[64:67], s36 offen
    s_mov_b32 s36, 4112384
    buffer_load_dword v59, v19, s[64:67], s36 offen
    s_waitcnt vmcnt(32)
    v_perm_b32 v76, v61, v60, s44
    v_perm_b32 v77, v63, v62, s44
    v_perm_b32 v78, v65, v64, s44
    v_perm_b32 v79, v67, v66, s44
    v_perm_b32 v80, v69, v68, s44
    v_perm_b32 v81, v71, v70, s44
    v_perm_b32 v82, v73, v72, s44
    v_perm_b32 v83, v75, v74, s44
    v_perm_b32 v84, v61, v60, s45
    v_perm_b32 v85, v63, v62, s45
    v_perm_b32 v86, v65, v64, s45
    v_perm_b32 v87, v67, v66, s45
    v_perm_b32 v88, v69, v68, s45
    v_perm_b32 v89, v71, v70, s45
    v_perm_b32 v90, v73, v72, s45
    v_perm_b32 v91, v75, v74, s45
    v_accvgpr_write_b32 a40, v76
    v_accvgpr_write_b32 a41, v77
    v_accvgpr_write_b32 a42, v78
    v_accvgpr_write_b32 a43, v79
    v_accvgpr_write_b32 a44, v80
    v_accvgpr_write_b32 a45, v81
    v_accvgpr_write_b32 a46, v82
    v_accvgpr_write_b32 a47, v83
    v_accvgpr_write_b32 a104, v84
    v_accvgpr_write_b32 a105, v85
    v_accvgpr_write_b32 a106, v86
    v_accvgpr_write_b32 a107, v87
    v_accvgpr_write_b32 a108, v88
    v_accvgpr_write_b32 a109, v89
    v_accvgpr_write_b32 a110, v90
    v_accvgpr_write_b32 a111, v91
    s_waitcnt vmcnt(16)
    v_perm_b32 v76, v29, v28, s44
    v_perm_b32 v77, v31, v30, s44
    v_perm_b32 v78, v33, v32, s44
    v_perm_b32 v79, v35, v34, s44
    v_perm_b32 v80, v37, v36, s44
    v_perm_b32 v81, v39, v38, s44
    v_perm_b32 v82, v41, v40, s44
    v_perm_b32 v83, v43, v42, s44
    v_perm_b32 v84, v29, v28, s45
    v_perm_b32 v85, v31, v30, s45
    v_perm_b32 v86, v33, v32, s45
    v_perm_b32 v87, v35, v34, s45
    v_perm_b32 v88, v37, v36, s45
    v_perm_b32 v89, v39, v38, s45
    v_perm_b32 v90, v41, v40, s45
    v_perm_b32 v91, v43, v42, s45
    v_accvgpr_write_b32 a48, v76
    v_accvgpr_write_b32 a49, v77
    v_accvgpr_write_b32 a50, v78
    v_accvgpr_write_b32 a51, v79
    v_accvgpr_write_b32 a52, v80
    v_accvgpr_write_b32 a53, v81
    v_accvgpr_write_b32 a54, v82
    v_accvgpr_write_b32 a55, v83
    v_accvgpr_write_b32 a112, v84
    v_accvgpr_write_b32 a113, v85
    v_accvgpr_write_b32 a114, v86
    v_accvgpr_write_b32 a115, v87
    v_accvgpr_write_b32 a116, v88
    v_accvgpr_write_b32 a117, v89
    v_accvgpr_write_b32 a118, v90
    v_accvgpr_write_b32 a119, v91
    s_waitcnt vmcnt(0)
    v_perm_b32 v76, v45, v44, s44
    v_perm_b32 v77, v47, v46, s44
    v_perm_b32 v78, v49, v48, s44
    v_perm_b32 v79, v51, v50, s44
    v_perm_b32 v80, v53, v52, s44
    v_perm_b32 v81, v55, v54, s44
    v_perm_b32 v82, v57, v56, s44
    v_perm_b32 v83, v59, v58, s44
    v_perm_b32 v84, v45, v44, s45
    v_perm_b32 v85, v47, v46, s45
    v_perm_b32 v86, v49, v48, s45
    v_perm_b32 v87, v51, v50, s45
    v_perm_b32 v88, v53, v52, s45
    v_perm_b32 v89, v55, v54, s45
    v_perm_b32 v90, v57, v56, s45
    v_perm_b32 v91, v59, v58, s45
    v_accvgpr_write_b32 a56, v76
    v_accvgpr_write_b32 a57, v77
    v_accvgpr_write_b32 a58, v78
    v_accvgpr_write_b32 a59, v79
    v_accvgpr_write_b32 a60, v80
    v_accvgpr_write_b32 a61, v81
    v_accvgpr_write_b32 a62, v82
    v_accvgpr_write_b32 a63, v83
    v_accvgpr_write_b32 a120, v84
    v_accvgpr_write_b32 a121, v85
    v_accvgpr_write_b32 a122, v86
    v_accvgpr_write_b32 a123, v87
    v_accvgpr_write_b32 a124, v88
    v_accvgpr_write_b32 a125, v89
    v_accvgpr_write_b32 a126, v90
    v_accvgpr_write_b32 a127, v91
    s_mov_b32 s64, s48
    s_mov_b32 s65, s49
    s_mov_b32 s66, 0x400000
    s_mov_b32 s67, 0x20000
    s_mov_b32 s36, 0
    buffer_load_dword v28, v19, s[64:67], s36 offen
    s_mov_b32 s36, 16384
    buffer_load_dword v29, v19, s[64:67], s36 offen
    s_mov_b32 s36, 131072
    buffer_load_dword v30, v19, s[64:67], s36 offen
    s_mov_b32 s36, 147456
    buffer_load_dword v31, v19, s[64:67], s36 offen
    s_mov_b32 s36, 32768
    buffer_load_dword v32, v19, s[64:67], s36 offen
    s_mov_b32 s36, 49152
    buffer_load_dword v33, v19, s[64:67], s36 offen
    s_mov_b32 s36, 163840
    buffer_load_dword v34, v19, s[64:67], s36 offen
    s_mov_b32 s36, 180224
    buffer_load_dword v35, v19, s[64:67], s36 offen
    s_mov_b32 s36, 262144
    buffer_load_dword v36, v19, s[64:67], s36 offen
    s_mov_b32 s36, 278528
    buffer_load_dword v37, v19, s[64:67], s36 offen
    s_mov_b32 s36, 393216
    buffer_load_dword v38, v19, s[64:67], s36 offen
    s_mov_b32 s36, 409600
    buffer_load_dword v39, v19, s[64:67], s36 offen
    s_mov_b32 s36, 294912
    buffer_load_dword v40, v19, s[64:67], s36 offen
    s_mov_b32 s36, 311296
    buffer_load_dword v41, v19, s[64:67], s36 offen
    s_mov_b32 s36, 425984
    buffer_load_dword v42, v19, s[64:67], s36 offen
    s_mov_b32 s36, 442368
    buffer_load_dword v43, v19, s[64:67], s36 offen
    s_mov_b32 s36, 524288
    buffer_load_dword v44, v19, s[64:67], s36 offen
    s_mov_b32 s36, 540672
    buffer_load_dword v45, v19, s[64:67], s36 offen
    s_mov_b32 s36, 655360
    buffer_load_dword v46, v19, s[64:67], s36 offen
    s_mov_b32 s36, 671744
    buffer_load_dword v47, v19, s[64:67], s36 offen
    s_mov_b32 s36, 557056
    buffer_load_dword v48, v19, s[64:67], s36 offen
    s_mov_b32 s36, 573440
    buffer_load_dword v49, v19, s[64:67], s36 offen
    s_mov_b32 s36, 688128
    buffer_load_dword v50, v19, s[64:67], s36 offen
    s_mov_b32 s36, 704512
    buffer_load_dword v51, v19, s[64:67], s36 offen
    s_mov_b32 s36, 786432
    buffer_load_dword v52, v19, s[64:67], s36 offen
    s_mov_b32 s36, 802816
    buffer_load_dword v53, v19, s[64:67], s36 offen
    s_mov_b32 s36, 917504
    buffer_load_dword v54, v19, s[64:67], s36 offen
    s_mov_b32 s36, 933888
    buffer_load_dword v55, v19, s[64:67], s36 offen
    s_mov_b32 s36, 819200
    buffer_load_dword v56, v19, s[64:67], s36 offen
    s_mov_b32 s36, 835584
    buffer_load_dword v57, v19, s[64:67], s36 offen
    s_mov_b32 s36, 950272
    buffer_load_dword v58, v19, s[64:67], s36 offen
    s_mov_b32 s36, 966656
    buffer_load_dword v59, v19, s[64:67], s36 offen
    s_mov_b32 s36, 1048576
    buffer_load_dword v60, v19, s[64:67], s36 offen
    s_mov_b32 s36, 1064960
    buffer_load_dword v61, v19, s[64:67], s36 offen
    s_mov_b32 s36, 1179648
    buffer_load_dword v62, v19, s[64:67], s36 offen
    s_mov_b32 s36, 1196032
    buffer_load_dword v63, v19, s[64:67], s36 offen
    s_mov_b32 s36, 1081344
    buffer_load_dword v64, v19, s[64:67], s36 offen
    s_mov_b32 s36, 1097728
    buffer_load_dword v65, v19, s[64:67], s36 offen
    s_mov_b32 s36, 1212416
    buffer_load_dword v66, v19, s[64:67], s36 offen
    s_mov_b32 s36, 1228800
    buffer_load_dword v67, v19, s[64:67], s36 offen
    s_mov_b32 s36, 1310720
    buffer_load_dword v68, v19, s[64:67], s36 offen
    s_mov_b32 s36, 1327104
    buffer_load_dword v69, v19, s[64:67], s36 offen
    s_mov_b32 s36, 1441792
    buffer_load_dword v70, v19, s[64:67], s36 offen
    s_mov_b32 s36, 1458176
    buffer_load_dword v71, v19, s[64:67], s36 offen
    s_mov_b32 s36, 1343488
    buffer_load_dword v72, v19, s[64:67], s36 offen
    s_mov_b32 s36, 1359872
    buffer_load_dword v73, v19, s[64:67], s36 offen
    s_mov_b32 s36, 1474560
    buffer_load_dword v74, v19, s[64:67], s36 offen
    s_mov_b32 s36, 1490944
    buffer_load_dword v75, v19, s[64:67], s36 offen
    s_waitcnt vmcnt(32)
    v_perm_b32 v76, v29, v28, s44
    v_perm_b32 v77, v31, v30, s44
    v_perm_b32 v78, v33, v32, s44
    v_perm_b32 v79, v35, v34, s44
    v_perm_b32 v80, v37, v36, s44
    v_perm_b32 v81, v39, v38, s44
    v_perm_b32 v82, v41, v40, s44
    v_perm_b32 v83, v43, v42, s44
    v_perm_b32 v84, v29, v28, s45
    v_perm_b32 v85, v31, v30, s45
    v_perm_b32 v86, v33, v32, s45
    v_perm_b32 v87, v35, v34, s45
    v_perm_b32 v88, v37, v36, s45
    v_perm_b32 v89, v39, v38, s45
    v_perm_b32 v90, v41, v40, s45
    v_perm_b32 v91, v43, v42, s45
    v_accvgpr_write_b32 a128, v76
    v_accvgpr_write_b32 a129, v77
    v_accvgpr_write_b32 a130, v78
    v_accvgpr_write_b32 a131, v79
    v_accvgpr_write_b32 a132, v80
    v_accvgpr_write_b32 a133, v81
    v_accvgpr_write_b32 a134, v82
    v_accvgpr_write_b32 a135, v83
    v_accvgpr_write_b32 a192, v84
    v_accvgpr_write_b32 a193, v85
    v_accvgpr_write_b32 a194, v86
    v_accvgpr_write_b32 a195, v87
    v_accvgpr_write_b32 a196, v88
    v_accvgpr_write_b32 a197, v89
    v_accvgpr_write_b32 a198, v90
    v_accvgpr_write_b32 a199, v91
    s_mov_b32 s36, 1572864
    buffer_load_dword v28, v19, s[64:67], s36 offen
    s_mov_b32 s36, 1589248
    buffer_load_dword v29, v19, s[64:67], s36 offen
    s_mov_b32 s36, 1703936
    buffer_load_dword v30, v19, s[64:67], s36 offen
    s_mov_b32 s36, 1720320
    buffer_load_dword v31, v19, s[64:67], s36 offen
    s_mov_b32 s36, 1605632
    buffer_load_dword v32, v19, s[64:67], s36 offen
    s_mov_b32 s36, 1622016
    buffer_load_dword v33, v19, s[64:67], s36 offen
    s_mov_b32 s36, 1736704
    buffer_load_dword v34, v19, s[64:67], s36 offen
    s_mov_b32 s36, 1753088
    buffer_load_dword v35, v19, s[64:67], s36 offen
    s_mov_b32 s36, 1835008
    buffer_load_dword v36, v19, s[64:67], s36 offen
    s_mov_b32 s36, 1851392
    buffer_load_dword v37, v19, s[64:67], s36 offen
    s_mov_b32 s36, 1966080
    buffer_load_dword v38, v19, s[64:67], s36 offen
    s_mov_b32 s36, 1982464
    buffer_load_dword v39, v19, s[64:67], s36 offen
    s_mov_b32 s36, 1867776
    buffer_load_dword v40, v19, s[64:67], s36 offen
    s_mov_b32 s36, 1884160
    buffer_load_dword v41, v19, s[64:67], s36 offen
    s_mov_b32 s36, 1998848
    buffer_load_dword v42, v19, s[64:67], s36 offen
    s_mov_b32 s36, 2015232
    buffer_load_dword v43, v19, s[64:67], s36 offen
    s_waitcnt vmcnt(32)
    v_perm_b32 v76, v45, v44, s44
    v_perm_b32 v77, v47, v46, s44
    v_perm_b32 v78, v49, v48, s44
    v_perm_b32 v79, v51, v50, s44
    v_perm_b32 v80, v53, v52, s44
    v_perm_b32 v81, v55, v54, s44
    v_perm_b32 v82, v57, v56, s44
    v_perm_b32 v83, v59, v58, s44
    v_perm_b32 v84, v45, v44, s45
    v_perm_b32 v85, v47, v46, s45
    v_perm_b32 v86, v49, v48, s45
    v_perm_b32 v87, v51, v50, s45
    v_perm_b32 v88, v53, v52, s45
    v_perm_b32 v89, v55, v54, s45
    v_perm_b32 v90, v57, v56, s45
    v_perm_b32 v91, v59, v58, s45
    v_accvgpr_write_b32 a136, v76
    v_accvgpr_write_b32 a137, v77
    v_accvgpr_write_b32 a138, v78
    v_accvgpr_write_b32 a139, v79
    v_accvgpr_write_b32 a140, v80
    v_accvgpr_write_b32 a141, v81
    v_accvgpr_write_b32 a142, v82
    v_accvgpr_write_b32 a143, v83
    v_accvgpr_write_b32 a200, v84
    v_accvgpr_write_b32 a201, v85
    v_accvgpr_write_b32 a202, v86
    v_accvgpr_write_b32 a203, v87
    v_accvgpr_write_b32 a204, v88
    v_accvgpr_write_b32 a205, v89
    v_accvgpr_write_b32 a206, v90
    v_accvgpr_write_b32 a207, v91
    s_mov_b32 s36, 2097152
    buffer_load_dword v44, v19, s[64:67], s36 offen
    s_mov_b32 s36, 2113536
    buffer_load_dword v45, v19, s[64:67], s36 offen
    s_mov_b32 s36, 2228224
    buffer_load_dword v46, v19, s[64:67], s36 offen
    s_mov_b32 s36, 2244608
    buffer_load_dword v47, v19, s[64:67], s36 offen
    s_mov_b32 s36, 2129920
    buffer_load_dword v48, v19, s[64:67], s36 offen
    s_mov_b32 s36, 2146304
    buffer_load_dword v49, v19, s[64:67], s36 offen
    s_mov_b32 s36, 2260992
    buffer_load_dword v50, v19, s[64:67], s36 offen
    s_mov_b32 s36, 2277376
    buffer_load_dword v51, v19, s[64:67], s36 offen
    s_mov_b32 s36, 2359296
    buffer_load_dword v52, v19, s[64:67], s36 offen
    s_mov_b32 s36, 2375680
    buffer_load_dword v53, v19, s[64:67], s36 offen
    s_mov_b32 s36, 2490368
    buffer_load_dword v54, v19, s[64:67], s36 offen
    s_mov_b32 s36, 2506752
    buffer_load_dword v55, v19, s[64:67], s36 offen
    s_mov_b32 s36, 2392064
    buffer_load_dword v56, v19, s[64:67], s36 offen
    s_mov_b32 s36, 2408448
    buffer_load_dword v57, v19, s[64:67], s36 offen
    s_mov_b32 s36, 2523136
    buffer_load_dword v58, v19, s[64:67], s36 offen
    s_mov_b32 s36, 2539520
    buffer_load_dword v59, v19, s[64:67], s36 offen
    s_waitcnt vmcnt(32)
    v_perm_b32 v76, v61, v60, s44
    v_perm_b32 v77, v63, v62, s44
    v_perm_b32 v78, v65, v64, s44
    v_perm_b32 v79, v67, v66, s44
    v_perm_b32 v80, v69, v68, s44
    v_perm_b32 v81, v71, v70, s44
    v_perm_b32 v82, v73, v72, s44
    v_perm_b32 v83, v75, v74, s44
    v_perm_b32 v84, v61, v60, s45
    v_perm_b32 v85, v63, v62, s45
    v_perm_b32 v86, v65, v64, s45
    v_perm_b32 v87, v67, v66, s45
    v_perm_b32 v88, v69, v68, s45
    v_perm_b32 v89, v71, v70, s45
    v_perm_b32 v90, v73, v72, s45
    v_perm_b32 v91, v75, v74, s45
    v_accvgpr_write_b32 a144, v76
    v_accvgpr_write_b32 a145, v77
    v_accvgpr_write_b32 a146, v78
    v_accvgpr_write_b32 a147, v79
    v_accvgpr_write_b32 a148, v80
    v_accvgpr_write_b32 a149, v81
    v_accvgpr_write_b32 a150, v82
    v_accvgpr_write_b32 a151, v83
    v_accvgpr_write_b32 a208, v84
    v_accvgpr_write_b32 a209, v85
    v_accvgpr_write_b32 a210, v86
    v_accvgpr_write_b32 a211, v87
    v_accvgpr_write_b32 a212, v88
    v_accvgpr_write_b32 a213, v89
    v_accvgpr_write_b32 a214, v90
    v_accvgpr_write_b32 a215, v91
    s_mov_b32 s36, 2621440
    buffer_load_dword v60, v19, s[64:67], s36 offen
    s_mov_b32 s36, 2637824
    buffer_load_dword v61, v19, s[64:67], s36 offen
    s_mov_b32 s36, 2752512
    buffer_load_dword v62, v19, s[64:67], s36 offen
    s_mov_b32 s36, 2768896
    buffer_load_dword v63, v19, s[64:67], s36 offen
    s_mov_b32 s36, 2654208
    buffer_load_dword v64, v19, s[64:67], s36 offen
    s_mov_b32 s36, 2670592
    buffer_load_dword v65, v19, s[64:67], s36 offen
    s_mov_b32 s36, 2785280
    buffer_load_dword v66, v19, s[64:67], s36 offen
    s_mov_b32 s36, 2801664
    buffer_load_dword v67, v19, s[64:67], s36 offen
    s_mov_b32 s36, 2883584
    buffer_load_dword v68, v19, s[64:67], s36 offen
    s_mov_b32 s36, 2899968
    buffer_load_dword v69, v19, s[64:67], s36 offen
    s_mov_b32 s36, 3014656
    buffer_load_dword v70, v19, s[64:67], s36 offen
    s_mov_b32 s36, 3031040
    buffer_load_dword v71, v19, s[64:67], s36 offen
    s_mov_b32 s36, 2916352
    buffer_load_dword v72, v19, s[64:67], s36 offen
    s_mov_b32 s36, 2932736
    buffer_load_dword v73, v19, s[64:67], s36 offen
    s_mov_b32 s36, 3047424
    buffer_load_dword v74, v19, s[64:67], s36 offen
    s_mov_b32 s36, 3063808
    buffer_load_dword v75, v19, s[64:67], s36 offen
    s_waitcnt vmcnt(32)
    v_perm_b32 v76, v29, v28, s44
    v_perm_b32 v77, v31, v30, s44
    v_perm_b32 v78, v33, v32, s44
    v_perm_b32 v79, v35, v34, s44
    v_perm_b32 v80, v37, v36, s44
    v_perm_b32 v81, v39, v38, s44
    v_perm_b32 v82, v41, v40, s44
    v_perm_b32 v83, v43, v42, s44
    v_perm_b32 v84, v29, v28, s45
    v_perm_b32 v85, v31, v30, s45
    v_perm_b32 v86, v33, v32, s45
    v_perm_b32 v87, v35, v34, s45
    v_perm_b32 v88, v37, v36, s45
    v_perm_b32 v89, v39, v38, s45
    v_perm_b32 v90, v41, v40, s45
    v_perm_b32 v91, v43, v42, s45
    v_accvgpr_write_b32 a152, v76
    v_accvgpr_write_b32 a153, v77
    v_accvgpr_write_b32 a154, v78
    v_accvgpr_write_b32 a155, v79
    v_accvgpr_write_b32 a156, v80
    v_accvgpr_write_b32 a157, v81
    v_accvgpr_write_b32 a158, v82
    v_accvgpr_write_b32 a159, v83
    v_accvgpr_write_b32 a216, v84
    v_accvgpr_write_b32 a217, v85
    v_accvgpr_write_b32 a218, v86
    v_accvgpr_write_b32 a219, v87
    v_accvgpr_write_b32 a220, v88
    v_accvgpr_write_b32 a221, v89
    v_accvgpr_write_b32 a222, v90
    v_accvgpr_write_b32 a223, v91
    s_mov_b32 s36, 3145728
    buffer_load_dword v28, v19, s[64:67], s36 offen
    s_mov_b32 s36, 3162112
    buffer_load_dword v29, v19, s[64:67], s36 offen
    s_mov_b32 s36, 3276800
    buffer_load_dword v30, v19, s[64:67], s36 offen
    s_mov_b32 s36, 3293184
    buffer_load_dword v31, v19, s[64:67], s36 offen
    s_mov_b32 s36, 3178496
    buffer_load_dword v32, v19, s[64:67], s36 offen
    s_mov_b32 s36, 3194880
    buffer_load_dword v33, v19, s[64:67], s36 offen
    s_mov_b32 s36, 3309568
    buffer_load_dword v34, v19, s[64:67], s36 offen
    s_mov_b32 s36, 3325952
    buffer_load_dword v35, v19, s[64:67], s36 offen
    s_mov_b32 s36, 3407872
    buffer_load_dword v36, v19, s[64:67], s36 offen
    s_mov_b32 s36, 3424256
    buffer_load_dword v37, v19, s[64:67], s36 offen
    s_mov_b32 s36, 3538944
    buffer_load_dword v38, v19, s[64:67], s36 offen
    s_mov_b32 s36, 3555328
    buffer_load_dword v39, v19, s[64:67], s36 offen
    s_mov_b32 s36, 3440640
    buffer_load_dword v40, v19, s[64:67], s36 offen
    s_mov_b32 s36, 3457024
    buffer_load_dword v41, v19, s[64:67], s36 offen
    s_mov_b32 s36, 3571712
    buffer_load_dword v42, v19, s[64:67], s36 offen
    s_mov_b32 s36, 3588096
    buffer_load_dword v43, v19, s[64:67], s36 offen
    s_waitcnt vmcnt(32)
    v_perm_b32 v76, v45, v44, s44
    v_perm_b32 v77, v47, v46, s44
    v_perm_b32 v78, v49, v48, s44
    v_perm_b32 v79, v51, v50, s44
    v_perm_b32 v80, v53, v52, s44
    v_perm_b32 v81, v55, v54, s44
    v_perm_b32 v82, v57, v56, s44
    v_perm_b32 v83, v59, v58, s44
    v_perm_b32 v84, v45, v44, s45
    v_perm_b32 v85, v47, v46, s45
    v_perm_b32 v86, v49, v48, s45
    v_perm_b32 v87, v51, v50, s45
    v_perm_b32 v88, v53, v52, s45
    v_perm_b32 v89, v55, v54, s45
    v_perm_b32 v90, v57, v56, s45
    v_perm_b32 v91, v59, v58, s45
    v_accvgpr_write_b32 a160, v76
    v_accvgpr_write_b32 a161, v77
    v_accvgpr_write_b32 a162, v78
    v_accvgpr_write_b32 a163, v79
    v_accvgpr_write_b32 a164, v80
    v_accvgpr_write_b32 a165, v81
    v_accvgpr_write_b32 a166, v82
    v_accvgpr_write_b32 a167, v83
    v_accvgpr_write_b32 a224, v84
    v_accvgpr_write_b32 a225, v85
    v_accvgpr_write_b32 a226, v86
    v_accvgpr_write_b32 a227, v87
    v_accvgpr_write_b32 a228, v88
    v_accvgpr_write_b32 a229, v89
    v_accvgpr_write_b32 a230, v90
    v_accvgpr_write_b32 a231, v91
    s_mov_b32 s36, 3670016
    buffer_load_dword v44, v19, s[64:67], s36 offen
    s_mov_b32 s36, 3686400
    buffer_load_dword v45, v19, s[64:67], s36 offen
    s_mov_b32 s36, 3801088
    buffer_load_dword v46, v19, s[64:67], s36 offen
    s_mov_b32 s36, 3817472
    buffer_load_dword v47, v19, s[64:67], s36 offen
    s_mov_b32 s36, 3702784
    buffer_load_dword v48, v19, s[64:67], s36 offen
    s_mov_b32 s36, 3719168
    buffer_load_dword v49, v19, s[64:67], s36 offen
    s_mov_b32 s36, 3833856
    buffer_load_dword v50, v19, s[64:67], s36 offen
    s_mov_b32 s36, 3850240
    buffer_load_dword v51, v19, s[64:67], s36 offen
    s_mov_b32 s36, 3932160
    buffer_load_dword v52, v19, s[64:67], s36 offen
    s_mov_b32 s36, 3948544
    buffer_load_dword v53, v19, s[64:67], s36 offen
    s_mov_b32 s36, 4063232
    buffer_load_dword v54, v19, s[64:67], s36 offen
    s_mov_b32 s36, 4079616
    buffer_load_dword v55, v19, s[64:67], s36 offen
    s_mov_b32 s36, 3964928
    buffer_load_dword v56, v19, s[64:67], s36 offen
    s_mov_b32 s36, 3981312
    buffer_load_dword v57, v19, s[64:67], s36 offen
    s_mov_b32 s36, 4096000
    buffer_load_dword v58, v19, s[64:67], s36 offen
    s_mov_b32 s36, 4112384
    buffer_load_dword v59, v19, s[64:67], s36 offen
    s_waitcnt vmcnt(32)
    v_perm_b32 v76, v61, v60, s44
    v_perm_b32 v77, v63, v62, s44
    v_perm_b32 v78, v65, v64, s44
    v_perm_b32 v79, v67, v66, s44
    v_perm_b32 v80, v69, v68, s44
    v_perm_b32 v81, v71, v70, s44
    v_perm_b32 v82, v73, v72, s44
    v_perm_b32 v83, v75, v74, s44
    v_perm_b32 v84, v61, v60, s45
    v_perm_b32 v85, v63, v62, s45
    v_perm_b32 v86, v65, v64, s45
    v_perm_b32 v87, v67, v66, s45
    v_perm_b32 v88, v69, v68, s45
    v_perm_b32 v89, v71, v70, s45
    v_perm_b32 v90, v73, v72, s45
    v_perm_b32 v91, v75, v74, s45
    v_accvgpr_write_b32 a168, v76
    v_accvgpr_write_b32 a169, v77
    v_accvgpr_write_b32 a170, v78
    v_accvgpr_write_b32 a171, v79
    v_accvgpr_write_b32 a172, v80
    v_accvgpr_write_b32 a173, v81
    v_accvgpr_write_b32 a174, v82
    v_accvgpr_write_b32 a175, v83
    v_accvgpr_write_b32 a232, v84
    v_accvgpr_write_b32 a233, v85
    v_accvgpr_write_b32 a234, v86
    v_accvgpr_write_b32 a235, v87
    v_accvgpr_write_b32 a236, v88
    v_accvgpr_write_b32 a237, v89
    v_accvgpr_write_b32 a238, v90
    v_accvgpr_write_b32 a239, v91
    s_waitcnt vmcnt(16)
    v_perm_b32 v76, v29, v28, s44
    v_perm_b32 v77, v31, v30, s44
    v_perm_b32 v78, v33, v32, s44
    v_perm_b32 v79, v35, v34, s44
    v_perm_b32 v80, v37, v36, s44
    v_perm_b32 v81, v39, v38, s44
    v_perm_b32 v82, v41, v40, s44
    v_perm_b32 v83, v43, v42, s44
    v_perm_b32 v84, v29, v28, s45
    v_perm_b32 v85, v31, v30, s45
    v_perm_b32 v86, v33, v32, s45
    v_perm_b32 v87, v35, v34, s45
    v_perm_b32 v88, v37, v36, s45
    v_perm_b32 v89, v39, v38, s45
    v_perm_b32 v90, v41, v40, s45
    v_perm_b32 v91, v43, v42, s45
    v_accvgpr_write_b32 a176, v76
    v_accvgpr_write_b32 a177, v77
    v_accvgpr_write_b32 a178, v78
    v_accvgpr_write_b32 a179, v79
    v_accvgpr_write_b32 a180, v80
    v_accvgpr_write_b32 a181, v81
    v_accvgpr_write_b32 a182, v82
    v_accvgpr_write_b32 a183, v83
    v_accvgpr_write_b32 a240, v84
    v_accvgpr_write_b32 a241, v85
    v_accvgpr_write_b32 a242, v86
    v_accvgpr_write_b32 a243, v87
    v_accvgpr_write_b32 a244, v88
    v_accvgpr_write_b32 a245, v89
    v_accvgpr_write_b32 a246, v90
    v_accvgpr_write_b32 a247, v91
    s_waitcnt vmcnt(0)
    v_perm_b32 v76, v45, v44, s44
    v_perm_b32 v77, v47, v46, s44
    v_perm_b32 v78, v49, v48, s44
    v_perm_b32 v79, v51, v50, s44
    v_perm_b32 v80, v53, v52, s44
    v_perm_b32 v81, v55, v54, s44
    v_perm_b32 v82, v57, v56, s44
    v_perm_b32 v83, v59, v58, s44
    v_perm_b32 v84, v45, v44, s45
    v_perm_b32 v85, v47, v46, s45
    v_perm_b32 v86, v49, v48, s45
    v_perm_b32 v87, v51, v50, s45
    v_perm_b32 v88, v53, v52, s45
    v_perm_b32 v89, v55, v54, s45
    v_perm_b32 v90, v57, v56, s45
    v_perm_b32 v91, v59, v58, s45
    v_accvgpr_write_b32 a184, v76
    v_accvgpr_write_b32 a185, v77
    v_accvgpr_write_b32 a186, v78
    v_accvgpr_write_b32 a187, v79
    v_accvgpr_write_b32 a188, v80
    v_accvgpr_write_b32 a189, v81
    v_accvgpr_write_b32 a190, v82
    v_accvgpr_write_b32 a191, v83
    v_accvgpr_write_b32 a248, v84
    v_accvgpr_write_b32 a249, v85
    v_accvgpr_write_b32 a250, v86
    v_accvgpr_write_b32 a251, v87
    v_accvgpr_write_b32 a252, v88
    v_accvgpr_write_b32 a253, v89
    v_accvgpr_write_b32 a254, v90
    v_accvgpr_write_b32 a255, v91
    s_mov_b32 s64, s50
    s_mov_b32 s65, s51
    s_mov_b32 s66, 0x400000
    s_mov_b32 s67, 0x20000
    v_lshlrev_b32 v4, 4, v0
    s_lshl_b32 s36, s30, 15
    v_add_u32 v4, s36, v4
    s_mov_b32 s36, 0
    buffer_load_dword v28, v19, s[64:67], s36 offen
    s_mov_b32 s36, 16384
    buffer_load_dword v29, v19, s[64:67], s36 offen
    s_mov_b32 s36, 131072
    buffer_load_dword v30, v19, s[64:67], s36 offen
    s_mov_b32 s36, 147456
    buffer_load_dword v31, v19, s[64:67], s36 offen
    s_mov_b32 s36, 32768
    buffer_load_dword v32, v19, s[64:67], s36 offen
    s_mov_b32 s36, 49152
    buffer_load_dword v33, v19, s[64:67], s36 offen
    s_mov_b32 s36, 163840
    buffer_load_dword v34, v19, s[64:67], s36 offen
    s_mov_b32 s36, 180224
    buffer_load_dword v35, v19, s[64:67], s36 offen
    s_mov_b32 s36, 262144
    buffer_load_dword v36, v19, s[64:67], s36 offen
    s_mov_b32 s36, 278528
    buffer_load_dword v37, v19, s[64:67], s36 offen
    s_mov_b32 s36, 393216
    buffer_load_dword v38, v19, s[64:67], s36 offen
    s_mov_b32 s36, 409600
    buffer_load_dword v39, v19, s[64:67], s36 offen
    s_mov_b32 s36, 294912
    buffer_load_dword v40, v19, s[64:67], s36 offen
    s_mov_b32 s36, 311296
    buffer_load_dword v41, v19, s[64:67], s36 offen
    s_mov_b32 s36, 425984
    buffer_load_dword v42, v19, s[64:67], s36 offen
    s_mov_b32 s36, 442368
    buffer_load_dword v43, v19, s[64:67], s36 offen
    s_mov_b32 s36, 524288
    buffer_load_dword v44, v19, s[64:67], s36 offen
    s_mov_b32 s36, 540672
    buffer_load_dword v45, v19, s[64:67], s36 offen
    s_mov_b32 s36, 655360
    buffer_load_dword v46, v19, s[64:67], s36 offen
    s_mov_b32 s36, 671744
    buffer_load_dword v47, v19, s[64:67], s36 offen
    s_mov_b32 s36, 557056
    buffer_load_dword v48, v19, s[64:67], s36 offen
    s_mov_b32 s36, 573440
    buffer_load_dword v49, v19, s[64:67], s36 offen
    s_mov_b32 s36, 688128
    buffer_load_dword v50, v19, s[64:67], s36 offen
    s_mov_b32 s36, 704512
    buffer_load_dword v51, v19, s[64:67], s36 offen
    s_mov_b32 s36, 786432
    buffer_load_dword v52, v19, s[64:67], s36 offen
    s_mov_b32 s36, 802816
    buffer_load_dword v53, v19, s[64:67], s36 offen
    s_mov_b32 s36, 917504
    buffer_load_dword v54, v19, s[64:67], s36 offen
    s_mov_b32 s36, 933888
    buffer_load_dword v55, v19, s[64:67], s36 offen
    s_mov_b32 s36, 819200
    buffer_load_dword v56, v19, s[64:67], s36 offen
    s_mov_b32 s36, 835584
    buffer_load_dword v57, v19, s[64:67], s36 offen
    s_mov_b32 s36, 950272
    buffer_load_dword v58, v19, s[64:67], s36 offen
    s_mov_b32 s36, 966656
    buffer_load_dword v59, v19, s[64:67], s36 offen
    s_mov_b32 s36, 1048576
    buffer_load_dword v60, v19, s[64:67], s36 offen
    s_mov_b32 s36, 1064960
    buffer_load_dword v61, v19, s[64:67], s36 offen
    s_mov_b32 s36, 1179648
    buffer_load_dword v62, v19, s[64:67], s36 offen
    s_mov_b32 s36, 1196032
    buffer_load_dword v63, v19, s[64:67], s36 offen
    s_mov_b32 s36, 1081344
    buffer_load_dword v64, v19, s[64:67], s36 offen
    s_mov_b32 s36, 1097728
    buffer_load_dword v65, v19, s[64:67], s36 offen
    s_mov_b32 s36, 1212416
    buffer_load_dword v66, v19, s[64:67], s36 offen
    s_mov_b32 s36, 1228800
    buffer_load_dword v67, v19, s[64:67], s36 offen
    s_mov_b32 s36, 1310720
    buffer_load_dword v68, v19, s[64:67], s36 offen
    s_mov_b32 s36, 1327104
    buffer_load_dword v69, v19, s[64:67], s36 offen
    s_mov_b32 s36, 1441792
    buffer_load_dword v70, v19, s[64:67], s36 offen
    s_mov_b32 s36, 1458176
    buffer_load_dword v71, v19, s[64:67], s36 offen
    s_mov_b32 s36, 1343488
    buffer_load_dword v72, v19, s[64:67], s36 offen
    s_mov_b32 s36, 1359872
    buffer_load_dword v73, v19, s[64:67], s36 offen
    s_mov_b32 s36, 1474560
    buffer_load_dword v74, v19, s[64:67], s36 offen
    s_mov_b32 s36, 1490944
    buffer_load_dword v75, v19, s[64:67], s36 offen
    s_waitcnt vmcnt(32)
    v_perm_b32 v76, v29, v28, s44
    v_perm_b32 v77, v31, v30, s44
    v_perm_b32 v78, v33, v32, s44
    v_perm_b32 v79, v35, v34, s44
    v_perm_b32 v80, v37, v36, s44
    v_perm_b32 v81, v39, v38, s44
    v_perm_b32 v82, v41, v40, s44
    v_perm_b32 v83, v43, v42, s44
    v_perm_b32 v84, v29, v28, s45
    v_perm_b32 v85, v31, v30, s45
    v_perm_b32 v86, v33, v32, s45
    v_perm_b32 v87, v35, v34, s45
    v_perm_b32 v88, v37, v36, s45
    v_perm_b32 v89, v39, v38, s45
    v_perm_b32 v90, v41, v40, s45
    v_perm_b32 v91, v43, v42, s45
    ds_write_b128 v4, v[76:79] offset:0
    ds_write_b128 v4, v[80:83] offset:1024
    ds_write_b128 v4, v[84:87] offset:16384
    ds_write_b128 v4, v[88:91] offset:17408
    s_waitcnt lgkmcnt(0)
    s_mov_b32 s36, 1572864
    buffer_load_dword v28, v19, s[64:67], s36 offen
    s_mov_b32 s36, 1589248
    buffer_load_dword v29, v19, s[64:67], s36 offen
    s_mov_b32 s36, 1703936
    buffer_load_dword v30, v19, s[64:67], s36 offen
    s_mov_b32 s36, 1720320
    buffer_load_dword v31, v19, s[64:67], s36 offen
    s_mov_b32 s36, 1605632
    buffer_load_dword v32, v19, s[64:67], s36 offen
    s_mov_b32 s36, 1622016
    buffer_load_dword v33, v19, s[64:67], s36 offen
    s_mov_b32 s36, 1736704
    buffer_load_dword v34, v19, s[64:67], s36 offen
    s_mov_b32 s36, 1753088
    buffer_load_dword v35, v19, s[64:67], s36 offen
    s_mov_b32 s36, 1835008
    buffer_load_dword v36, v19, s[64:67], s36 offen
    s_mov_b32 s36, 1851392
    buffer_load_dword v37, v19, s[64:67], s36 offen
    s_mov_b32 s36, 1966080
    buffer_load_dword v38, v19, s[64:67], s36 offen
    s_mov_b32 s36, 1982464
    buffer_load_dword v39, v19, s[64:67], s36 offen
    s_mov_b32 s36, 1867776
    buffer_load_dword v40, v19, s[64:67], s36 offen
    s_mov_b32 s36, 1884160
    buffer_load_dword v41, v19, s[64:67], s36 offen
    s_mov_b32 s36, 1998848
    buffer_load_dword v42, v19, s[64:67], s36 offen
    s_mov_b32 s36, 2015232
    buffer_load_dword v43, v19, s[64:67], s36 offen
    s_waitcnt vmcnt(32)
    v_perm_b32 v76, v45, v44, s44
    v_perm_b32 v77, v47, v46, s44
    v_perm_b32 v78, v49, v48, s44
    v_perm_b32 v79, v51, v50, s44
    v_perm_b32 v80, v53, v52, s44
    v_perm_b32 v81, v55, v54, s44
    v_perm_b32 v82, v57, v56, s44
    v_perm_b32 v83, v59, v58, s44
    v_perm_b32 v84, v45, v44, s45
    v_perm_b32 v85, v47, v46, s45
    v_perm_b32 v86, v49, v48, s45
    v_perm_b32 v87, v51, v50, s45
    v_perm_b32 v88, v53, v52, s45
    v_perm_b32 v89, v55, v54, s45
    v_perm_b32 v90, v57, v56, s45
    v_perm_b32 v91, v59, v58, s45
    ds_write_b128 v4, v[76:79] offset:2048
    ds_write_b128 v4, v[80:83] offset:3072
    ds_write_b128 v4, v[84:87] offset:18432
    ds_write_b128 v4, v[88:91] offset:19456
    s_waitcnt lgkmcnt(0)
    s_mov_b32 s36, 2097152
    buffer_load_dword v44, v19, s[64:67], s36 offen
    s_mov_b32 s36, 2113536
    buffer_load_dword v45, v19, s[64:67], s36 offen
    s_mov_b32 s36, 2228224
    buffer_load_dword v46, v19, s[64:67], s36 offen
    s_mov_b32 s36, 2244608
    buffer_load_dword v47, v19, s[64:67], s36 offen
    s_mov_b32 s36, 2129920
    buffer_load_dword v48, v19, s[64:67], s36 offen
    s_mov_b32 s36, 2146304
    buffer_load_dword v49, v19, s[64:67], s36 offen
    s_mov_b32 s36, 2260992
    buffer_load_dword v50, v19, s[64:67], s36 offen
    s_mov_b32 s36, 2277376
    buffer_load_dword v51, v19, s[64:67], s36 offen
    s_mov_b32 s36, 2359296
    buffer_load_dword v52, v19, s[64:67], s36 offen
    s_mov_b32 s36, 2375680
    buffer_load_dword v53, v19, s[64:67], s36 offen
    s_mov_b32 s36, 2490368
    buffer_load_dword v54, v19, s[64:67], s36 offen
    s_mov_b32 s36, 2506752
    buffer_load_dword v55, v19, s[64:67], s36 offen
    s_mov_b32 s36, 2392064
    buffer_load_dword v56, v19, s[64:67], s36 offen
    s_mov_b32 s36, 2408448
    buffer_load_dword v57, v19, s[64:67], s36 offen
    s_mov_b32 s36, 2523136
    buffer_load_dword v58, v19, s[64:67], s36 offen
    s_mov_b32 s36, 2539520
    buffer_load_dword v59, v19, s[64:67], s36 offen
    s_waitcnt vmcnt(32)
    v_perm_b32 v76, v61, v60, s44
    v_perm_b32 v77, v63, v62, s44
    v_perm_b32 v78, v65, v64, s44
    v_perm_b32 v79, v67, v66, s44
    v_perm_b32 v80, v69, v68, s44
    v_perm_b32 v81, v71, v70, s44
    v_perm_b32 v82, v73, v72, s44
    v_perm_b32 v83, v75, v74, s44
    v_perm_b32 v84, v61, v60, s45
    v_perm_b32 v85, v63, v62, s45
    v_perm_b32 v86, v65, v64, s45
    v_perm_b32 v87, v67, v66, s45
    v_perm_b32 v88, v69, v68, s45
    v_perm_b32 v89, v71, v70, s45
    v_perm_b32 v90, v73, v72, s45
    v_perm_b32 v91, v75, v74, s45
    ds_write_b128 v4, v[76:79] offset:4096
    ds_write_b128 v4, v[80:83] offset:5120
    ds_write_b128 v4, v[84:87] offset:20480
    ds_write_b128 v4, v[88:91] offset:21504
    s_waitcnt lgkmcnt(0)
    s_mov_b32 s36, 2621440
    buffer_load_dword v60, v19, s[64:67], s36 offen
    s_mov_b32 s36, 2637824
    buffer_load_dword v61, v19, s[64:67], s36 offen
    s_mov_b32 s36, 2752512
    buffer_load_dword v62, v19, s[64:67], s36 offen
    s_mov_b32 s36, 2768896
    buffer_load_dword v63, v19, s[64:67], s36 offen
    s_mov_b32 s36, 2654208
    buffer_load_dword v64, v19, s[64:67], s36 offen
    s_mov_b32 s36, 2670592
    buffer_load_dword v65, v19, s[64:67], s36 offen
    s_mov_b32 s36, 2785280
    buffer_load_dword v66, v19, s[64:67], s36 offen
    s_mov_b32 s36, 2801664
    buffer_load_dword v67, v19, s[64:67], s36 offen
    s_mov_b32 s36, 2883584
    buffer_load_dword v68, v19, s[64:67], s36 offen
    s_mov_b32 s36, 2899968
    buffer_load_dword v69, v19, s[64:67], s36 offen
    s_mov_b32 s36, 3014656
    buffer_load_dword v70, v19, s[64:67], s36 offen
    s_mov_b32 s36, 3031040
    buffer_load_dword v71, v19, s[64:67], s36 offen
    s_mov_b32 s36, 2916352
    buffer_load_dword v72, v19, s[64:67], s36 offen
    s_mov_b32 s36, 2932736
    buffer_load_dword v73, v19, s[64:67], s36 offen
    s_mov_b32 s36, 3047424
    buffer_load_dword v74, v19, s[64:67], s36 offen
    s_mov_b32 s36, 3063808
    buffer_load_dword v75, v19, s[64:67], s36 offen
    s_waitcnt vmcnt(32)
    v_perm_b32 v76, v29, v28, s44
    v_perm_b32 v77, v31, v30, s44
    v_perm_b32 v78, v33, v32, s44
    v_perm_b32 v79, v35, v34, s44
    v_perm_b32 v80, v37, v36, s44
    v_perm_b32 v81, v39, v38, s44
    v_perm_b32 v82, v41, v40, s44
    v_perm_b32 v83, v43, v42, s44
    v_perm_b32 v84, v29, v28, s45
    v_perm_b32 v85, v31, v30, s45
    v_perm_b32 v86, v33, v32, s45
    v_perm_b32 v87, v35, v34, s45
    v_perm_b32 v88, v37, v36, s45
    v_perm_b32 v89, v39, v38, s45
    v_perm_b32 v90, v41, v40, s45
    v_perm_b32 v91, v43, v42, s45
    ds_write_b128 v4, v[76:79] offset:6144
    ds_write_b128 v4, v[80:83] offset:7168
    ds_write_b128 v4, v[84:87] offset:22528
    ds_write_b128 v4, v[88:91] offset:23552
    s_waitcnt lgkmcnt(0)
    s_mov_b32 s36, 3145728
    buffer_load_dword v28, v19, s[64:67], s36 offen
    s_mov_b32 s36, 3162112
    buffer_load_dword v29, v19, s[64:67], s36 offen
    s_mov_b32 s36, 3276800
    buffer_load_dword v30, v19, s[64:67], s36 offen
    s_mov_b32 s36, 3293184
    buffer_load_dword v31, v19, s[64:67], s36 offen
    s_mov_b32 s36, 3178496
    buffer_load_dword v32, v19, s[64:67], s36 offen
    s_mov_b32 s36, 3194880
    buffer_load_dword v33, v19, s[64:67], s36 offen
    s_mov_b32 s36, 3309568
    buffer_load_dword v34, v19, s[64:67], s36 offen
    s_mov_b32 s36, 3325952
    buffer_load_dword v35, v19, s[64:67], s36 offen
    s_mov_b32 s36, 3407872
    buffer_load_dword v36, v19, s[64:67], s36 offen
    s_mov_b32 s36, 3424256
    buffer_load_dword v37, v19, s[64:67], s36 offen
    s_mov_b32 s36, 3538944
    buffer_load_dword v38, v19, s[64:67], s36 offen
    s_mov_b32 s36, 3555328
    buffer_load_dword v39, v19, s[64:67], s36 offen
    s_mov_b32 s36, 3440640
    buffer_load_dword v40, v19, s[64:67], s36 offen
    s_mov_b32 s36, 3457024
    buffer_load_dword v41, v19, s[64:67], s36 offen
    s_mov_b32 s36, 3571712
    buffer_load_dword v42, v19, s[64:67], s36 offen
    s_mov_b32 s36, 3588096
    buffer_load_dword v43, v19, s[64:67], s36 offen
    s_waitcnt vmcnt(32)
    v_perm_b32 v76, v45, v44, s44
    v_perm_b32 v77, v47, v46, s44
    v_perm_b32 v78, v49, v48, s44
    v_perm_b32 v79, v51, v50, s44
    v_perm_b32 v80, v53, v52, s44
    v_perm_b32 v81, v55, v54, s44
    v_perm_b32 v82, v57, v56, s44
    v_perm_b32 v83, v59, v58, s44
    v_perm_b32 v84, v45, v44, s45
    v_perm_b32 v85, v47, v46, s45
    v_perm_b32 v86, v49, v48, s45
    v_perm_b32 v87, v51, v50, s45
    v_perm_b32 v88, v53, v52, s45
    v_perm_b32 v89, v55, v54, s45
    v_perm_b32 v90, v57, v56, s45
    v_perm_b32 v91, v59, v58, s45
    ds_write_b128 v4, v[76:79] offset:8192
    ds_write_b128 v4, v[80:83] offset:9216
    ds_write_b128 v4, v[84:87] offset:24576
    ds_write_b128 v4, v[88:91] offset:25600
    s_waitcnt lgkmcnt(0)
    s_mov_b32 s36, 3670016
    buffer_load_dword v44, v19, s[64:67], s36 offen
    s_mov_b32 s36, 3686400
    buffer_load_dword v45, v19, s[64:67], s36 offen
    s_mov_b32 s36, 3801088
    buffer_load_dword v46, v19, s[64:67], s36 offen
    s_mov_b32 s36, 3817472
    buffer_load_dword v47, v19, s[64:67], s36 offen
    s_mov_b32 s36, 3702784
    buffer_load_dword v48, v19, s[64:67], s36 offen
    s_mov_b32 s36, 3719168
    buffer_load_dword v49, v19, s[64:67], s36 offen
    s_mov_b32 s36, 3833856
    buffer_load_dword v50, v19, s[64:67], s36 offen
    s_mov_b32 s36, 3850240
    buffer_load_dword v51, v19, s[64:67], s36 offen
    s_mov_b32 s36, 3932160
    buffer_load_dword v52, v19, s[64:67], s36 offen
    s_mov_b32 s36, 3948544
    buffer_load_dword v53, v19, s[64:67], s36 offen
    s_mov_b32 s36, 4063232
    buffer_load_dword v54, v19, s[64:67], s36 offen
    s_mov_b32 s36, 4079616
    buffer_load_dword v55, v19, s[64:67], s36 offen
    s_mov_b32 s36, 3964928
    buffer_load_dword v56, v19, s[64:67], s36 offen
    s_mov_b32 s36, 3981312
    buffer_load_dword v57, v19, s[64:67], s36 offen
    s_mov_b32 s36, 4096000
    buffer_load_dword v58, v19, s[64:67], s36 offen
    s_mov_b32 s36, 4112384
    buffer_load_dword v59, v19, s[64:67], s36 offen
    s_waitcnt vmcnt(32)
    v_perm_b32 v76, v61, v60, s44
    v_perm_b32 v77, v63, v62, s44
    v_perm_b32 v78, v65, v64, s44
    v_perm_b32 v79, v67, v66, s44
    v_perm_b32 v80, v69, v68, s44
    v_perm_b32 v81, v71, v70, s44
    v_perm_b32 v82, v73, v72, s44
    v_perm_b32 v83, v75, v74, s44
    v_perm_b32 v84, v61, v60, s45
    v_perm_b32 v85, v63, v62, s45
    v_perm_b32 v86, v65, v64, s45
    v_perm_b32 v87, v67, v66, s45
    v_perm_b32 v88, v69, v68, s45
    v_perm_b32 v89, v71, v70, s45
    v_perm_b32 v90, v73, v72, s45
    v_perm_b32 v91, v75, v74, s45
    ds_write_b128 v4, v[76:79] offset:10240
    ds_write_b128 v4, v[80:83] offset:11264
    ds_write_b128 v4, v[84:87] offset:26624
    ds_write_b128 v4, v[88:91] offset:27648
    s_waitcnt lgkmcnt(0)
    s_waitcnt vmcnt(16)
    v_perm_b32 v76, v29, v28, s44
    v_perm_b32 v77, v31, v30, s44
    v_perm_b32 v78, v33, v32, s44
    v_perm_b32 v79, v35, v34, s44
    v_perm_b32 v80, v37, v36, s44
    v_perm_b32 v81, v39, v38, s44
    v_perm_b32 v82, v41, v40, s44
    v_perm_b32 v83, v43, v42, s44
    v_perm_b32 v84, v29, v28, s45
    v_perm_b32 v85, v31, v30, s45
    v_perm_b32 v86, v33, v32, s45
    v_perm_b32 v87, v35, v34, s45
    v_perm_b32 v88, v37, v36, s45
    v_perm_b32 v89, v39, v38, s45
    v_perm_b32 v90, v41, v40, s45
    v_perm_b32 v91, v43, v42, s45
    ds_write_b128 v4, v[76:79] offset:12288
    ds_write_b128 v4, v[80:83] offset:13312
    ds_write_b128 v4, v[84:87] offset:28672
    ds_write_b128 v4, v[88:91] offset:29696
    s_waitcnt lgkmcnt(0)
    s_waitcnt vmcnt(0)
    v_perm_b32 v76, v45, v44, s44
    v_perm_b32 v77, v47, v46, s44
    v_perm_b32 v78, v49, v48, s44
    v_perm_b32 v79, v51, v50, s44
    v_perm_b32 v80, v53, v52, s44
    v_perm_b32 v81, v55, v54, s44
    v_perm_b32 v82, v57, v56, s44
    v_perm_b32 v83, v59, v58, s44
    v_perm_b32 v84, v45, v44, s45
    v_perm_b32 v85, v47, v46, s45
    v_perm_b32 v86, v49, v48, s45
    v_perm_b32 v87, v51, v50, s45
    v_perm_b32 v88, v53, v52, s45
    v_perm_b32 v89, v55, v54, s45
    v_perm_b32 v90, v57, v56, s45
    v_perm_b32 v91, v59, v58, s45
    ds_write_b128 v4, v[76:79] offset:14336
    ds_write_b128 v4, v[80:83] offset:15360
    ds_write_b128 v4, v[84:87] offset:30720
    ds_write_b128 v4, v[88:91] offset:31744
    s_waitcnt lgkmcnt(0)
    s_mov_b32 s64, s52
    s_mov_b32 s65, s53
    s_mov_b32 s66, 0x400000
    s_mov_b32 s67, 0x20000
    v_lshlrev_b32 v19, 4, v22
    v_lshl_add_u32 v19, v23, 2, v19
    v_lshlrev_b32 v19, 10, v19
    v_lshl_add_u32 v19, v20, 2, v19
    s_lshl_b32 s36, s29, 17
    s_lshl_b32 s38, s30, 8
    s_add_u32 s36, s36, s38
    v_add_u32 v19, s36, v19

    s_mov_b32 s36, 0
    buffer_load_dword v28, v19, s[64:67], s36 offen
    s_mov_b32 s36, 1024
    buffer_load_dword v29, v19, s[64:67], s36 offen
    s_mov_b32 s36, 8192
    buffer_load_dword v30, v19, s[64:67], s36 offen
    s_mov_b32 s36, 9216
    buffer_load_dword v31, v19, s[64:67], s36 offen
    s_mov_b32 s36, 2048
    buffer_load_dword v32, v19, s[64:67], s36 offen
    s_mov_b32 s36, 3072
    buffer_load_dword v33, v19, s[64:67], s36 offen
    s_mov_b32 s36, 10240
    buffer_load_dword v34, v19, s[64:67], s36 offen
    s_mov_b32 s36, 11264
    buffer_load_dword v35, v19, s[64:67], s36 offen
    s_mov_b32 s36, 32768
    buffer_load_dword v36, v19, s[64:67], s36 offen
    s_mov_b32 s36, 33792
    buffer_load_dword v37, v19, s[64:67], s36 offen
    s_mov_b32 s36, 40960
    buffer_load_dword v38, v19, s[64:67], s36 offen
    s_mov_b32 s36, 41984
    buffer_load_dword v39, v19, s[64:67], s36 offen
    s_mov_b32 s36, 34816
    buffer_load_dword v40, v19, s[64:67], s36 offen
    s_mov_b32 s36, 35840
    buffer_load_dword v41, v19, s[64:67], s36 offen
    s_mov_b32 s36, 43008
    buffer_load_dword v42, v19, s[64:67], s36 offen
    s_mov_b32 s36, 44032
    buffer_load_dword v43, v19, s[64:67], s36 offen
    s_mov_b32 s36, 65536
    buffer_load_dword v44, v19, s[64:67], s36 offen
    s_mov_b32 s36, 66560
    buffer_load_dword v45, v19, s[64:67], s36 offen
    s_mov_b32 s36, 73728
    buffer_load_dword v46, v19, s[64:67], s36 offen
    s_mov_b32 s36, 74752
    buffer_load_dword v47, v19, s[64:67], s36 offen
    s_mov_b32 s36, 67584
    buffer_load_dword v48, v19, s[64:67], s36 offen
    s_mov_b32 s36, 68608
    buffer_load_dword v49, v19, s[64:67], s36 offen
    s_mov_b32 s36, 75776
    buffer_load_dword v50, v19, s[64:67], s36 offen
    s_mov_b32 s36, 76800
    buffer_load_dword v51, v19, s[64:67], s36 offen
    s_mov_b32 s36, 98304
    buffer_load_dword v52, v19, s[64:67], s36 offen
    s_mov_b32 s36, 99328
    buffer_load_dword v53, v19, s[64:67], s36 offen
    s_mov_b32 s36, 106496
    buffer_load_dword v54, v19, s[64:67], s36 offen
    s_mov_b32 s36, 107520
    buffer_load_dword v55, v19, s[64:67], s36 offen
    s_mov_b32 s36, 100352
    buffer_load_dword v56, v19, s[64:67], s36 offen
    s_mov_b32 s36, 101376
    buffer_load_dword v57, v19, s[64:67], s36 offen
    s_mov_b32 s36, 108544
    buffer_load_dword v58, v19, s[64:67], s36 offen
    s_mov_b32 s36, 109568
    buffer_load_dword v59, v19, s[64:67], s36 offen
    s_mov_b32 s36, 64
    buffer_load_dword v60, v19, s[64:67], s36 offen
    s_mov_b32 s36, 1088
    buffer_load_dword v61, v19, s[64:67], s36 offen
    s_mov_b32 s36, 8256
    buffer_load_dword v62, v19, s[64:67], s36 offen
    s_mov_b32 s36, 9280
    buffer_load_dword v63, v19, s[64:67], s36 offen
    s_mov_b32 s36, 2112
    buffer_load_dword v64, v19, s[64:67], s36 offen
    s_mov_b32 s36, 3136
    buffer_load_dword v65, v19, s[64:67], s36 offen
    s_mov_b32 s36, 10304
    buffer_load_dword v66, v19, s[64:67], s36 offen
    s_mov_b32 s36, 11328
    buffer_load_dword v67, v19, s[64:67], s36 offen
    s_mov_b32 s36, 32832
    buffer_load_dword v68, v19, s[64:67], s36 offen
    s_mov_b32 s36, 33856
    buffer_load_dword v69, v19, s[64:67], s36 offen
    s_mov_b32 s36, 41024
    buffer_load_dword v70, v19, s[64:67], s36 offen
    s_mov_b32 s36, 42048
    buffer_load_dword v71, v19, s[64:67], s36 offen
    s_mov_b32 s36, 34880
    buffer_load_dword v72, v19, s[64:67], s36 offen
    s_mov_b32 s36, 35904
    buffer_load_dword v73, v19, s[64:67], s36 offen
    s_mov_b32 s36, 43072
    buffer_load_dword v74, v19, s[64:67], s36 offen
    s_mov_b32 s36, 44096
    buffer_load_dword v75, v19, s[64:67], s36 offen
    s_waitcnt vmcnt(32)
    v_perm_b32 v76, v29, v28, s44
    v_perm_b32 v77, v31, v30, s44
    v_perm_b32 v78, v33, v32, s44
    v_perm_b32 v79, v35, v34, s44
    v_perm_b32 v80, v37, v36, s44
    v_perm_b32 v81, v39, v38, s44
    v_perm_b32 v82, v41, v40, s44
    v_perm_b32 v83, v43, v42, s44
    v_perm_b32 v84, v29, v28, s45
    v_perm_b32 v85, v31, v30, s45
    v_perm_b32 v86, v33, v32, s45
    v_perm_b32 v87, v35, v34, s45
    v_perm_b32 v88, v37, v36, s45
    v_perm_b32 v89, v39, v38, s45
    v_perm_b32 v90, v41, v40, s45
    v_perm_b32 v91, v43, v42, s45
    v_mov_b32 v128, v76
    v_mov_b32 v129, v77
    v_mov_b32 v130, v78
    v_mov_b32 v131, v79
    v_mov_b32 v132, v80
    v_mov_b32 v133, v81
    v_mov_b32 v134, v82
    v_mov_b32 v135, v83
    v_mov_b32 v144, v84
    v_mov_b32 v145, v85
    v_mov_b32 v146, v86
    v_mov_b32 v147, v87
    v_mov_b32 v148, v88
    v_mov_b32 v149, v89
    v_mov_b32 v150, v90
    v_mov_b32 v151, v91
    s_mov_b32 s36, 65600
    buffer_load_dword v28, v19, s[64:67], s36 offen
    s_mov_b32 s36, 66624
    buffer_load_dword v29, v19, s[64:67], s36 offen
    s_mov_b32 s36, 73792
    buffer_load_dword v30, v19, s[64:67], s36 offen
    s_mov_b32 s36, 74816
    buffer_load_dword v31, v19, s[64:67], s36 offen
    s_mov_b32 s36, 67648
    buffer_load_dword v32, v19, s[64:67], s36 offen
    s_mov_b32 s36, 68672
    buffer_load_dword v33, v19, s[64:67], s36 offen
    s_mov_b32 s36, 75840
    buffer_load_dword v34, v19, s[64:67], s36 offen
    s_mov_b32 s36, 76864
    buffer_load_dword v35, v19, s[64:67], s36 offen
    s_mov_b32 s36, 98368
    buffer_load_dword v36, v19, s[64:67], s36 offen
    s_mov_b32 s36, 99392
    buffer_load_dword v37, v19, s[64:67], s36 offen
    s_mov_b32 s36, 106560
    buffer_load_dword v38, v19, s[64:67], s36 offen
    s_mov_b32 s36, 107584
    buffer_load_dword v39, v19, s[64:67], s36 offen
    s_mov_b32 s36, 100416
    buffer_load_dword v40, v19, s[64:67], s36 offen
    s_mov_b32 s36, 101440
    buffer_load_dword v41, v19, s[64:67], s36 offen
    s_mov_b32 s36, 108608
    buffer_load_dword v42, v19, s[64:67], s36 offen
    s_mov_b32 s36, 109632
    buffer_load_dword v43, v19, s[64:67], s36 offen
    s_waitcnt vmcnt(32)
    v_perm_b32 v76, v45, v44, s44
    v_perm_b32 v77, v47, v46, s44
    v_perm_b32 v78, v49, v48, s44
    v_perm_b32 v79, v51, v50, s44
    v_perm_b32 v80, v53, v52, s44
    v_perm_b32 v81, v55, v54, s44
    v_perm_b32 v82, v57, v56, s44
    v_perm_b32 v83, v59, v58, s44
    v_perm_b32 v84, v45, v44, s45
    v_perm_b32 v85, v47, v46, s45
    v_perm_b32 v86, v49, v48, s45
    v_perm_b32 v87, v51, v50, s45
    v_perm_b32 v88, v53, v52, s45
    v_perm_b32 v89, v55, v54, s45
    v_perm_b32 v90, v57, v56, s45
    v_perm_b32 v91, v59, v58, s45
    v_mov_b32 v136, v76
    v_mov_b32 v137, v77
    v_mov_b32 v138, v78
    v_mov_b32 v139, v79
    v_mov_b32 v140, v80
    v_mov_b32 v141, v81
    v_mov_b32 v142, v82
    v_mov_b32 v143, v83
    v_mov_b32 v152, v84
    v_mov_b32 v153, v85
    v_mov_b32 v154, v86
    v_mov_b32 v155, v87
    v_mov_b32 v156, v88
    v_mov_b32 v157, v89
    v_mov_b32 v158, v90
    v_mov_b32 v159, v91
    s_mov_b32 s36, 128
    buffer_load_dword v44, v19, s[64:67], s36 offen
    s_mov_b32 s36, 1152
    buffer_load_dword v45, v19, s[64:67], s36 offen
    s_mov_b32 s36, 8320
    buffer_load_dword v46, v19, s[64:67], s36 offen
    s_mov_b32 s36, 9344
    buffer_load_dword v47, v19, s[64:67], s36 offen
    s_mov_b32 s36, 2176
    buffer_load_dword v48, v19, s[64:67], s36 offen
    s_mov_b32 s36, 3200
    buffer_load_dword v49, v19, s[64:67], s36 offen
    s_mov_b32 s36, 10368
    buffer_load_dword v50, v19, s[64:67], s36 offen
    s_mov_b32 s36, 11392
    buffer_load_dword v51, v19, s[64:67], s36 offen
    s_mov_b32 s36, 32896
    buffer_load_dword v52, v19, s[64:67], s36 offen
    s_mov_b32 s36, 33920
    buffer_load_dword v53, v19, s[64:67], s36 offen
    s_mov_b32 s36, 41088
    buffer_load_dword v54, v19, s[64:67], s36 offen
    s_mov_b32 s36, 42112
    buffer_load_dword v55, v19, s[64:67], s36 offen
    s_mov_b32 s36, 34944
    buffer_load_dword v56, v19, s[64:67], s36 offen
    s_mov_b32 s36, 35968
    buffer_load_dword v57, v19, s[64:67], s36 offen
    s_mov_b32 s36, 43136
    buffer_load_dword v58, v19, s[64:67], s36 offen
    s_mov_b32 s36, 44160
    buffer_load_dword v59, v19, s[64:67], s36 offen
    s_waitcnt vmcnt(32)
    v_perm_b32 v76, v61, v60, s44
    v_perm_b32 v77, v63, v62, s44
    v_perm_b32 v78, v65, v64, s44
    v_perm_b32 v79, v67, v66, s44
    v_perm_b32 v80, v69, v68, s44
    v_perm_b32 v81, v71, v70, s44
    v_perm_b32 v82, v73, v72, s44
    v_perm_b32 v83, v75, v74, s44
    v_perm_b32 v84, v61, v60, s45
    v_perm_b32 v85, v63, v62, s45
    v_perm_b32 v86, v65, v64, s45
    v_perm_b32 v87, v67, v66, s45
    v_perm_b32 v88, v69, v68, s45
    v_perm_b32 v89, v71, v70, s45
    v_perm_b32 v90, v73, v72, s45
    v_perm_b32 v91, v75, v74, s45
    v_mov_b32 v160, v76
    v_mov_b32 v161, v77
    v_mov_b32 v162, v78
    v_mov_b32 v163, v79
    v_mov_b32 v164, v80
    v_mov_b32 v165, v81
    v_mov_b32 v166, v82
    v_mov_b32 v167, v83
    v_mov_b32 v176, v84
    v_mov_b32 v177, v85
    v_mov_b32 v178, v86
    v_mov_b32 v179, v87
    v_mov_b32 v180, v88
    v_mov_b32 v181, v89
    v_mov_b32 v182, v90
    v_mov_b32 v183, v91
    s_mov_b32 s36, 65664
    buffer_load_dword v60, v19, s[64:67], s36 offen
    s_mov_b32 s36, 66688
    buffer_load_dword v61, v19, s[64:67], s36 offen
    s_mov_b32 s36, 73856
    buffer_load_dword v62, v19, s[64:67], s36 offen
    s_mov_b32 s36, 74880
    buffer_load_dword v63, v19, s[64:67], s36 offen
    s_mov_b32 s36, 67712
    buffer_load_dword v64, v19, s[64:67], s36 offen
    s_mov_b32 s36, 68736
    buffer_load_dword v65, v19, s[64:67], s36 offen
    s_mov_b32 s36, 75904
    buffer_load_dword v66, v19, s[64:67], s36 offen
    s_mov_b32 s36, 76928
    buffer_load_dword v67, v19, s[64:67], s36 offen
    s_mov_b32 s36, 98432
    buffer_load_dword v68, v19, s[64:67], s36 offen
    s_mov_b32 s36, 99456
    buffer_load_dword v69, v19, s[64:67], s36 offen
    s_mov_b32 s36, 106624
    buffer_load_dword v70, v19, s[64:67], s36 offen
    s_mov_b32 s36, 107648
    buffer_load_dword v71, v19, s[64:67], s36 offen
    s_mov_b32 s36, 100480
    buffer_load_dword v72, v19, s[64:67], s36 offen
    s_mov_b32 s36, 101504
    buffer_load_dword v73, v19, s[64:67], s36 offen
    s_mov_b32 s36, 108672
    buffer_load_dword v74, v19, s[64:67], s36 offen
    s_mov_b32 s36, 109696
    buffer_load_dword v75, v19, s[64:67], s36 offen
    s_waitcnt vmcnt(32)
    v_perm_b32 v76, v29, v28, s44
    v_perm_b32 v77, v31, v30, s44
    v_perm_b32 v78, v33, v32, s44
    v_perm_b32 v79, v35, v34, s44
    v_perm_b32 v80, v37, v36, s44
    v_perm_b32 v81, v39, v38, s44
    v_perm_b32 v82, v41, v40, s44
    v_perm_b32 v83, v43, v42, s44
    v_perm_b32 v84, v29, v28, s45
    v_perm_b32 v85, v31, v30, s45
    v_perm_b32 v86, v33, v32, s45
    v_perm_b32 v87, v35, v34, s45
    v_perm_b32 v88, v37, v36, s45
    v_perm_b32 v89, v39, v38, s45
    v_perm_b32 v90, v41, v40, s45
    v_perm_b32 v91, v43, v42, s45
    v_mov_b32 v168, v76
    v_mov_b32 v169, v77
    v_mov_b32 v170, v78
    v_mov_b32 v171, v79
    v_mov_b32 v172, v80
    v_mov_b32 v173, v81
    v_mov_b32 v174, v82
    v_mov_b32 v175, v83
    v_mov_b32 v184, v84
    v_mov_b32 v185, v85
    v_mov_b32 v186, v86
    v_mov_b32 v187, v87
    v_mov_b32 v188, v88
    v_mov_b32 v189, v89
    v_mov_b32 v190, v90
    v_mov_b32 v191, v91
    s_mov_b32 s36, 192
    buffer_load_dword v28, v19, s[64:67], s36 offen
    s_mov_b32 s36, 1216
    buffer_load_dword v29, v19, s[64:67], s36 offen
    s_mov_b32 s36, 8384
    buffer_load_dword v30, v19, s[64:67], s36 offen
    s_mov_b32 s36, 9408
    buffer_load_dword v31, v19, s[64:67], s36 offen
    s_mov_b32 s36, 2240
    buffer_load_dword v32, v19, s[64:67], s36 offen
    s_mov_b32 s36, 3264
    buffer_load_dword v33, v19, s[64:67], s36 offen
    s_mov_b32 s36, 10432
    buffer_load_dword v34, v19, s[64:67], s36 offen
    s_mov_b32 s36, 11456
    buffer_load_dword v35, v19, s[64:67], s36 offen
    s_mov_b32 s36, 32960
    buffer_load_dword v36, v19, s[64:67], s36 offen
    s_mov_b32 s36, 33984
    buffer_load_dword v37, v19, s[64:67], s36 offen
    s_mov_b32 s36, 41152
    buffer_load_dword v38, v19, s[64:67], s36 offen
    s_mov_b32 s36, 42176
    buffer_load_dword v39, v19, s[64:67], s36 offen
    s_mov_b32 s36, 35008
    buffer_load_dword v40, v19, s[64:67], s36 offen
    s_mov_b32 s36, 36032
    buffer_load_dword v41, v19, s[64:67], s36 offen
    s_mov_b32 s36, 43200
    buffer_load_dword v42, v19, s[64:67], s36 offen
    s_mov_b32 s36, 44224
    buffer_load_dword v43, v19, s[64:67], s36 offen
    s_waitcnt vmcnt(32)
    v_perm_b32 v76, v45, v44, s44
    v_perm_b32 v77, v47, v46, s44
    v_perm_b32 v78, v49, v48, s44
    v_perm_b32 v79, v51, v50, s44
    v_perm_b32 v80, v53, v52, s44
    v_perm_b32 v81, v55, v54, s44
    v_perm_b32 v82, v57, v56, s44
    v_perm_b32 v83, v59, v58, s44
    v_perm_b32 v84, v45, v44, s45
    v_perm_b32 v85, v47, v46, s45
    v_perm_b32 v86, v49, v48, s45
    v_perm_b32 v87, v51, v50, s45
    v_perm_b32 v88, v53, v52, s45
    v_perm_b32 v89, v55, v54, s45
    v_perm_b32 v90, v57, v56, s45
    v_perm_b32 v91, v59, v58, s45
    v_mov_b32 v192, v76
    v_mov_b32 v193, v77
    v_mov_b32 v194, v78
    v_mov_b32 v195, v79
    v_mov_b32 v196, v80
    v_mov_b32 v197, v81
    v_mov_b32 v198, v82
    v_mov_b32 v199, v83
    v_mov_b32 v208, v84
    v_mov_b32 v209, v85
    v_mov_b32 v210, v86
    v_mov_b32 v211, v87
    v_mov_b32 v212, v88
    v_mov_b32 v213, v89
    v_mov_b32 v214, v90
    v_mov_b32 v215, v91
    s_mov_b32 s36, 65728
    buffer_load_dword v44, v19, s[64:67], s36 offen
    s_mov_b32 s36, 66752
    buffer_load_dword v45, v19, s[64:67], s36 offen
    s_mov_b32 s36, 73920
    buffer_load_dword v46, v19, s[64:67], s36 offen
    s_mov_b32 s36, 74944
    buffer_load_dword v47, v19, s[64:67], s36 offen
    s_mov_b32 s36, 67776
    buffer_load_dword v48, v19, s[64:67], s36 offen
    s_mov_b32 s36, 68800
    buffer_load_dword v49, v19, s[64:67], s36 offen
    s_mov_b32 s36, 75968
    buffer_load_dword v50, v19, s[64:67], s36 offen
    s_mov_b32 s36, 76992
    buffer_load_dword v51, v19, s[64:67], s36 offen
    s_mov_b32 s36, 98496
    buffer_load_dword v52, v19, s[64:67], s36 offen
    s_mov_b32 s36, 99520
    buffer_load_dword v53, v19, s[64:67], s36 offen
    s_mov_b32 s36, 106688
    buffer_load_dword v54, v19, s[64:67], s36 offen
    s_mov_b32 s36, 107712
    buffer_load_dword v55, v19, s[64:67], s36 offen
    s_mov_b32 s36, 100544
    buffer_load_dword v56, v19, s[64:67], s36 offen
    s_mov_b32 s36, 101568
    buffer_load_dword v57, v19, s[64:67], s36 offen
    s_mov_b32 s36, 108736
    buffer_load_dword v58, v19, s[64:67], s36 offen
    s_mov_b32 s36, 109760
    buffer_load_dword v59, v19, s[64:67], s36 offen
    s_waitcnt vmcnt(32)
    v_perm_b32 v76, v61, v60, s44
    v_perm_b32 v77, v63, v62, s44
    v_perm_b32 v78, v65, v64, s44
    v_perm_b32 v79, v67, v66, s44
    v_perm_b32 v80, v69, v68, s44
    v_perm_b32 v81, v71, v70, s44
    v_perm_b32 v82, v73, v72, s44
    v_perm_b32 v83, v75, v74, s44
    v_perm_b32 v84, v61, v60, s45
    v_perm_b32 v85, v63, v62, s45
    v_perm_b32 v86, v65, v64, s45
    v_perm_b32 v87, v67, v66, s45
    v_perm_b32 v88, v69, v68, s45
    v_perm_b32 v89, v71, v70, s45
    v_perm_b32 v90, v73, v72, s45
    v_perm_b32 v91, v75, v74, s45
    v_mov_b32 v200, v76
    v_mov_b32 v201, v77
    v_mov_b32 v202, v78
    v_mov_b32 v203, v79
    v_mov_b32 v204, v80
    v_mov_b32 v205, v81
    v_mov_b32 v206, v82
    v_mov_b32 v207, v83
    v_mov_b32 v216, v84
    v_mov_b32 v217, v85
    v_mov_b32 v218, v86
    v_mov_b32 v219, v87
    v_mov_b32 v220, v88
    v_mov_b32 v221, v89
    v_mov_b32 v222, v90
    v_mov_b32 v223, v91
    s_waitcnt vmcnt(16)
    v_perm_b32 v76, v29, v28, s44
    v_perm_b32 v77, v31, v30, s44
    v_perm_b32 v78, v33, v32, s44
    v_perm_b32 v79, v35, v34, s44
    v_perm_b32 v80, v37, v36, s44
    v_perm_b32 v81, v39, v38, s44
    v_perm_b32 v82, v41, v40, s44
    v_perm_b32 v83, v43, v42, s44
    v_perm_b32 v84, v29, v28, s45
    v_perm_b32 v85, v31, v30, s45
    v_perm_b32 v86, v33, v32, s45
    v_perm_b32 v87, v35, v34, s45
    v_perm_b32 v88, v37, v36, s45
    v_perm_b32 v89, v39, v38, s45
    v_perm_b32 v90, v41, v40, s45
    v_perm_b32 v91, v43, v42, s45
    v_mov_b32 v224, v76
    v_mov_b32 v225, v77
    v_mov_b32 v226, v78
    v_mov_b32 v227, v79
    v_mov_b32 v228, v80
    v_mov_b32 v229, v81
    v_mov_b32 v230, v82
    v_mov_b32 v231, v83
    v_mov_b32 v240, v84
    v_mov_b32 v241, v85
    v_mov_b32 v242, v86
    v_mov_b32 v243, v87
    v_mov_b32 v244, v88
    v_mov_b32 v245, v89
    v_mov_b32 v246, v90
    v_mov_b32 v247, v91
    s_waitcnt vmcnt(0)
    v_perm_b32 v76, v45, v44, s44
    v_perm_b32 v77, v47, v46, s44
    v_perm_b32 v78, v49, v48, s44
    v_perm_b32 v79, v51, v50, s44
    v_perm_b32 v80, v53, v52, s44
    v_perm_b32 v81, v55, v54, s44
    v_perm_b32 v82, v57, v56, s44
    v_perm_b32 v83, v59, v58, s44
    v_perm_b32 v84, v45, v44, s45
    v_perm_b32 v85, v47, v46, s45
    v_perm_b32 v86, v49, v48, s45
    v_perm_b32 v87, v51, v50, s45
    v_perm_b32 v88, v53, v52, s45
    v_perm_b32 v89, v55, v54, s45
    v_perm_b32 v90, v57, v56, s45
    v_perm_b32 v91, v59, v58, s45
    v_mov_b32 v232, v76
    v_mov_b32 v233, v77
    v_mov_b32 v234, v78
    v_mov_b32 v235, v79
    v_mov_b32 v236, v80
    v_mov_b32 v237, v81
    v_mov_b32 v238, v82
    v_mov_b32 v239, v83
    v_mov_b32 v248, v84
    v_mov_b32 v249, v85
    v_mov_b32 v250, v86
    v_mov_b32 v251, v87
    v_mov_b32 v252, v88
    v_mov_b32 v253, v89
    v_mov_b32 v254, v90
    v_mov_b32 v255, v91
    s_lshl_b32 s36, s30, 11
    v_lshlrev_b32 v1, 4, v0
    v_add_u32 v2, s36, v1
    v_add_u32 v13, 131072, v2
    v_add_u32 v17, 146176, v2
    v_and_b32 v18, 7, v20
    v_lshrrev_b32 v19, 3, v20
    v_lshlrev_b32 v3, 8, v21
    v_lshl_add_u32 v3, v18, 5, v3
    v_lshl_add_u32 v3, v19, 4, v3
    v_add_u32 v3, 131072, v3
    v_lshlrev_b32 v5, 2, v23
    v_lshl_add_u32 v5, v22, 1, v5
    v_mul_u32_u24 v5, 288, v5
    v_lshl_add_u32 v5, v20, 2, v5
    s_lshl_b32 s36, s30, 6
    s_add_u32 s36, s36, 139264
    v_add_u32 v5, s36, v5
    v_mul_u32_u24 v6, 288, v18
    v_lshl_add_u32 v6, v21, 4, v6
    v_add_u32 v6, 139264, v6
    v_add_u32 v14, s36, v6
    v_subrev_u32 v14, 139264, v14
    v_add_u32 v8, 4608, v14
    v_add_u32 v7, 146176, v1
    s_lshl_b32 s36, s30, 11
    s_add_u32 s36, s36, 154368
    v_add_u32 v9, s36, v1
    v_mul_u32_u24 v10, 288, v18
    v_lshl_add_u32 v10, v21, 5, v10
    v_lshl_add_u32 v10, v19, 4, v10
    v_add_u32 v10, 143872, v10
    v_lshlrev_b32 v11, 14, v23
    v_lshl_add_u32 v11, v22, 13, v11
    v_lshrrev_b32 v12, 2, v20
    v_lshl_add_u32 v11, v12, 11, v11
    v_and_b32 v12, 3, v20
    v_lshl_add_u32 v11, v12, 4, v11
    s_lshl_b32 s36, s30, 16
    s_lshl_b32 s38, s29, 6
    s_add_u32 s36, s36, s38
    v_add_u32 v11, s36, v11
    s_lshl_b32 s36, s29, 13
    s_lshl_b32 s38, s30, 11
    s_add_u32 s36, s36, s38
    v_add_u32 v12, s36, v1
    v_lshlrev_b32 v15, 3, v0
    s_lshl_b32 s36, s30, 9
    v_add_u32 v15, s36, v15
    v_mov_b32 v16, 0x4444
    v_mov_b32 v19, 0xeeee
    v_cmp_le_u32 vcc, 8, v20
    v_cndmask_b32 v16, v16, v19, vcc
    v_mov_b32 v24, 0
    v_mov_b32 v19, 0xff61b1e6
    v_cmp_le_u32 vcc, 32, v0
    v_cndmask_b32 v24, v24, v19, vcc
    v_mov_b32 v25, v24
    v_mov_b32 v26, v24
    v_mov_b32 v27, v24

    v_lshrrev_b32 v60, 2, v20
    v_lshl_add_u32 v19, v21, 2, v60
    v_lshlrev_b32 v19, 5, v19
    v_and_b32 v61, 3, v20
    v_lshl_add_u32 v19, v61, 1, v19
    s_lshl_b32 s36, s30, 3
    s_lshl_b32 s38, s29, 8
    s_add_u32 s36, s36, s38
    v_add_u32 v61, s36, v19
    v_and_b32 v62, 33, v0
    v_cmp_eq_u32 vcc, 0, v62
    s_mov_b64 s[42:43], vcc
    v_and_b32 v62, 4, v0
    v_cmp_ne_u32 vcc, 0, v62
    s_mov_b64 s[44:45], vcc
    v_and_b32 v62, 8, v0
    v_cmp_ne_u32 vcc, 0, v62
    s_mov_b64 s[46:47], vcc
    v_lshrrev_b32 v62, 1, v20
    v_and_b32 v63, 1, v20
    v_lshlrev_b32 v63, 4, v63
    v_mov_b32 v64, 0x3f80
    v_lshlrev_b32 v64, v63, v64
    v_mov_b32 v65, 0
    v_cmp_eq_u32 vcc, 0, v62
    v_cndmask_b32 v20, v65, v64, vcc
    v_cmp_eq_u32 vcc, 1, v62
    v_cndmask_b32 v21, v65, v64, vcc
    v_cmp_eq_u32 vcc, 2, v62
    v_cndmask_b32 v22, v65, v64, vcc
    v_cmp_eq_u32 vcc, 3, v62
    v_cndmask_b32 v23, v65, v64, vcc
    s_mov_b32 s63, 0x3f803f80
    s_mov_b32 s41, 0x3e0293ee
    v_and_b32 v18, 3, v0
    v_bfe_u32 v19, v0, 2, 1
    v_lshl_add_u32 v18, v19, 6, v18
    s_lshr_b32 s36, s29, 1
    s_lshl_b32 s36, s36, 2
    v_add_u32 v18, s36, v18
    v_lshlrev_b32 v18, 7, v18
    v_add_u32 v18, 0x4000, v18
    v_mov_b32 v0, v61
    s_mov_b32 s28, 0
    s_mov_b32 s31, 0
    s_mov_b32 s32, 0x10000
    s_lshl_b32 s34, s29, 13
    s_lshl_b32 s37, s29, 11
    s_mov_b32 s40, 0x3e0293ee
    s_mov_b32 s35, 0
    s_lshl_b32 s64, s29, 4
    s_lshl_b32 s36, s30, 2
    s_add_u32 s64, s64, s36
    s_add_u32 s64, s64, 0xa000

    s_cmp_ge_u32 s35, 64
    s_cbranch_scc1 chain_f0_ok
chain_f0:
    s_cmp_gt_u32 s31, s35
    s_cbranch_scc1 chain_f0_ok
    buffer_load_dword v19, v18, s[8:11], 0 offen sc1
    s_add_u32 s98, s98, 1
    s_waitcnt vmcnt(0)
    v_readlane_b32 s31, v19, 0
    v_readlane_b32 s36, v19, 1
    s_min_u32 s31, s31, s36
    v_readlane_b32 s36, v19, 2
    s_min_u32 s31, s31, s36
    v_readlane_b32 s36, v19, 3
    s_min_u32 s31, s31, s36
    v_readlane_b32 s36, v19, 4
    s_min_u32 s31, s31, s36
    v_readlane_b32 s36, v19, 5
    s_min_u32 s31, s31, s36
    v_readlane_b32 s36, v19, 6
    s_min_u32 s31, s31, s36
    v_readlane_b32 s36, v19, 7
    s_min_u32 s31, s31, s36
    s_lshl_b32 s31, s31, 2
    s_cmp_gt_u32 s98, 262144
    s_cbranch_scc0 chain_f0
chain_f0_ok:
    s_lshl_b32 s36, s35, 18
    s_add_u32 s36, s36, s34
    buffer_load_dwordx4 v[92:95], v2, s[12:15], s36 offen offset:0 sc1
    buffer_load_dwordx4 v[96:99], v2, s[12:15], s36 offen offset:1024 sc1
    buffer_load_dwordx4 v[100:103], v2, s[16:19], s36 offen offset:0 sc1
    buffer_load_dwordx4 v[104:107], v2, s[16:19], s36 offen offset:1024 sc1
    s_waitcnt vmcnt(0)
    ds_write_b128 v17, v[92:95] offset:0
    ds_write_b128 v17, v[100:103] offset:8192
    ds_write_b128 v17, v[96:99] offset:1024
    ds_write_b128 v17, v[104:107] offset:9216
    s_waitcnt lgkmcnt(0)
    ds_read_b128 v[84:87], v4 offset:0
    ds_read_b128 v[88:91], v4 offset:1024
    ds_read_b128 v[92:95], v4 offset:16384
    ds_read_b128 v[96:99], v4 offset:17408
    ds_read_b128 v[100:103], v4 offset:2048
    ds_read_b128 v[104:107], v4 offset:3072
    ds_read_b128 v[108:111], v4 offset:18432
    ds_read_b128 v[112:115], v4 offset:19456
    ds_read_b128 v[116:119], v4 offset:4096
    ds_read_b128 v[120:123], v4 offset:5120
    v_mov_b32 v60, 0
    v_mov_b32 v61, 0
    v_mov_b32 v62, 0
    v_mov_b32 v63, 0
    v_mov_b32 v64, 0
    v_mov_b32 v65, 0
    v_mov_b32 v66, 0
    v_mov_b32 v67, 0
    v_mov_b32 v68, 0
    v_mov_b32 v69, 0
    v_mov_b32 v70, 0
    v_mov_b32 v71, 0
    v_mov_b32 v72, 0
    v_mov_b32 v73, 0
    v_mov_b32 v74, 0
    v_mov_b32 v75, 0
    v_mov_b32 v76, 0
    v_mov_b32 v77, 0
    v_mov_b32 v78, 0
    v_mov_b32 v79, 0
    v_mov_b32 v80, 0
    v_mov_b32 v81, 0
    v_mov_b32 v82, 0
    v_mov_b32 v83, 0
    v_mov_b32 v19, 0
chain_r1:
    buffer_load_dwordx2 v[28:29], v19, s[56:59], 0 offen sc1
    s_add_u32 s98, s98, 1
    s_waitcnt vmcnt(0)
    v_sad_u8 v30, v28, 0, 0
    v_sad_u8 v30, v29, 0, v30
    v_readfirstlane_b32 s60, v28
    v_readfirstlane_b32 s61, v29
    v_readfirstlane_b32 s36, v30
    s_cmp_gt_u32 s98, 262144
    s_cbranch_scc1 chain_r2
    s_cmp_lt_u32 s36, 32
    s_cbranch_scc1 chain_r1

chain_r2:
    s_waitcnt lgkmcnt(0)
    s_barrier
    s_lshr_b64 s[60:61], s[60:61], s62
    s_and_b32 s60, s60, 0xff
    s_cmp_eq_u32 s60, 32
    s_cbranch_scc0 slow_loop

fast_loop:
fast_pm:
    buffer_load_dwordx4 v[28:31], v2, s[8:11], s32 offen offset:0 sc1
    buffer_load_dwordx4 v[32:35], v2, s[8:11], s32 offen offset:1024 sc1
    s_add_u32 s98, s98, 1
    s_waitcnt vmcnt(0)
    v_max3_u32 v19, v28, v29, v30
    v_max3_u32 v19, v31, v32, v19
    v_max3_u32 v19, v33, v34, v19
    v_max_u32 v19, v35, v19
    v_cmp_eq_u32 vcc, -1, v19
    s_cmp_gt_u32 s98, 262144
    s_cbranch_scc1 fast_pm_x
    s_cbranch_vccnz fast_pm
fast_pm_x:
    v_mov_b32 v19, s28
    v_mov_b32 v125, s64
    s_mov_b64 exec, 1
    buffer_store_dword v19, v125, s[8:11], 0 offen sc1
    s_mov_b64 exec, -1
    ds_write_b128 v13, v[28:31] offset:0
    ds_write_b128 v13, v[32:35] offset:1024
    s_waitcnt lgkmcnt(0)
    s_barrier
    ds_read_b128 v[28:31], v3 offset:0
    ds_read_b128 v[32:35], v3 offset:1024
    ds_read_b128 v[36:39], v3 offset:2048
    ds_read_b128 v[40:43], v3 offset:3072
    ds_read_b128 v[44:47], v3 offset:4096
    ds_read_b128 v[48:51], v3 offset:5120
    ds_read_b128 v[52:55], v3 offset:6144
    ds_read_b128 v[56:59], v3 offset:7168
    s_waitcnt lgkmcnt(7)
    v_smfmac_f32_16x16x64_bf16 v[60:63], v[28:31], a[0:7], v16
    v_smfmac_f32_16x16x64_bf16 v[64:67], v[28:31], a[64:71], v16
    v_smfmac_f32_16x16x64_bf16 v[68:71], v[28:31], a[128:135], v16
    v_smfmac_f32_16x16x64_bf16 v[72:75], v[28:31], a[192:199], v16
    s_waitcnt lgkmcnt(6)
    v_smfmac_f32_16x16x64_bf16 v[60:63], v[32:35], a[8:15], v16
    v_smfmac_f32_16x16x64_bf16 v[64:67], v[32:35], a[72:79], v16
    v_smfmac_f32_16x16x64_bf16 v[68:71], v[32:35], a[136:143], v16
    v_smfmac_f32_16x16x64_bf16 v[72:75], v[32:35], a[200:207], v16
    s_waitcnt lgkmcnt(5)
    v_smfmac_f32_16x16x64_bf16 v[60:63], v[36:39], a[16:23], v16
    v_smfmac_f32_16x16x64_bf16 v[64:67], v[36:39], a[80:87], v16
    v_smfmac_f32_16x16x64_bf16 v[68:71], v[36:39], a[144:151], v16
    v_smfmac_f32_16x16x64_bf16 v[72:75], v[36:39], a[208:215], v16
    v_smfmac_f32_16x16x64_bf16 v[76:79], v[28:31], v[84:91], v16
    ds_read_b128 v[84:87], v4 offset:20480
    ds_read_b128 v[88:91], v4 offset:21504
    s_waitcnt lgkmcnt(6)
    v_smfmac_f32_16x16x64_bf16 v[60:63], v[40:43], a[24:31], v16
    v_smfmac_f32_16x16x64_bf16 v[64:67], v[40:43], a[88:95], v16
    v_smfmac_f32_16x16x64_bf16 v[68:71], v[40:43], a[152:159], v16
    v_smfmac_f32_16x16x64_bf16 v[72:75], v[40:43], a[216:223], v16
    v_smfmac_f32_16x16x64_bf16 v[80:83], v[28:31], v[92:99], v16
    ds_read_b128 v[92:95], v4 offset:6144
    ds_read_b128 v[96:99], v4 offset:7168
    s_waitcnt lgkmcnt(7)
    v_smfmac_f32_16x16x64_bf16 v[60:63], v[44:47], a[32:39], v16
    v_smfmac_f32_16x16x64_bf16 v[64:67], v[44:47], a[96:103], v16
    v_smfmac_f32_16x16x64_bf16 v[68:71], v[44:47], a[160:167], v16
    v_smfmac_f32_16x16x64_bf16 v[72:75], v[44:47], a[224:231], v16
    v_smfmac_f32_16x16x64_bf16 v[76:79], v[32:35], v[100:107], v16
    ds_read_b128 v[100:103], v4 offset:22528
    ds_read_b128 v[104:107], v4 offset:23552
    s_waitcnt lgkmcnt(8)
    v_smfmac_f32_16x16x64_bf16 v[60:63], v[48:51], a[40:47], v16
    v_smfmac_f32_16x16x64_bf16 v[64:67], v[48:51], a[104:111], v16
    v_smfmac_f32_16x16x64_bf16 v[68:71], v[48:51], a[168:175], v16
    v_smfmac_f32_16x16x64_bf16 v[72:75], v[48:51], a[232:239], v16
    v_smfmac_f32_16x16x64_bf16 v[80:83], v[32:35], v[108:115], v16
    ds_read_b128 v[108:111], v4 offset:8192
    ds_read_b128 v[112:115], v4 offset:9216
    s_waitcnt lgkmcnt(9)
    v_smfmac_f32_16x16x64_bf16 v[60:63], v[52:55], a[48:55], v16
    v_smfmac_f32_16x16x64_bf16 v[64:67], v[52:55], a[112:119], v16
    v_smfmac_f32_16x16x64_bf16 v[68:71], v[52:55], a[176:183], v16
    v_smfmac_f32_16x16x64_bf16 v[72:75], v[52:55], a[240:247], v16
    v_smfmac_f32_16x16x64_bf16 v[76:79], v[36:39], v[116:123], v16
    ds_read_b128 v[116:119], v4 offset:24576
    ds_read_b128 v[120:123], v4 offset:25600
    s_waitcnt lgkmcnt(10)
    v_smfmac_f32_16x16x64_bf16 v[60:63], v[56:59], a[56:63], v16
    v_smfmac_f32_16x16x64_bf16 v[64:67], v[56:59], a[120:127], v16
    v_smfmac_f32_16x16x64_bf16 v[68:71], v[56:59], a[184:191], v16
    v_smfmac_f32_16x16x64_bf16 v[72:75], v[56:59], a[248:255], v16
    s_waitcnt lgkmcnt(8)
    v_smfmac_f32_16x16x64_bf16 v[80:83], v[36:39], v[84:91], v16
    ds_read_b128 v[84:87], v4 offset:10240
    ds_read_b128 v[88:91], v4 offset:11264
    s_waitcnt lgkmcnt(8)
    v_smfmac_f32_16x16x64_bf16 v[76:79], v[40:43], v[92:99], v16
    ds_read_b128 v[92:95], v4 offset:26624
    ds_read_b128 v[96:99], v4 offset:27648
    s_nop 1
    v_permlane32_swap_b32 v60, v62
    v_permlane32_swap_b32 v61, v63
    v_permlane32_swap_b32 v64, v66
    v_permlane32_swap_b32 v65, v67
    s_waitcnt lgkmcnt(8)
    v_smfmac_f32_16x16x64_bf16 v[80:83], v[40:43], v[100:107], v16
    ds_read_b128 v[100:103], v4 offset:12288
    ds_read_b128 v[104:107], v4 offset:13312
    v_add_f32 v60, v60, v62
    v_add_f32 v61, v61, v63
    v_add_f32 v64, v64, v66
    v_add_f32 v65, v65, v67
    s_waitcnt lgkmcnt(8)
    v_smfmac_f32_16x16x64_bf16 v[76:79], v[44:47], v[108:115], v16
    ds_read_b128 v[108:111], v4 offset:28672
    ds_read_b128 v[112:115], v4 offset:29696
    v_cvt_pk_bf16_f32 v60, v60, v64
    v_cvt_pk_bf16_f32 v61, v61, v65
    ds_write_b32 v5, v60 offset:0
    ds_write_b32 v5, v61 offset:288
    v_permlane32_swap_b32 v68, v70
    v_permlane32_swap_b32 v69, v71
    v_permlane32_swap_b32 v72, v74
    v_permlane32_swap_b32 v73, v75
    s_waitcnt lgkmcnt(10)
    v_smfmac_f32_16x16x64_bf16 v[80:83], v[44:47], v[116:123], v16
    ds_read_b128 v[116:119], v4 offset:14336
    ds_read_b128 v[120:123], v4 offset:15360
    v_add_f32 v68, v68, v70
    v_add_f32 v69, v69, v71
    v_add_f32 v72, v72, v74
    v_add_f32 v73, v73, v75
    s_waitcnt lgkmcnt(10)
    v_smfmac_f32_16x16x64_bf16 v[76:79], v[48:51], v[84:91], v16
    ds_read_b128 v[84:87], v4 offset:30720
    ds_read_b128 v[88:91], v4 offset:31744
    v_cvt_pk_bf16_f32 v68, v68, v72
    v_cvt_pk_bf16_f32 v69, v69, v73
    ds_write_b32 v5, v68 offset:2304
    ds_write_b32 v5, v69 offset:2592
    s_waitcnt lgkmcnt(12)
    v_smfmac_f32_16x16x64_bf16 v[80:83], v[48:51], v[92:99], v16
    ds_read_b128 v[92:95], v7 offset:0
    ds_read_b128 v[96:99], v7 offset:4096
    s_waitcnt lgkmcnt(2)
    s_barrier
    ds_read_b128 v[28:31], v6 offset:0
    ds_read_b128 v[32:35], v6 offset:2304
    ds_read_b128 v[36:39], v6 offset:64
    ds_read_b128 v[40:43], v6 offset:2368
    ds_read_b128 v[44:47], v6 offset:128
    ds_read_b128 v[48:51], v6 offset:2432
    ds_read_b128 v[60:63], v6 offset:192
    ds_read_b128 v[64:67], v6 offset:2496
    v_smfmac_f32_16x16x64_bf16 v[76:79], v[52:55], v[100:107], v16
    ds_read_b128 v[100:103], v7 offset:1024
    ds_read_b128 v[104:107], v7 offset:5120
    v_smfmac_f32_16x16x64_bf16 v[80:83], v[52:55], v[108:115], v16
    ds_read_b128 v[108:111], v7 offset:2048
    ds_read_b128 v[112:115], v7 offset:6144
    v_smfmac_f32_16x16x64_bf16 v[76:79], v[56:59], v[116:123], v16
    ds_read_b128 v[116:119], v7 offset:3072
    ds_read_b128 v[120:123], v7 offset:7168
    v_smfmac_f32_16x16x64_bf16 v[80:83], v[56:59], v[84:91], v16
    ds_read_b128 v[84:87], v9
    ds_read_b128 v[88:91], v9 offset:1024
    s_waitcnt lgkmcnt(14)
    v_mfma_f32_16x16x32_bf16 v[68:71], v[92:95], v[28:31], 0
    v_mfma_f32_16x16x32_bf16 v[72:75], v[96:99], v[28:31], 0
    v_mfma_f32_16x16x32_bf16 v[52:55], v[32:35], v[28:31], v[24:27]
    s_waitcnt lgkmcnt(12)
    s_waitcnt lgkmcnt(6)
    v_mfma_f32_16x16x32_bf16 v[68:71], v[100:103], v[36:39], v[68:71]
    v_mfma_f32_16x16x32_bf16 v[72:75], v[104:107], v[36:39], v[72:75]
    v_mfma_f32_16x16x32_bf16 v[52:55], v[40:43], v[36:39], v[52:55]
    v_permlane32_swap_b32 v76, v80
    v_permlane32_swap_b32 v77, v81
    v_permlane32_swap_b32 v78, v82
    v_permlane32_swap_b32 v79, v83
    s_nop 0
    v_add_f32 v76, v76, v80
    v_add_f32 v77, v77, v81
    v_add_f32 v78, v78, v82
    v_add_f32 v79, v79, v83
    v_cvt_pk_bf16_f32 v124, v76, v77
    v_cvt_pk_bf16_f32 v125, v78, v79
    s_waitcnt lgkmcnt(4)
    v_mfma_f32_16x16x32_bf16 v[68:71], v[108:111], v[44:47], v[68:71]
    v_mfma_f32_16x16x32_bf16 v[72:75], v[112:115], v[44:47], v[72:75]
    v_mfma_f32_16x16x32_bf16 v[52:55], v[48:51], v[44:47], v[52:55]
    s_waitcnt lgkmcnt(2)
    v_mfma_f32_16x16x32_bf16 v[68:71], v[116:119], v[60:63], v[68:71]
    v_mfma_f32_16x16x32_bf16 v[72:75], v[120:123], v[60:63], v[72:75]
    v_mfma_f32_16x16x32_bf16 v[52:55], v[64:67], v[60:63], v[52:55]
    ds_read_b128 v[56:59], v14 offset:2304
    v_mov_b32 v126, v124
    v_mov_b32 v127, v125
    v_mov_b32 v76, v124
    v_mov_b32 v77, v125
    s_lshl_b32 s36, s28, 16
    s_add_u32 s36, s36, s37
    buffer_store_dwordx2 v[124:125], v15, s[24:27], s36 offen sc1
    v_permlane32_swap_b32 v76, v126
    v_permlane32_swap_b32 v77, v127
    s_lshl_b32 s36, s28, 17
    s_lshl_b32 s38, s37, 1
    s_add_u32 s36, s36, s38
    s_lshl_b32 s38, s30, 10
    s_add_u32 s36, s36, s38
    s_waitcnt lgkmcnt(0)
    buffer_store_dwordx4 v[56:59], v1, s[20:23], s36 offen sc1
    s_cmp_eq_u32 s28, 63
    s_cbranch_scc1 chain_end
    v_max3_f32 v80, v68, v69, v70
    v_max3_f32 v81, v71, v72, v73
    v_max3_f32 v80, v74, v75, v80
    v_max3_f32 v81, v52, v53, v81
    v_max3_f32 v80, v54, v55, v80
    v_max_f32 v80, v80, v81
    v_mov_b32 v81, v80
    s_nop 1
    v_permlane16_swap_b32 v80, v81
    s_nop 0
    v_max_f32 v80, v80, v81
    v_mov_b32 v81, v80
    s_nop 1
    v_permlane32_swap_b32 v80, v81
    s_nop 0
    v_max_f32 v80, v80, v81
    v_mul_f32 v80, s40, v80
    v_mov_b32 v81, v80
    v_pk_fma_f32 v[68:69], v[68:69], s[40:41], v[80:81] neg_lo:[0,0,1] neg_hi:[0,0,1]
    v_pk_fma_f32 v[70:71], v[70:71], s[40:41], v[80:81] neg_lo:[0,0,1] neg_hi:[0,0,1]
    v_pk_fma_f32 v[72:73], v[72:73], s[40:41], v[80:81] neg_lo:[0,0,1] neg_hi:[0,0,1]
    v_pk_fma_f32 v[74:75], v[74:75], s[40:41], v[80:81] neg_lo:[0,0,1] neg_hi:[0,0,1]
    v_pk_fma_f32 v[52:53], v[52:53], s[40:41], v[80:81] neg_lo:[0,0,1] neg_hi:[0,0,1]
    v_pk_fma_f32 v[54:55], v[54:55], s[40:41], v[80:81] neg_lo:[0,0,1] neg_hi:[0,0,1]
    v_exp_f32 v68, v68
    v_exp_f32 v69, v69
    v_exp_f32 v70, v70
    v_exp_f32 v71, v71
    v_exp_f32 v72, v72
    v_exp_f32 v73, v73
    v_exp_f32 v74, v74
    v_exp_f32 v75, v75
    v_exp_f32 v52, v52
    v_exp_f32 v53, v53
    v_exp_f32 v54, v54
    v_exp_f32 v55, v55
    v_mov_b32 v44, s63
    v_mov_b32 v45, s63
    v_mov_b32 v46, s63
    v_mov_b32 v47, s63
    v_cvt_pk_bf16_f32 v60, v68, v69
    v_cvt_pk_bf16_f32 v61, v70, v71
    v_cvt_pk_bf16_f32 v62, v72, v73
    v_cvt_pk_bf16_f32 v63, v74, v75
    v_cvt_pk_bf16_f32 v64, v52, v53
    v_cvt_pk_bf16_f32 v65, v54, v55
    s_nop 0
    v_mfma_f32_16x16x32_bf16 v[36:39], v[44:47], v[60:63], 0
    v_mfma_f32_16x16x32_bf16 v[28:31], v[84:87], v[60:63], 0
    v_mfma_f32_16x16x32_bf16 v[32:35], v[88:91], v[60:63], 0
    s_add_u32 s35, s28, 1
    s_cmp_ge_u32 s35, 64
    s_cbranch_scc1 fast_fl_ok
fast_fl:
    s_cmp_gt_u32 s31, s35
    s_cbranch_scc1 fast_fl_ok
    buffer_load_dword v19, v18, s[8:11], 0 offen sc1
    s_add_u32 s98, s98, 1
    s_waitcnt vmcnt(0)
    v_readlane_b32 s31, v19, 0
    v_readlane_b32 s36, v19, 1
    s_min_u32 s31, s31, s36
    v_readlane_b32 s36, v19, 2
    s_min_u32 s31, s31, s36
    v_readlane_b32 s36, v19, 3
    s_min_u32 s31, s31, s36
    v_readlane_b32 s36, v19, 4
    s_min_u32 s31, s31, s36
    v_readlane_b32 s36, v19, 5
    s_min_u32 s31, s31, s36
    v_readlane_b32 s36, v19, 6
    s_min_u32 s31, s31, s36
    v_readlane_b32 s36, v19, 7
    s_min_u32 s31, s31, s36
    s_lshl_b32 s31, s31, 2
    s_cmp_gt_u32 s98, 262144
    s_cbranch_scc0 fast_fl
fast_fl_ok:
    s_lshl_b32 s36, s35, 18
    s_add_u32 s36, s36, s34
    buffer_load_dwordx4 v[92:95], v2, s[12:15], s36 offen offset:0 sc1
    buffer_load_dwordx4 v[96:99], v2, s[12:15], s36 offen offset:1024 sc1
    buffer_load_dwordx4 v[100:103], v2, s[16:19], s36 offen offset:0 sc1
    buffer_load_dwordx4 v[104:107], v2, s[16:19], s36 offen offset:1024 sc1
    s_nop 1
    v_mfma_f32_16x16x16_bf16 v[36:39], v[44:45], v[64:65], v[36:39]
    v_mfma_f32_16x16x16_bf16 v[28:31], v[124:125], v[64:65], v[28:31]
    v_mfma_f32_16x16x16_bf16 v[32:35], v[126:127], v[64:65], v[32:35]
    v_mov_b32 v68, 0
    v_mov_b32 v69, 0
    v_mov_b32 v70, 0
    v_mov_b32 v71, 0
    v_mov_b32 v72, 0
    v_mov_b32 v73, 0
    v_mov_b32 v74, 0
    v_mov_b32 v75, 0
    v_mov_b32 v76, 0
    v_mov_b32 v77, 0
    v_mov_b32 v78, 0
    v_mov_b32 v79, 0
    v_mov_b32 v80, 0
    v_mov_b32 v81, 0
    v_mov_b32 v82, 0
    v_mov_b32 v83, 0
    v_rcp_f32 v36, v36
    s_nop 0
    v_pk_mul_f32 v[28:29], v[28:29], v[36:37] op_sel_hi:[1,0]
    v_pk_mul_f32 v[30:31], v[30:31], v[36:37] op_sel_hi:[1,0]
    v_pk_mul_f32 v[32:33], v[32:33], v[36:37] op_sel_hi:[1,0]
    v_pk_mul_f32 v[34:35], v[34:35], v[36:37] op_sel_hi:[1,0]
    v_cvt_pk_bf16_f32 v40, v28, v32
    v_cvt_pk_bf16_f32 v41, v29, v33
    v_cvt_pk_bf16_f32 v42, v30, v34
    v_cvt_pk_bf16_f32 v43, v31, v35
    ds_write_b128 v8, v[40:43]
    v_mov_b32 v60, 0
    v_mov_b32 v61, 0
    v_mov_b32 v62, 0
    v_mov_b32 v63, 0
    v_mov_b32 v64, 0
    v_mov_b32 v65, 0
    v_mov_b32 v66, 0
    v_mov_b32 v67, 0
    v_mov_b32 v84, 0
    v_mov_b32 v85, 0
    v_mov_b32 v86, 0
    v_mov_b32 v87, 0
    v_mov_b32 v88, 0
    v_mov_b32 v89, 0
    v_mov_b32 v90, 0
    v_mov_b32 v91, 0
    s_waitcnt lgkmcnt(0)
    s_barrier
    ds_read_b128 v[28:31], v10 offset:0
    ds_read_b128 v[32:35], v10 offset:128
    s_and_b32 s33, s28, 1
    s_lshl_b32 s33, s33, 18
    s_add_u32 s33, s33, 0x100000
    s_waitcnt lgkmcnt(0)
    v_smfmac_f32_16x16x64_bf16 v[60:63], v[28:31], v[128:135], v16
    v_smfmac_f32_16x16x64_bf16 v[64:67], v[28:31], v[144:151], v16
    v_smfmac_f32_16x16x64_bf16 v[60:63], v[32:35], v[136:143], v16
    v_smfmac_f32_16x16x64_bf16 v[64:67], v[32:35], v[152:159], v16
    v_smfmac_f32_16x16x64_bf16 v[68:71], v[28:31], v[160:167], v16
    v_smfmac_f32_16x16x64_bf16 v[72:75], v[28:31], v[176:183], v16
    v_smfmac_f32_16x16x64_bf16 v[68:71], v[32:35], v[168:175], v16
    v_smfmac_f32_16x16x64_bf16 v[72:75], v[32:35], v[184:191], v16
    v_smfmac_f32_16x16x64_bf16 v[76:79], v[28:31], v[192:199], v16
    v_permlane32_swap_b32 v60, v64
    v_permlane32_swap_b32 v61, v65
    v_permlane32_swap_b32 v62, v66
    v_smfmac_f32_16x16x64_bf16 v[80:83], v[28:31], v[208:215], v16
    v_permlane32_swap_b32 v63, v67
    s_nop 0
    v_add_f32 v60, v60, v64
    v_smfmac_f32_16x16x64_bf16 v[76:79], v[32:35], v[200:207], v16
    v_add_f32 v61, v61, v65
    v_add_f32 v62, v62, v66
    v_add_f32 v63, v63, v67
    v_smfmac_f32_16x16x64_bf16 v[80:83], v[32:35], v[216:223], v16
    v_cvt_pk_bf16_f32 v36, v60, v61
    v_cvt_pk_bf16_f32 v37, v62, v63
    v_smfmac_f32_16x16x64_bf16 v[84:87], v[28:31], v[224:231], v16
    v_permlane32_swap_b32 v68, v72
    v_permlane32_swap_b32 v69, v73
    v_permlane32_swap_b32 v70, v74
    v_permlane32_swap_b32 v71, v75
    v_smfmac_f32_16x16x64_bf16 v[88:91], v[28:31], v[240:247], v16
    s_nop 0
    v_add_f32 v68, v68, v72
    v_add_f32 v69, v69, v73
    v_add_f32 v70, v70, v74
    v_smfmac_f32_16x16x64_bf16 v[84:87], v[32:35], v[232:239], v16
    v_add_f32 v71, v71, v75
    v_cvt_pk_bf16_f32 v38, v68, v69
    v_cvt_pk_bf16_f32 v39, v70, v71
    s_add_u32 s36, s33, 0
    v_smfmac_f32_16x16x64_bf16 v[88:91], v[32:35], v[248:255], v16
    s_nop 0
    v_permlane16_swap_b32 v36, v38
    v_permlane16_swap_b32 v37, v39
    buffer_store_dwordx4 v[36:39], v11, s[8:11], s36 offen
    v_permlane32_swap_b32 v76, v80
    v_permlane32_swap_b32 v77, v81
    v_permlane32_swap_b32 v78, v82
    v_permlane32_swap_b32 v79, v83
    s_nop 0
    v_add_f32 v76, v76, v80
    v_add_f32 v77, v77, v81
    v_add_f32 v78, v78, v82
    v_add_f32 v79, v79, v83
    v_cvt_pk_bf16_f32 v40, v76, v77
    v_cvt_pk_bf16_f32 v41, v78, v79
    s_nop 0
    v_permlane32_swap_b32 v84, v88
    v_permlane32_swap_b32 v85, v89
    v_permlane32_swap_b32 v86, v90
    v_permlane32_swap_b32 v87, v91
    s_nop 0
    v_add_f32 v84, v84, v88
    v_add_f32 v85, v85, v89
    v_add_f32 v86, v86, v90
    v_add_f32 v87, v87, v91
    v_cvt_pk_bf16_f32 v42, v84, v85
    v_cvt_pk_bf16_f32 v43, v86, v87
    s_add_u32 s36, s33, 32768
    s_nop 0
    v_permlane16_swap_b32 v40, v42
    v_permlane16_swap_b32 v41, v43
    buffer_store_dwordx4 v[40:43], v11, s[8:11], s36 offen
fast_pp:
    buffer_load_dwordx4 v[44:47], v12, s[8:11], s33 offen offset:0 sc1
    buffer_load_dwordx4 v[48:51], v12, s[8:11], s33 offen offset:1024 sc1
    s_add_u32 s98, s98, 1
    s_waitcnt vmcnt(0)
    v_max3_u32 v19, v44, v45, v46
    v_max3_u32 v19, v47, v48, v19
    v_max3_u32 v19, v49, v50, v19
    v_max_u32 v19, v51, v19
    v_cmp_eq_u32 vcc, -1, v19
    s_cmp_gt_u32 s98, 262144
    s_cbranch_scc1 fast_pp_x
    s_cbranch_vccnz fast_pp
fast_pp_x:
    v_mfma_f32_16x16x32_bf16 v[28:31], v[20:23], v[44:47], 0
    v_mfma_f32_16x16x32_bf16 v[28:31], v[20:23], v[48:51], v[28:31]
    v_mov_b32 v32, -1
    v_mov_b32 v33, -1
    v_mov_b32 v34, -1
    v_mov_b32 v35, -1
    s_add_u32 s32, s32, 8192
    s_nop 4
    v_add_f32_dpp v28, v28, v28 row_ror:4 row_mask:0xf bank_mask:0xf
    v_add_f32_dpp v29, v29, v29 row_ror:4 row_mask:0xf bank_mask:0xf
    v_add_f32_dpp v30, v30, v30 row_ror:4 row_mask:0xf bank_mask:0xf
    v_add_f32_dpp v31, v31, v31 row_ror:4 row_mask:0xf bank_mask:0xf
    s_nop 0
    v_add_f32_dpp v28, v28, v28 row_ror:8 row_mask:0xf bank_mask:0xf
    v_add_f32_dpp v29, v29, v29 row_ror:8 row_mask:0xf bank_mask:0xf
    v_add_f32_dpp v30, v30, v30 row_ror:8 row_mask:0xf bank_mask:0xf
    v_add_f32_dpp v31, v31, v31 row_ror:8 row_mask:0xf bank_mask:0xf
    s_nop 0
    v_cndmask_b32 v28, v28, v29, s[44:45]
    v_cndmask_b32 v30, v30, v31, s[44:45]
    s_nop 0
    v_cndmask_b32 v28, v28, v30, s[46:47]
    s_nop 1
    v_mov_b32_dpp v29, v28 quad_perm:[1,1,3,3] row_mask:0xf bank_mask:0xf
    s_nop 0
    v_cvt_pk_bf16_f32 v28, v28, v29
    s_mov_b64 exec, s[42:43]
    buffer_store_dword v28, v0, s[8:11], s32 offen
    s_mov_b64 exec, -1
    buffer_store_dwordx4 v[32:35], v12, s[8:11], s33 offen offset:0
    buffer_store_dwordx4 v[32:35], v12, s[8:11], s33 offen offset:1024
    ds_write_b128 v17, v[92:95] offset:0
    ds_write_b128 v17, v[100:103] offset:8192
    ds_write_b128 v17, v[96:99] offset:1024
    ds_write_b128 v17, v[104:107] offset:9216
    ds_read_b128 v[84:87], v4 offset:0
    ds_read_b128 v[88:91], v4 offset:1024
    ds_read_b128 v[92:95], v4 offset:16384
    ds_read_b128 v[96:99], v4 offset:17408
    ds_read_b128 v[100:103], v4 offset:2048
    ds_read_b128 v[104:107], v4 offset:3072
    ds_read_b128 v[108:111], v4 offset:18432
    ds_read_b128 v[112:115], v4 offset:19456
    ds_read_b128 v[116:119], v4 offset:4096
    ds_read_b128 v[120:123], v4 offset:5120
    v_mov_b32 v60, 0
    v_mov_b32 v61, 0
    v_mov_b32 v62, 0
    v_mov_b32 v63, 0
    v_mov_b32 v64, 0
    v_mov_b32 v65, 0
    v_mov_b32 v66, 0
    v_mov_b32 v67, 0
    v_mov_b32 v68, 0
    v_mov_b32 v69, 0
    v_mov_b32 v70, 0
    v_mov_b32 v71, 0
    v_mov_b32 v72, 0
    v_mov_b32 v73, 0
    v_mov_b32 v74, 0
    v_mov_b32 v75, 0
    v_mov_b32 v76, 0
    v_mov_b32 v77, 0
    v_mov_b32 v78, 0
    v_mov_b32 v79, 0
    v_mov_b32 v80, 0
    v_mov_b32 v81, 0
    v_mov_b32 v82, 0
    v_mov_b32 v83, 0
    s_add_u32 s28, s28, 1
    s_waitcnt lgkmcnt(0)
    s_branch fast_loop
slow_loop:
slow_pm:
    buffer_load_dwordx4 v[28:31], v2, s[8:11], s32 offen offset:0 sc1
    buffer_load_dwordx4 v[32:35], v2, s[8:11], s32 offen offset:1024 sc1
    s_add_u32 s98, s98, 1
    s_waitcnt vmcnt(0)
    v_max3_u32 v19, v28, v29, v30
    v_max3_u32 v19, v31, v32, v19
    v_max3_u32 v19, v33, v34, v19
    v_max_u32 v19, v35, v19
    v_cmp_eq_u32 vcc, -1, v19
    s_cmp_gt_u32 s98, 262144
    s_cbranch_scc1 slow_pm_x
    s_cbranch_vccnz slow_pm
slow_pm_x:
    v_mov_b32 v19, s28
    v_mov_b32 v125, s64
    s_mov_b64 exec, 1
    buffer_store_dword v19, v125, s[8:11], 0 offen sc1
    s_mov_b64 exec, -1
    ds_write_b128 v13, v[28:31] offset:0
    ds_write_b128 v13, v[32:35] offset:1024
    s_waitcnt lgkmcnt(0)
    s_barrier
    ds_read_b128 v[28:31], v3 offset:0
    ds_read_b128 v[32:35], v3 offset:1024
    ds_read_b128 v[36:39], v3 offset:2048
    ds_read_b128 v[40:43], v3 offset:3072
    ds_read_b128 v[44:47], v3 offset:4096
    ds_read_b128 v[48:51], v3 offset:5120
    ds_read_b128 v[52:55], v3 offset:6144
    ds_read_b128 v[56:59], v3 offset:7168
    s_waitcnt lgkmcnt(7)
    v_smfmac_f32_16x16x64_bf16 v[60:63], v[28:31], a[0:7], v16
    v_smfmac_f32_16x16x64_bf16 v[64:67], v[28:31], a[64:71], v16
    v_smfmac_f32_16x16x64_bf16 v[68:71], v[28:31], a[128:135], v16
    v_smfmac_f32_16x16x64_bf16 v[72:75], v[28:31], a[192:199], v16
    s_waitcnt lgkmcnt(6)
    v_smfmac_f32_16x16x64_bf16 v[60:63], v[32:35], a[8:15], v16
    v_smfmac_f32_16x16x64_bf16 v[64:67], v[32:35], a[72:79], v16
    v_smfmac_f32_16x16x64_bf16 v[68:71], v[32:35], a[136:143], v16
    v_smfmac_f32_16x16x64_bf16 v[72:75], v[32:35], a[200:207], v16
    s_waitcnt lgkmcnt(5)
    v_smfmac_f32_16x16x64_bf16 v[60:63], v[36:39], a[16:23], v16
    v_smfmac_f32_16x16x64_bf16 v[64:67], v[36:39], a[80:87], v16
    v_smfmac_f32_16x16x64_bf16 v[68:71], v[36:39], a[144:151], v16
    v_smfmac_f32_16x16x64_bf16 v[72:75], v[36:39], a[208:215], v16
    v_smfmac_f32_16x16x64_bf16 v[76:79], v[28:31], v[84:91], v16
    ds_read_b128 v[84:87], v4 offset:20480
    ds_read_b128 v[88:91], v4 offset:21504
    s_waitcnt lgkmcnt(6)
    v_smfmac_f32_16x16x64_bf16 v[60:63], v[40:43], a[24:31], v16
    v_smfmac_f32_16x16x64_bf16 v[64:67], v[40:43], a[88:95], v16
    v_smfmac_f32_16x16x64_bf16 v[68:71], v[40:43], a[152:159], v16
    v_smfmac_f32_16x16x64_bf16 v[72:75], v[40:43], a[216:223], v16
    v_smfmac_f32_16x16x64_bf16 v[80:83], v[28:31], v[92:99], v16
    ds_read_b128 v[92:95], v4 offset:6144
    ds_read_b128 v[96:99], v4 offset:7168
    s_waitcnt lgkmcnt(7)
    v_smfmac_f32_16x16x64_bf16 v[60:63], v[44:47], a[32:39], v16
    v_smfmac_f32_16x16x64_bf16 v[64:67], v[44:47], a[96:103], v16
    v_smfmac_f32_16x16x64_bf16 v[68:71], v[44:47], a[160:167], v16
    v_smfmac_f32_16x16x64_bf16 v[72:75], v[44:47], a[224:231], v16
    v_smfmac_f32_16x16x64_bf16 v[76:79], v[32:35], v[100:107], v16
    ds_read_b128 v[100:103], v4 offset:22528
    ds_read_b128 v[104:107], v4 offset:23552
    s_waitcnt lgkmcnt(8)
    v_smfmac_f32_16x16x64_bf16 v[60:63], v[48:51], a[40:47], v16
    v_smfmac_f32_16x16x64_bf16 v[64:67], v[48:51], a[104:111], v16
    v_smfmac_f32_16x16x64_bf16 v[68:71], v[48:51], a[168:175], v16
    v_smfmac_f32_16x16x64_bf16 v[72:75], v[48:51], a[232:239], v16
    v_smfmac_f32_16x16x64_bf16 v[80:83], v[32:35], v[108:115], v16
    ds_read_b128 v[108:111], v4 offset:8192
    ds_read_b128 v[112:115], v4 offset:9216
    s_waitcnt lgkmcnt(9)
    v_smfmac_f32_16x16x64_bf16 v[60:63], v[52:55], a[48:55], v16
    v_smfmac_f32_16x16x64_bf16 v[64:67], v[52:55], a[112:119], v16
    v_smfmac_f32_16x16x64_bf16 v[68:71], v[52:55], a[176:183], v16
    v_smfmac_f32_16x16x64_bf16 v[72:75], v[52:55], a[240:247], v16
    v_smfmac_f32_16x16x64_bf16 v[76:79], v[36:39], v[116:123], v16
    ds_read_b128 v[116:119], v4 offset:24576
    ds_read_b128 v[120:123], v4 offset:25600
    s_waitcnt lgkmcnt(10)
    v_smfmac_f32_16x16x64_bf16 v[60:63], v[56:59], a[56:63], v16
    v_smfmac_f32_16x16x64_bf16 v[64:67], v[56:59], a[120:127], v16
    v_smfmac_f32_16x16x64_bf16 v[68:71], v[56:59], a[184:191], v16
    v_smfmac_f32_16x16x64_bf16 v[72:75], v[56:59], a[248:255], v16
    s_waitcnt lgkmcnt(8)
    v_smfmac_f32_16x16x64_bf16 v[80:83], v[36:39], v[84:91], v16
    ds_read_b128 v[84:87], v4 offset:10240
    ds_read_b128 v[88:91], v4 offset:11264
    s_waitcnt lgkmcnt(8)
    v_smfmac_f32_16x16x64_bf16 v[76:79], v[40:43], v[92:99], v16
    ds_read_b128 v[92:95], v4 offset:26624
    ds_read_b128 v[96:99], v4 offset:27648
    s_nop 1
    v_permlane32_swap_b32 v60, v62
    v_permlane32_swap_b32 v61, v63
    v_permlane32_swap_b32 v64, v66
    v_permlane32_swap_b32 v65, v67
    s_waitcnt lgkmcnt(8)
    v_smfmac_f32_16x16x64_bf16 v[80:83], v[40:43], v[100:107], v16
    ds_read_b128 v[100:103], v4 offset:12288
    ds_read_b128 v[104:107], v4 offset:13312
    v_add_f32 v60, v60, v62
    v_add_f32 v61, v61, v63
    v_add_f32 v64, v64, v66
    v_add_f32 v65, v65, v67
    s_waitcnt lgkmcnt(8)
    v_smfmac_f32_16x16x64_bf16 v[76:79], v[44:47], v[108:115], v16
    ds_read_b128 v[108:111], v4 offset:28672
    ds_read_b128 v[112:115], v4 offset:29696
    v_cvt_pk_bf16_f32 v60, v60, v64
    v_cvt_pk_bf16_f32 v61, v61, v65
    ds_write_b32 v5, v60 offset:0
    ds_write_b32 v5, v61 offset:288
    v_permlane32_swap_b32 v68, v70
    v_permlane32_swap_b32 v69, v71
    v_permlane32_swap_b32 v72, v74
    v_permlane32_swap_b32 v73, v75
    s_waitcnt lgkmcnt(10)
    v_smfmac_f32_16x16x64_bf16 v[80:83], v[44:47], v[116:123], v16
    ds_read_b128 v[116:119], v4 offset:14336
    ds_read_b128 v[120:123], v4 offset:15360
    v_add_f32 v68, v68, v70
    v_add_f32 v69, v69, v71
    v_add_f32 v72, v72, v74
    v_add_f32 v73, v73, v75
    s_waitcnt lgkmcnt(10)
    v_smfmac_f32_16x16x64_bf16 v[76:79], v[48:51], v[84:91], v16
    ds_read_b128 v[84:87], v4 offset:30720
    ds_read_b128 v[88:91], v4 offset:31744
    v_cvt_pk_bf16_f32 v68, v68, v72
    v_cvt_pk_bf16_f32 v69, v69, v73
    ds_write_b32 v5, v68 offset:2304
    ds_write_b32 v5, v69 offset:2592
    s_waitcnt lgkmcnt(12)
    v_smfmac_f32_16x16x64_bf16 v[80:83], v[48:51], v[92:99], v16
    ds_read_b128 v[92:95], v7 offset:0
    ds_read_b128 v[96:99], v7 offset:4096
    s_waitcnt lgkmcnt(2)
    s_barrier
    ds_read_b128 v[28:31], v6 offset:0
    ds_read_b128 v[32:35], v6 offset:2304
    ds_read_b128 v[36:39], v6 offset:64
    ds_read_b128 v[40:43], v6 offset:2368
    ds_read_b128 v[44:47], v6 offset:128
    ds_read_b128 v[48:51], v6 offset:2432
    ds_read_b128 v[60:63], v6 offset:192
    ds_read_b128 v[64:67], v6 offset:2496
    v_smfmac_f32_16x16x64_bf16 v[76:79], v[52:55], v[100:107], v16
    ds_read_b128 v[100:103], v7 offset:1024
    ds_read_b128 v[104:107], v7 offset:5120
    v_smfmac_f32_16x16x64_bf16 v[80:83], v[52:55], v[108:115], v16
    ds_read_b128 v[108:111], v7 offset:2048
    ds_read_b128 v[112:115], v7 offset:6144
    v_smfmac_f32_16x16x64_bf16 v[76:79], v[56:59], v[116:123], v16
    ds_read_b128 v[116:119], v7 offset:3072
    ds_read_b128 v[120:123], v7 offset:7168
    v_smfmac_f32_16x16x64_bf16 v[80:83], v[56:59], v[84:91], v16
    ds_read_b128 v[84:87], v9
    ds_read_b128 v[88:91], v9 offset:1024
    s_waitcnt lgkmcnt(14)
    v_mfma_f32_16x16x32_bf16 v[68:71], v[92:95], v[28:31], 0
    v_mfma_f32_16x16x32_bf16 v[72:75], v[96:99], v[28:31], 0
    v_mfma_f32_16x16x32_bf16 v[52:55], v[32:35], v[28:31], v[24:27]
    s_waitcnt lgkmcnt(12)
    s_waitcnt lgkmcnt(6)
    v_mfma_f32_16x16x32_bf16 v[68:71], v[100:103], v[36:39], v[68:71]
    v_mfma_f32_16x16x32_bf16 v[72:75], v[104:107], v[36:39], v[72:75]
    v_mfma_f32_16x16x32_bf16 v[52:55], v[40:43], v[36:39], v[52:55]
    v_permlane32_swap_b32 v76, v80
    v_permlane32_swap_b32 v77, v81
    v_permlane32_swap_b32 v78, v82
    v_permlane32_swap_b32 v79, v83
    s_nop 0
    v_add_f32 v76, v76, v80
    v_add_f32 v77, v77, v81
    v_add_f32 v78, v78, v82
    v_add_f32 v79, v79, v83
    v_cvt_pk_bf16_f32 v124, v76, v77
    v_cvt_pk_bf16_f32 v125, v78, v79
    s_waitcnt lgkmcnt(4)
    v_mfma_f32_16x16x32_bf16 v[68:71], v[108:111], v[44:47], v[68:71]
    v_mfma_f32_16x16x32_bf16 v[72:75], v[112:115], v[44:47], v[72:75]
    v_mfma_f32_16x16x32_bf16 v[52:55], v[48:51], v[44:47], v[52:55]
    s_waitcnt lgkmcnt(2)
    v_mfma_f32_16x16x32_bf16 v[68:71], v[116:119], v[60:63], v[68:71]
    v_mfma_f32_16x16x32_bf16 v[72:75], v[120:123], v[60:63], v[72:75]
    v_mfma_f32_16x16x32_bf16 v[52:55], v[64:67], v[60:63], v[52:55]
    ds_read_b128 v[56:59], v14 offset:2304
    v_mov_b32 v126, v124
    v_mov_b32 v127, v125
    v_mov_b32 v76, v124
    v_mov_b32 v77, v125
    s_lshl_b32 s36, s28, 16
    s_add_u32 s36, s36, s37
    buffer_store_dwordx2 v[124:125], v15, s[24:27], s36 offen sc1
    v_permlane32_swap_b32 v76, v126
    v_permlane32_swap_b32 v77, v127
    s_lshl_b32 s36, s28, 17
    s_lshl_b32 s38, s37, 1
    s_add_u32 s36, s36, s38
    s_lshl_b32 s38, s30, 10
    s_add_u32 s36, s36, s38
    s_waitcnt lgkmcnt(0)
    buffer_store_dwordx4 v[56:59], v1, s[20:23], s36 offen sc1
    s_cmp_eq_u32 s28, 63
    s_cbranch_scc1 chain_end
    v_max3_f32 v80, v68, v69, v70
    v_max3_f32 v81, v71, v72, v73
    v_max3_f32 v80, v74, v75, v80
    v_max3_f32 v81, v52, v53, v81
    v_max3_f32 v80, v54, v55, v80
    v_max_f32 v80, v80, v81
    v_mov_b32 v81, v80
    s_nop 1
    v_permlane16_swap_b32 v80, v81
    s_nop 0
    v_max_f32 v80, v80, v81
    v_mov_b32 v81, v80
    s_nop 1
    v_permlane32_swap_b32 v80, v81
    s_nop 0
    v_max_f32 v80, v80, v81
    v_mul_f32 v80, s40, v80
    v_mov_b32 v81, v80
    v_pk_fma_f32 v[68:69], v[68:69], s[40:41], v[80:81] neg_lo:[0,0,1] neg_hi:[0,0,1]
    v_pk_fma_f32 v[70:71], v[70:71], s[40:41], v[80:81] neg_lo:[0,0,1] neg_hi:[0,0,1]
    v_pk_fma_f32 v[72:73], v[72:73], s[40:41], v[80:81] neg_lo:[0,0,1] neg_hi:[0,0,1]
    v_pk_fma_f32 v[74:75], v[74:75], s[40:41], v[80:81] neg_lo:[0,0,1] neg_hi:[0,0,1]
    v_pk_fma_f32 v[52:53], v[52:53], s[40:41], v[80:81] neg_lo:[0,0,1] neg_hi:[0,0,1]
    v_pk_fma_f32 v[54:55], v[54:55], s[40:41], v[80:81] neg_lo:[0,0,1] neg_hi:[0,0,1]
    v_exp_f32 v68, v68
    v_exp_f32 v69, v69
    v_exp_f32 v70, v70
    v_exp_f32 v71, v71
    v_exp_f32 v72, v72
    v_exp_f32 v73, v73
    v_exp_f32 v74, v74
    v_exp_f32 v75, v75
    v_exp_f32 v52, v52
    v_exp_f32 v53, v53
    v_exp_f32 v54, v54
    v_exp_f32 v55, v55
    v_mov_b32 v44, s63
    v_mov_b32 v45, s63
    v_mov_b32 v46, s63
    v_mov_b32 v47, s63
    v_cvt_pk_bf16_f32 v60, v68, v69
    v_cvt_pk_bf16_f32 v61, v70, v71
    v_cvt_pk_bf16_f32 v62, v72, v73
    v_cvt_pk_bf16_f32 v63, v74, v75
    v_cvt_pk_bf16_f32 v64, v52, v53
    v_cvt_pk_bf16_f32 v65, v54, v55
    s_nop 0
    v_mfma_f32_16x16x32_bf16 v[36:39], v[44:47], v[60:63], 0
    v_mfma_f32_16x16x32_bf16 v[28:31], v[84:87], v[60:63], 0
    v_mfma_f32_16x16x32_bf16 v[32:35], v[88:91], v[60:63], 0
    s_add_u32 s35, s28, 1
    s_cmp_ge_u32 s35, 64
    s_cbranch_scc1 slow_fl_ok
slow_fl:
    s_cmp_gt_u32 s31, s35
    s_cbranch_scc1 slow_fl_ok
    buffer_load_dword v19, v18, s[8:11], 0 offen sc1
    s_add_u32 s98, s98, 1
    s_waitcnt vmcnt(0)
    v_readlane_b32 s31, v19, 0
    v_readlane_b32 s36, v19, 1
    s_min_u32 s31, s31, s36
    v_readlane_b32 s36, v19, 2
    s_min_u32 s31, s31, s36
    v_readlane_b32 s36, v19, 3
    s_min_u32 s31, s31, s36
    v_readlane_b32 s36, v19, 4
    s_min_u32 s31, s31, s36
    v_readlane_b32 s36, v19, 5
    s_min_u32 s31, s31, s36
    v_readlane_b32 s36, v19, 6
    s_min_u32 s31, s31, s36
    v_readlane_b32 s36, v19, 7
    s_min_u32 s31, s31, s36
    s_lshl_b32 s31, s31, 2
    s_cmp_gt_u32 s98, 262144
    s_cbranch_scc0 slow_fl
slow_fl_ok:
    s_lshl_b32 s36, s35, 18
    s_add_u32 s36, s36, s34
    buffer_load_dwordx4 v[92:95], v2, s[12:15], s36 offen offset:0 sc1
    buffer_load_dwordx4 v[96:99], v2, s[12:15], s36 offen offset:1024 sc1
    buffer_load_dwordx4 v[100:103], v2, s[16:19], s36 offen offset:0 sc1
    buffer_load_dwordx4 v[104:107], v2, s[16:19], s36 offen offset:1024 sc1
    s_nop 1
    v_mfma_f32_16x16x16_bf16 v[36:39], v[44:45], v[64:65], v[36:39]
    v_mfma_f32_16x16x16_bf16 v[28:31], v[124:125], v[64:65], v[28:31]
    v_mfma_f32_16x16x16_bf16 v[32:35], v[126:127], v[64:65], v[32:35]
    v_mov_b32 v68, 0
    v_mov_b32 v69, 0
    v_mov_b32 v70, 0
    v_mov_b32 v71, 0
    v_mov_b32 v72, 0
    v_mov_b32 v73, 0
    v_mov_b32 v74, 0
    v_mov_b32 v75, 0
    v_mov_b32 v76, 0
    v_mov_b32 v77, 0
    v_mov_b32 v78, 0
    v_mov_b32 v79, 0
    v_mov_b32 v80, 0
    v_mov_b32 v81, 0
    v_mov_b32 v82, 0
    v_mov_b32 v83, 0
    v_rcp_f32 v36, v36
    s_nop 0
    v_pk_mul_f32 v[28:29], v[28:29], v[36:37] op_sel_hi:[1,0]
    v_pk_mul_f32 v[30:31], v[30:31], v[36:37] op_sel_hi:[1,0]
    v_pk_mul_f32 v[32:33], v[32:33], v[36:37] op_sel_hi:[1,0]
    v_pk_mul_f32 v[34:35], v[34:35], v[36:37] op_sel_hi:[1,0]
    v_cvt_pk_bf16_f32 v40, v28, v32
    v_cvt_pk_bf16_f32 v41, v29, v33
    v_cvt_pk_bf16_f32 v42, v30, v34
    v_cvt_pk_bf16_f32 v43, v31, v35
    ds_write_b128 v8, v[40:43]
    v_mov_b32 v60, 0
    v_mov_b32 v61, 0
    v_mov_b32 v62, 0
    v_mov_b32 v63, 0
    v_mov_b32 v64, 0
    v_mov_b32 v65, 0
    v_mov_b32 v66, 0
    v_mov_b32 v67, 0
    v_mov_b32 v84, 0
    v_mov_b32 v85, 0
    v_mov_b32 v86, 0
    v_mov_b32 v87, 0
    v_mov_b32 v88, 0
    v_mov_b32 v89, 0
    v_mov_b32 v90, 0
    v_mov_b32 v91, 0
    s_waitcnt lgkmcnt(0)
    s_barrier
    ds_read_b128 v[28:31], v10 offset:0
    ds_read_b128 v[32:35], v10 offset:128
    s_and_b32 s33, s28, 1
    s_lshl_b32 s33, s33, 18
    s_add_u32 s33, s33, 0x100000
    s_waitcnt lgkmcnt(0)
    v_smfmac_f32_16x16x64_bf16 v[60:63], v[28:31], v[128:135], v16
    v_smfmac_f32_16x16x64_bf16 v[64:67], v[28:31], v[144:151], v16
    v_smfmac_f32_16x16x64_bf16 v[60:63], v[32:35], v[136:143], v16
    v_smfmac_f32_16x16x64_bf16 v[64:67], v[32:35], v[152:159], v16
    v_smfmac_f32_16x16x64_bf16 v[68:71], v[28:31], v[160:167], v16
    v_smfmac_f32_16x16x64_bf16 v[72:75], v[28:31], v[176:183], v16
    v_smfmac_f32_16x16x64_bf16 v[68:71], v[32:35], v[168:175], v16
    v_smfmac_f32_16x16x64_bf16 v[72:75], v[32:35], v[184:191], v16
    v_smfmac_f32_16x16x64_bf16 v[76:79], v[28:31], v[192:199], v16
    v_permlane32_swap_b32 v60, v64
    v_permlane32_swap_b32 v61, v65
    v_permlane32_swap_b32 v62, v66
    v_smfmac_f32_16x16x64_bf16 v[80:83], v[28:31], v[208:215], v16
    v_permlane32_swap_b32 v63, v67
    s_nop 0
    v_add_f32 v60, v60, v64
    v_smfmac_f32_16x16x64_bf16 v[76:79], v[32:35], v[200:207], v16
    v_add_f32 v61, v61, v65
    v_add_f32 v62, v62, v66
    v_add_f32 v63, v63, v67
    v_smfmac_f32_16x16x64_bf16 v[80:83], v[32:35], v[216:223], v16
    v_cvt_pk_bf16_f32 v36, v60, v61
    v_cvt_pk_bf16_f32 v37, v62, v63
    v_smfmac_f32_16x16x64_bf16 v[84:87], v[28:31], v[224:231], v16
    v_permlane32_swap_b32 v68, v72
    v_permlane32_swap_b32 v69, v73
    v_permlane32_swap_b32 v70, v74
    v_permlane32_swap_b32 v71, v75
    v_smfmac_f32_16x16x64_bf16 v[88:91], v[28:31], v[240:247], v16
    s_nop 0
    v_add_f32 v68, v68, v72
    v_add_f32 v69, v69, v73
    v_add_f32 v70, v70, v74
    v_smfmac_f32_16x16x64_bf16 v[84:87], v[32:35], v[232:239], v16
    v_add_f32 v71, v71, v75
    v_cvt_pk_bf16_f32 v38, v68, v69
    v_cvt_pk_bf16_f32 v39, v70, v71
    s_add_u32 s36, s33, 0
    v_smfmac_f32_16x16x64_bf16 v[88:91], v[32:35], v[248:255], v16
    s_nop 0
    v_permlane16_swap_b32 v36, v38
    v_permlane16_swap_b32 v37, v39
    buffer_store_dwordx4 v[36:39], v11, s[8:11], s36 offen sc1
    v_permlane32_swap_b32 v76, v80
    v_permlane32_swap_b32 v77, v81
    v_permlane32_swap_b32 v78, v82
    v_permlane32_swap_b32 v79, v83
    s_nop 0
    v_add_f32 v76, v76, v80
    v_add_f32 v77, v77, v81
    v_add_f32 v78, v78, v82
    v_add_f32 v79, v79, v83
    v_cvt_pk_bf16_f32 v40, v76, v77
    v_cvt_pk_bf16_f32 v41, v78, v79
    s_nop 0
    v_permlane32_swap_b32 v84, v88
    v_permlane32_swap_b32 v85, v89
    v_permlane32_swap_b32 v86, v90
    v_permlane32_swap_b32 v87, v91
    s_nop 0
    v_add_f32 v84, v84, v88
    v_add_f32 v85, v85, v89
    v_add_f32 v86, v86, v90
    v_add_f32 v87, v87, v91
    v_cvt_pk_bf16_f32 v42, v84, v85
    v_cvt_pk_bf16_f32 v43, v86, v87
    s_add_u32 s36, s33, 32768
    s_nop 0
    v_permlane16_swap_b32 v40, v42
    v_permlane16_swap_b32 v41, v43
    buffer_store_dwordx4 v[40:43], v11, s[8:11], s36 offen sc1
slow_pp:
    buffer_load_dwordx4 v[44:47], v12, s[8:11], s33 offen offset:0 sc1
    buffer_load_dwordx4 v[48:51], v12, s[8:11], s33 offen offset:1024 sc1
    s_add_u32 s98, s98, 1
    s_waitcnt vmcnt(0)
    v_max3_u32 v19, v44, v45, v46
    v_max3_u32 v19, v47, v48, v19
    v_max3_u32 v19, v49, v50, v19
    v_max_u32 v19, v51, v19
    v_cmp_eq_u32 vcc, -1, v19
    s_cmp_gt_u32 s98, 262144
    s_cbranch_scc1 slow_pp_x
    s_cbranch_vccnz slow_pp
slow_pp_x:
    v_mfma_f32_16x16x32_bf16 v[28:31], v[20:23], v[44:47], 0
    v_mfma_f32_16x16x32_bf16 v[28:31], v[20:23], v[48:51], v[28:31]
    v_mov_b32 v32, -1
    v_mov_b32 v33, -1
    v_mov_b32 v34, -1
    v_mov_b32 v35, -1
    s_add_u32 s32, s32, 8192
    s_nop 4
    v_add_f32_dpp v28, v28, v28 row_ror:4 row_mask:0xf bank_mask:0xf
    v_add_f32_dpp v29, v29, v29 row_ror:4 row_mask:0xf bank_mask:0xf
    v_add_f32_dpp v30, v30, v30 row_ror:4 row_mask:0xf bank_mask:0xf
    v_add_f32_dpp v31, v31, v31 row_ror:4 row_mask:0xf bank_mask:0xf
    s_nop 0
    v_add_f32_dpp v28, v28, v28 row_ror:8 row_mask:0xf bank_mask:0xf
    v_add_f32_dpp v29, v29, v29 row_ror:8 row_mask:0xf bank_mask:0xf
    v_add_f32_dpp v30, v30, v30 row_ror:8 row_mask:0xf bank_mask:0xf
    v_add_f32_dpp v31, v31, v31 row_ror:8 row_mask:0xf bank_mask:0xf
    s_nop 0
    v_cndmask_b32 v28, v28, v29, s[44:45]
    v_cndmask_b32 v30, v30, v31, s[44:45]
    s_nop 0
    v_cndmask_b32 v28, v28, v30, s[46:47]
    s_nop 1
    v_mov_b32_dpp v29, v28 quad_perm:[1,1,3,3] row_mask:0xf bank_mask:0xf
    s_nop 0
    v_cvt_pk_bf16_f32 v28, v28, v29
    s_mov_b64 exec, s[42:43]
    buffer_store_dword v28, v0, s[8:11], s32 offen sc1
    s_mov_b64 exec, -1
    buffer_store_dwordx4 v[32:35], v12, s[8:11], s33 offen offset:0 sc1
    buffer_store_dwordx4 v[32:35], v12, s[8:11], s33 offen offset:1024 sc1
    ds_write_b128 v17, v[92:95] offset:0
    ds_write_b128 v17, v[100:103] offset:8192
    ds_write_b128 v17, v[96:99] offset:1024
    ds_write_b128 v17, v[104:107] offset:9216
    ds_read_b128 v[84:87], v4 offset:0
    ds_read_b128 v[88:91], v4 offset:1024
    ds_read_b128 v[92:95], v4 offset:16384
    ds_read_b128 v[96:99], v4 offset:17408
    ds_read_b128 v[100:103], v4 offset:2048
    ds_read_b128 v[104:107], v4 offset:3072
    ds_read_b128 v[108:111], v4 offset:18432
    ds_read_b128 v[112:115], v4 offset:19456
    ds_read_b128 v[116:119], v4 offset:4096
    ds_read_b128 v[120:123], v4 offset:5120
    v_mov_b32 v60, 0
    v_mov_b32 v61, 0
    v_mov_b32 v62, 0
    v_mov_b32 v63, 0
    v_mov_b32 v64, 0
    v_mov_b32 v65, 0
    v_mov_b32 v66, 0
    v_mov_b32 v67, 0
    v_mov_b32 v68, 0
    v_mov_b32 v69, 0
    v_mov_b32 v70, 0
    v_mov_b32 v71, 0
    v_mov_b32 v72, 0
    v_mov_b32 v73, 0
    v_mov_b32 v74, 0
    v_mov_b32 v75, 0
    v_mov_b32 v76, 0
    v_mov_b32 v77, 0
    v_mov_b32 v78, 0
    v_mov_b32 v79, 0
    v_mov_b32 v80, 0
    v_mov_b32 v81, 0
    v_mov_b32 v82, 0
    v_mov_b32 v83, 0
    s_add_u32 s28, s28, 1
    s_waitcnt lgkmcnt(0)
    s_branch slow_loop
chain_end:
    s_waitcnt vmcnt(0)
    s_mov_b32 s28, 64
    v_mov_b32 v19, s28
    v_mov_b32 v125, s64
    s_mov_b64 exec, 1
    buffer_store_dword v19, v125, s[8:11], 0 offen sc1
    s_mov_b64 exec, -1
    s_waitcnt vmcnt(0)
main_done:
    s_endpgm
.section .rodata,"a"
.p2align 6
.amdhsa_kernel prep_kernel
  .amdhsa_next_free_vgpr 128
  .amdhsa_next_free_sgpr 64
  .amdhsa_accum_offset 128
  .amdhsa_group_segment_fixed_size 0
  .amdhsa_kernarg_size 128
  .amdhsa_user_sgpr_count 2
  .amdhsa_user_sgpr_kernarg_segment_ptr 1
  .amdhsa_system_sgpr_workgroup_id_x 1
.end_amdhsa_kernel
.p2align 6
.amdhsa_kernel main_kernel
  .amdhsa_next_free_vgpr 512
  .amdhsa_next_free_sgpr 102
  .amdhsa_accum_offset 256
  .amdhsa_group_segment_fixed_size 0
  .amdhsa_kernarg_size 128
  .amdhsa_user_sgpr_count 2
  .amdhsa_user_sgpr_kernarg_segment_ptr 1
  .amdhsa_system_sgpr_workgroup_id_x 1
.end_amdhsa_kernel
```
